```python
import torch

def _softmax(x, axis=-1):
    return torch.softmax(x, dim=axis)
def _gelu(x):
    return torch.nn.functional.gelu(x, approximate="tanh")
def _silu(x):
    return torch.nn.functional.silu(x)
def _sigmoid(x):
    return torch.sigmoid(x)
def _layernorm(x, axis=-1, eps=1e-5):
    m = x.mean(dim=axis, keepdim=True)
    v = x.var(dim=axis, keepdim=True, unbiased=False)
    return (x - m) / torch.sqrt(v + eps)
def _scatter_add(tgt, idx, src, axis=0):
    return tgt.clone().index_add_(axis, idx, src)
def _segment_sum(src, seg, n):
    out = torch.zeros((n,) + src.shape[1:], dtype=src.dtype)
    return out.index_add_(0, seg, src)
def _pad(x, pw):
    flat = tuple(v for pair in reversed(pw) for v in pair)
    return torch.nn.functional.pad(x, flat)

kernel_name = 'sequential_preLN__mha_block__glu_gated_glu__prompt'

def setup_inputs():

    _w = (lambda a: (lambda t: t.to(torch.bfloat16) if t.is_floating_point() else t)(torch.as_tensor(a)))
    def _A_setup():
        B, S, D, H = 1, 2048, 1024, 32
        return {
            "x": _w((lambda *s: torch.randn(*s, dtype=torch.bfloat16) * 0.05)(B, S, D)),
            "wqkv": _w((lambda *s: torch.randn(*s, dtype=torch.bfloat16) * 0.05)(D, 3 * D)),
            "wo": _w((lambda *s: torch.randn(*s, dtype=torch.bfloat16) * 0.05)(D, D)),
        }
    _A_in = _A_setup()

    def _B_setup():
        B, S, D, F = 1, 2048, 1024, 3584
        return {
            "x": _w((lambda *s: torch.randn(*s, dtype=torch.bfloat16) * 0.05)(B, S, D)),
            "w_gate": _w((lambda *s: torch.randn(*s, dtype=torch.bfloat16) * 0.05)(D, F)),
            "w_up": _w((lambda *s: torch.randn(*s, dtype=torch.bfloat16) * 0.05)(D, F)),
            "w_down": _w((lambda *s: torch.randn(*s, dtype=torch.bfloat16) * 0.05)(F, D)),
        }
    _B_in = _B_setup()

    return {
        "A_x": _A_in["x"],
        "A_wqkv": _A_in["wqkv"],
        "A_wo": _A_in["wo"],
        "B_x": _B_in["x"],
        "B_w_gate": _B_in["w_gate"],
        "B_w_up": _B_in["w_up"],
        "B_w_down": _B_in["w_down"],
    }

def reference(A_x, A_wqkv, A_wo, B_x, B_w_gate, B_w_up, B_w_down):
    def _A_ref(x, wqkv, wo):
        B, S, D = x.shape
        H = 32
        Dh = D // H
        qkv = (lambda x, *d: x.permute(*d))((x @ wqkv).reshape(B, S, 3, H, Dh), 2, 0, 3, 1, 4)
        q, k, v = qkv[0], qkv[1], qkv[2]
        scores = torch.einsum("bhqd,bhkd->bhqk", q, k) * (Dh ** -0.5)
        p = _softmax(scores, axis=-1)
        o = torch.einsum("bhqk,bhkd->bhqd", p, v)
        return (lambda x, *d: x.permute(*d))(o, 0, 2, 1, 3).reshape(B, S, D) @ wo

    def _B_ref(x, w_gate, w_up, w_down):
        g = torch.einsum("bsd,df->bsf", x, w_gate)
        u = torch.einsum("bsd,df->bsf", x, w_up)
        h = _sigmoid(g) * u
        return torch.einsum("bsf,fd->bsd", h, w_down)

    x = A_x
    h = x + _A_ref(_layernorm(x, axis=-1), A_wqkv, A_wo)
    h2 = h + _B_ref(_layernorm(h, axis=-1), B_w_gate, B_w_up, B_w_down)
    return h2
```

```asm
; @launch grid=(256,1,1) block=(512,1,1) lds=163840
.amdgcn_target "amdgcn-amd-amdhsa--gfx950"
.text
.globl sequential_preLN__mha_block__glu_gated_glu__prompt_kernel
.p2align 8
.type sequential_preLN__mha_block__glu_gated_glu__prompt_kernel,@function
sequential_preLN__mha_block__glu_gated_glu__prompt_kernel:
    s_cmp_ge_u32 s2, 256
    s_cbranch_scc1 the_end
    s_load_dwordx4 s[40:43], s[0:1], 0
    s_load_dwordx4 s[4:7], s[0:1], 64
    s_memrealtime s[62:63]
    v_lshrrev_b32 v1, 6, v0
    s_nop 0
    v_readfirstlane_b32 s20, v1
    v_and_b32 v1, 63, v0
    v_lshrrev_b32 v2, 4, v1
    v_bfe_u32 v3, v1, 2, 2
    v_and_b32 v4, 3, v1
    v_and_b32 v5, 15, v1
    v_lshlrev_b32 v6, 4, v1
    s_and_b32 s21, s2, 1
    s_lshl_b32 s21, s21, 3
    s_bfe_u32 s28, s2, 0x30003
    s_add_u32 s21, s21, s28
    s_bfe_u32 s22, s2, 0x20001
    s_lshl_b32 s22, s22, 2
    s_lshr_b32 s28, s2, 6
    s_add_u32 s22, s22, s28
    s_and_b32 s31, s20, 3
    s_and_b32 s39, s21, 3
    s_mul_i32 s39, s39, 2
    s_cmp_ge_u32 s20, 4
    s_cbranch_scc1 p0_B
    v_and_b32 v7, 7, v1
    v_bfe_u32 v8, v1, 3, 2
    v_lshrrev_b32 v9, 5, v1
    v_lshlrev_b32 v10, 11, v7
    v_lshl_add_u32 v10, v9, 6, v10
    v_lshl_add_u32 v10, v8, 3, v10
    s_lshl_b32 s3, s2, 14
    s_lshl_b32 s28, s20, 9
    s_add_u32 s3, s3, s28
    s_waitcnt lgkmcnt(0)
    s_mov_b32 s8, s40
    s_mov_b32 s9, s41
    s_mov_b32 s10, 0x400000
    s_mov_b32 s11, 0x20000
    buffer_load_dwordx2 v[32:33], v10, s[8:11], s3 offen offset:0
    buffer_load_dwordx2 v[34:35], v10, s[8:11], s3 offen offset:32
    buffer_load_dwordx2 v[36:37], v10, s[8:11], s3 offen offset:128
    buffer_load_dwordx2 v[38:39], v10, s[8:11], s3 offen offset:160
    buffer_load_dwordx2 v[40:41], v10, s[8:11], s3 offen offset:256
    buffer_load_dwordx2 v[42:43], v10, s[8:11], s3 offen offset:288
    buffer_load_dwordx2 v[44:45], v10, s[8:11], s3 offen offset:384
    buffer_load_dwordx2 v[46:47], v10, s[8:11], s3 offen offset:416
    s_mov_b32 s16, s4
    s_mov_b32 s17, s5
    s_mov_b32 s18, 0x100
    s_mov_b32 s19, 0x20000
    s_or_b32 s28, s2, s20
    s_cmp_lg_u32 s28, 0
    s_cbranch_scc1 p0_nopub
    s_or_b32 s62, s62, 1
    v_mov_b32 v20, s62
    v_mov_b32 v21, s63
    v_mov_b32 v22, 0
    s_mov_b64 exec, 1
    buffer_store_dwordx2 v[20:21], v22, s[16:19], 0 offen sc1
    s_mov_b64 exec, -1
    s_waitcnt vmcnt(0)
p0_nopub:
    s_mov_b32 s12, s6
    s_mov_b32 s13, s7
    s_mov_b32 s14, 0x400000
    s_mov_b32 s15, 0x20000
    v_lshlrev_b32 v11, 17, v9
    v_lshl_add_u32 v11, v7, 4, v11
    v_lshl_add_u32 v11, v8, 8, v11
    s_lshr_b32 s32, s2, 1
    s_lshl_b32 s32, s32, 10
    s_and_b32 s33, s2, 1
    s_lshl_b32 s33, s33, 7
    s_add_u32 s32, s32, s33
    s_lshl_b32 s33, s20, 20
    s_add_u32 s32, s32, s33
    s_add_u32 s33, s32, 0x40000
    s_add_u32 s34, s32, 0x80000
    s_add_u32 s35, s32, 0xc0000
    v_mov_b32 v24, 0
    v_mov_b32 v25, 0
    s_waitcnt vmcnt(7)
    v_lshlrev_b32 v64, 16, v32
    v_and_b32 v65, 0xffff0000, v32
    v_add_f32 v24, v24, v64
    v_fmac_f32 v25, v64, v64
    v_add_f32 v24, v24, v65
    v_fmac_f32 v25, v65, v65
    v_lshlrev_b32 v66, 16, v33
    v_and_b32 v67, 0xffff0000, v33
    v_add_f32 v24, v24, v66
    v_fmac_f32 v25, v66, v66
    v_add_f32 v24, v24, v67
    v_fmac_f32 v25, v67, v67
    s_waitcnt vmcnt(6)
    v_lshlrev_b32 v68, 16, v34
    v_and_b32 v69, 0xffff0000, v34
    v_add_f32 v24, v24, v68
    v_fmac_f32 v25, v68, v68
    v_add_f32 v24, v24, v69
    v_fmac_f32 v25, v69, v69
    v_lshlrev_b32 v70, 16, v35
    v_and_b32 v71, 0xffff0000, v35
    v_add_f32 v24, v24, v70
    v_fmac_f32 v25, v70, v70
    v_add_f32 v24, v24, v71
    v_fmac_f32 v25, v71, v71
    s_waitcnt vmcnt(5)
    v_lshlrev_b32 v72, 16, v36
    v_and_b32 v73, 0xffff0000, v36
    v_add_f32 v24, v24, v72
    v_fmac_f32 v25, v72, v72
    v_add_f32 v24, v24, v73
    v_fmac_f32 v25, v73, v73
    v_lshlrev_b32 v74, 16, v37
    v_and_b32 v75, 0xffff0000, v37
    v_add_f32 v24, v24, v74
    v_fmac_f32 v25, v74, v74
    v_add_f32 v24, v24, v75
    v_fmac_f32 v25, v75, v75
    s_waitcnt vmcnt(4)
    v_lshlrev_b32 v76, 16, v38
    v_and_b32 v77, 0xffff0000, v38
    v_add_f32 v24, v24, v76
    v_fmac_f32 v25, v76, v76
    v_add_f32 v24, v24, v77
    v_fmac_f32 v25, v77, v77
    v_lshlrev_b32 v78, 16, v39
    v_and_b32 v79, 0xffff0000, v39
    v_add_f32 v24, v24, v78
    v_fmac_f32 v25, v78, v78
    v_add_f32 v24, v24, v79
    v_fmac_f32 v25, v79, v79
    s_waitcnt vmcnt(3)
    v_lshlrev_b32 v80, 16, v40
    v_and_b32 v81, 0xffff0000, v40
    v_add_f32 v24, v24, v80
    v_fmac_f32 v25, v80, v80
    v_add_f32 v24, v24, v81
    v_fmac_f32 v25, v81, v81
    v_lshlrev_b32 v82, 16, v41
    v_and_b32 v83, 0xffff0000, v41
    v_add_f32 v24, v24, v82
    v_fmac_f32 v25, v82, v82
    v_add_f32 v24, v24, v83
    v_fmac_f32 v25, v83, v83
    s_waitcnt vmcnt(2)
    v_lshlrev_b32 v84, 16, v42
    v_and_b32 v85, 0xffff0000, v42
    v_add_f32 v24, v24, v84
    v_fmac_f32 v25, v84, v84
    v_add_f32 v24, v24, v85
    v_fmac_f32 v25, v85, v85
    v_lshlrev_b32 v86, 16, v43
    v_and_b32 v87, 0xffff0000, v43
    v_add_f32 v24, v24, v86
    v_fmac_f32 v25, v86, v86
    v_add_f32 v24, v24, v87
    v_fmac_f32 v25, v87, v87
    s_waitcnt vmcnt(1)
    v_lshlrev_b32 v88, 16, v44
    v_and_b32 v89, 0xffff0000, v44
    v_add_f32 v24, v24, v88
    v_fmac_f32 v25, v88, v88
    v_add_f32 v24, v24, v89
    v_fmac_f32 v25, v89, v89
    v_lshlrev_b32 v90, 16, v45
    v_and_b32 v91, 0xffff0000, v45
    v_add_f32 v24, v24, v90
    v_fmac_f32 v25, v90, v90
    v_add_f32 v24, v24, v91
    v_fmac_f32 v25, v91, v91
    s_waitcnt vmcnt(0)
    v_lshlrev_b32 v92, 16, v46
    v_and_b32 v93, 0xffff0000, v46
    v_add_f32 v24, v24, v92
    v_fmac_f32 v25, v92, v92
    v_add_f32 v24, v24, v93
    v_fmac_f32 v25, v93, v93
    v_lshlrev_b32 v94, 16, v47
    v_and_b32 v95, 0xffff0000, v47
    v_add_f32 v24, v24, v94
    v_fmac_f32 v25, v94, v94
    v_add_f32 v24, v24, v95
    v_fmac_f32 v25, v95, v95
    v_mov_b32 v22, 0
    buffer_load_dwordx2 v[28:29], v22, s[16:19], 0 offen sc1
    v_add_f32_dpp v24, v24, v24 row_ror:8 row_mask:0xf bank_mask:0xf
    v_add_f32_dpp v25, v25, v25 row_ror:8 row_mask:0xf bank_mask:0xf
    v_mov_b32 v26, v24
    v_mov_b32 v27, v25
    s_nop 1
    v_permlane16_swap_b32 v26, v24
    v_permlane16_swap_b32 v27, v25
    s_nop 1
    v_add_f32 v24, v24, v26
    v_add_f32 v25, v25, v27
    v_mov_b32 v26, v24
    v_mov_b32 v27, v25
    s_nop 1
    v_permlane32_swap_b32 v26, v24
    v_permlane32_swap_b32 v27, v25
    s_nop 1
    v_add_f32 v24, v24, v26
    v_add_f32 v25, v25, v27
    v_lshlrev_b32 v26, 5, v7
    s_lshl_b32 s28, s20, 3
    v_add_u32 v27, s28, v26
    ds_write_b64 v27, v[24:25]
    s_waitcnt lgkmcnt(0)
    s_barrier
    ds_read_b128 v[100:103], v26
    ds_read_b128 v[104:107], v26 offset:16
    s_waitcnt lgkmcnt(0)
    v_pk_add_f32 v[24:25], v[100:101], v[102:103]
    v_pk_add_f32 v[26:27], v[104:105], v[106:107]
    v_pk_add_f32 v[24:25], v[24:25], v[26:27]
    v_mul_f32 v24, 0x3a800000, v24
    v_mul_f32 v25, 0x3a800000, v25
    v_fma_f32 v25, -v24, v24, v25
    v_max_f32 v25, 0, v25
    v_add_f32 v25, 0x3727c5ac, v25
    v_rsq_f32 v25, v25
    s_nop 0
    v_mul_f32 v24, v24, v25
    v_fma_f32 v64, v64, v25, -v24
    v_fma_f32 v65, v65, v25, -v24
    v_cvt_pk_bf16_f32 v32, v64, v65
    v_fma_f32 v66, v66, v25, -v24
    v_fma_f32 v67, v67, v25, -v24
    v_cvt_pk_bf16_f32 v33, v66, v67
    v_fma_f32 v68, v68, v25, -v24
    v_fma_f32 v69, v69, v25, -v24
    v_cvt_pk_bf16_f32 v34, v68, v69
    v_fma_f32 v70, v70, v25, -v24
    v_fma_f32 v71, v71, v25, -v24
    v_cvt_pk_bf16_f32 v35, v70, v71
    buffer_store_dwordx4 v[32:35], v11, s[12:15], s32 offen sc1
    v_fma_f32 v72, v72, v25, -v24
    v_fma_f32 v73, v73, v25, -v24
    v_cvt_pk_bf16_f32 v36, v72, v73
    v_fma_f32 v74, v74, v25, -v24
    v_fma_f32 v75, v75, v25, -v24
    v_cvt_pk_bf16_f32 v37, v74, v75
    v_fma_f32 v76, v76, v25, -v24
    v_fma_f32 v77, v77, v25, -v24
    v_cvt_pk_bf16_f32 v38, v76, v77
    v_fma_f32 v78, v78, v25, -v24
    v_fma_f32 v79, v79, v25, -v24
    v_cvt_pk_bf16_f32 v39, v78, v79
    buffer_store_dwordx4 v[36:39], v11, s[12:15], s33 offen sc1
    v_fma_f32 v80, v80, v25, -v24
    v_fma_f32 v81, v81, v25, -v24
    v_cvt_pk_bf16_f32 v40, v80, v81
    v_fma_f32 v82, v82, v25, -v24
    v_fma_f32 v83, v83, v25, -v24
    v_cvt_pk_bf16_f32 v41, v82, v83
    v_fma_f32 v84, v84, v25, -v24
    v_fma_f32 v85, v85, v25, -v24
    v_cvt_pk_bf16_f32 v42, v84, v85
    v_fma_f32 v86, v86, v25, -v24
    v_fma_f32 v87, v87, v25, -v24
    v_cvt_pk_bf16_f32 v43, v86, v87
    buffer_store_dwordx4 v[40:43], v11, s[12:15], s34 offen sc1
    v_fma_f32 v88, v88, v25, -v24
    v_fma_f32 v89, v89, v25, -v24
    v_cvt_pk_bf16_f32 v44, v88, v89
    v_fma_f32 v90, v90, v25, -v24
    v_fma_f32 v91, v91, v25, -v24
    v_cvt_pk_bf16_f32 v45, v90, v91
    v_fma_f32 v92, v92, v25, -v24
    v_fma_f32 v93, v93, v25, -v24
    v_cvt_pk_bf16_f32 v46, v92, v93
    v_fma_f32 v94, v94, v25, -v24
    v_fma_f32 v95, v95, v25, -v24
    v_cvt_pk_bf16_f32 v47, v94, v95
    buffer_store_dwordx4 v[44:47], v11, s[12:15], s35 offen sc1
    s_lshr_b32 s32, s2, 4
    s_and_b32 s33, s2, 15
    s_lshl_b32 s3, s32, 8
    s_lshl_b32 s28, s33, 3
    s_add_u32 s3, s3, s28
    s_add_u32 s3, s3, 0
    v_mov_b32 v250, s3
    s_mov_b32 s28, 262144
p0_nonce:
    s_waitcnt vmcnt(0)
    v_readfirstlane_b32 s62, v28
    v_readfirstlane_b32 s63, v29
    s_nop 1
    s_cmp_lg_u32 s62, 0
    s_cbranch_scc1 p0_gotnonce
    buffer_load_dwordx2 v[28:29], v22, s[16:19], 0 offen sc1
    s_sub_u32 s28, s28, 1
    s_cmp_lg_u32 s28, 0
    s_cbranch_scc1 p0_nonce
p0_gotnonce:
    v_mov_b32 v248, s62
    v_mov_b32 v249, s63
    s_add_u32 s56, s6, 0x1a00000
    s_addc_u32 s57, s7, 0
    s_mov_b32 s58, 0x6000
    s_mov_b32 s59, 0x20000
    s_barrier
    s_cmp_lg_u32 s20, 0
    s_cbranch_scc1 pub_skip_1
    s_mov_b64 exec, 1
    buffer_store_dwordx2 v[248:249], v250, s[56:59], 0 offen sc1
    s_mov_b64 exec, -1
pub_skip_1:
    v_mov_b32 v12, 0
    s_lshr_b32 s28, s31, 1
    s_lshl_b32 s28, s28, 7
    s_lshl_b32 s29, s21, 3
    s_add_u32 s28, s28, s29
    s_and_b32 s29, s31, 1
    s_lshl_b32 s29, s29, 2
    s_add_u32 s28, s28, s29
    s_lshl_b32 s25, s28, 10
    s_mov_b32 s37, s25
    s_mov_b32 s38, -1
    s_add_u32 s38, s38, 1
    s_add_u32 s3, s38, s39
    s_and_b32 s3, s3, 7
    s_andn2_b32 s25, s38, 7
    s_or_b32 s3, s3, s25
    s_mul_i32 s3, s3, 0x40000
    s_add_u32 s25, s3, s37
    s_lshl_b32 s30, s31, 12
    s_branch p1_common
p0_B:
    v_lshrrev_b32 v7, 3, v1
    v_mul_u32_u24 v7, 6144, v7
    v_and_b32 v20, 7, v1
    v_lshlrev_b32 v21, 1, v2
    v_xor_b32 v20, v20, v21
    v_lshl_add_u32 v7, v20, 4, v7
    v_add_u32 v8, 48128, v7
    v_add_u32 v9, 2048, v7
    v_add_u32 v10, 2048, v8
    v_add_u32 v11, 4096, v7
    v_add_u32 v12, 4096, v8
    s_mul_i32 s28, s31, 98304
    s_lshl_b32 s29, s22, 7
    s_add_u32 s25, s28, s29
    s_mov_b32 s37, s25
    s_mov_b32 s38, -1
    s_add_u32 s38, s38, 1
    s_add_u32 s3, s38, s39
    s_and_b32 s3, s3, 7
    s_andn2_b32 s25, s38, 7
    s_or_b32 s3, s3, s25
    s_mul_i32 s3, s3, 0x60000
    s_add_u32 s25, s3, s37
    s_lshl_b32 s30, s31, 11
    s_add_u32 s30, s30, 16384
    v_and_b32 v13, 31, v1
    v_mul_u32_u24 v13, 6144, v13
    v_lshrrev_b32 v14, 5, v1
    v_lshl_add_u32 v15, v14, 11, v13
    v_lshl_add_u32 v13, v14, 30, v13
    v_add_u32 v13, 4096, v13
    s_and_b32 s28, s21, 7
    s_lshl_b32 s28, s28, 2
    s_add_u32 s28, s28, s31
    s_mul_i32 s28, s28, 196608
    s_add_u32 s28, s28, s29
    s_waitcnt lgkmcnt(0)
    s_mov_b32 s12, s42
    s_mov_b32 s13, s43
    s_mov_b32 s14, 0x600000
    s_mov_b32 s15, 0x20000
    v_lshlrev_b32 v15, 7, v1
    v_cmp_gt_u32 vcc, 48, v1
    v_mov_b32 v13, 0x7fffffff
    s_lshl_b32 s28, s2, 2
    s_add_u32 s28, s28, s31
    v_cndmask_b32 v15, v13, v15, vcc
    s_mul_i32 s28, s28, 6144
    buffer_load_dword v24, v15, s[12:15], s28 offen
    s_mov_b32 s24, 0
    s_add_u32 m0, s24, s30
    s_nop 0
    buffer_load_dwordx4 v7, s[12:15], s25 offen lds
    buffer_load_dwordx4 v8, s[12:15], s25 offen offset:1024 lds
    s_add_u32 m0, m0, 8192
    s_nop 0
    buffer_load_dwordx4 v9, s[12:15], s25 offen lds
    buffer_load_dwordx4 v10, s[12:15], s25 offen offset:1024 lds
    s_add_u32 m0, m0, 8192
    s_nop 0
    buffer_load_dwordx4 v11, s[12:15], s25 offen lds
    buffer_load_dwordx4 v12, s[12:15], s25 offen offset:1024 lds
    s_add_u32 s38, s38, 1
    s_add_u32 s3, s38, s39
    s_and_b32 s3, s3, 7
    s_andn2_b32 s25, s38, 7
    s_or_b32 s3, s3, s25
    s_mul_i32 s3, s3, 0x60000
    s_add_u32 s25, s3, s37
    s_mov_b32 s24, 40960
    s_add_u32 m0, s24, s30
    s_nop 0
    buffer_load_dwordx4 v7, s[12:15], s25 offen lds
    buffer_load_dwordx4 v8, s[12:15], s25 offen offset:1024 lds
    s_add_u32 m0, m0, 8192
    s_nop 0
    buffer_load_dwordx4 v9, s[12:15], s25 offen lds
    buffer_load_dwordx4 v10, s[12:15], s25 offen offset:1024 lds
    s_add_u32 m0, m0, 8192
    s_nop 0
    buffer_load_dwordx4 v11, s[12:15], s25 offen lds
    buffer_load_dwordx4 v12, s[12:15], s25 offen offset:1024 lds
    s_add_u32 s38, s38, 1
    s_add_u32 s3, s38, s39
    s_and_b32 s3, s3, 7
    s_andn2_b32 s25, s38, 7
    s_or_b32 s3, s3, s25
    s_mul_i32 s3, s3, 0x60000
    s_add_u32 s25, s3, s37
    s_barrier
    s_barrier
    s_mov_b32 s24, 81920
    s_add_u32 m0, s24, s30
    s_nop 0
    buffer_load_dwordx4 v7, s[12:15], s25 offen lds
    buffer_load_dwordx4 v8, s[12:15], s25 offen offset:1024 lds
    s_add_u32 m0, m0, 8192
    s_nop 0
    buffer_load_dwordx4 v9, s[12:15], s25 offen lds
    buffer_load_dwordx4 v10, s[12:15], s25 offen offset:1024 lds
    s_add_u32 m0, m0, 8192
    s_nop 0
    buffer_load_dwordx4 v11, s[12:15], s25 offen lds
    buffer_load_dwordx4 v12, s[12:15], s25 offen offset:1024 lds
    s_add_u32 s38, s38, 1
    s_add_u32 s3, s38, s39
    s_and_b32 s3, s3, 7
    s_andn2_b32 s25, s38, 7
    s_or_b32 s3, s3, s25
    s_mul_i32 s3, s3, 0x60000
    s_add_u32 s25, s3, s37
    s_mov_b32 s24, 122880
    s_add_u32 m0, s24, s30
    s_nop 0
    buffer_load_dwordx4 v7, s[12:15], s25 offen lds
    buffer_load_dwordx4 v8, s[12:15], s25 offen offset:1024 lds
    s_add_u32 m0, m0, 8192
    s_nop 0
    buffer_load_dwordx4 v9, s[12:15], s25 offen lds
    buffer_load_dwordx4 v10, s[12:15], s25 offen offset:1024 lds
    s_add_u32 m0, m0, 8192
    s_nop 0
    buffer_load_dwordx4 v11, s[12:15], s25 offen lds
    buffer_load_dwordx4 v12, s[12:15], s25 offen offset:1024 lds
    s_add_u32 s38, s38, 1
    s_add_u32 s3, s38, s39
    s_and_b32 s3, s3, 7
    s_andn2_b32 s25, s38, 7
    s_or_b32 s3, s3, s25
    s_mul_i32 s3, s3, 0x60000
    s_add_u32 s25, s3, s37
p1_common:
    s_mov_b32 s8, s6
    s_mov_b32 s9, s7
    s_mov_b32 s10, 0x400000
    s_mov_b32 s11, 0x20000
    s_mov_b32 s12, s42
    s_mov_b32 s13, s43
    s_mov_b32 s14, 0x600000
    s_mov_b32 s15, 0x20000
    s_add_u32 s16, s6, 0x400000
    s_addc_u32 s17, s7, 0
    s_mov_b32 s18, 0xc00000
    s_mov_b32 s19, 0x20000
    s_and_b32 s28, s20, 1
    s_lshl_b32 s28, s28, 12
    v_add_u32 v32, s28, v6
    v_lshl_add_u32 v33, v2, 2, v3
    v_lshlrev_b32 v33, 7, v33
    v_lshl_add_u32 v33, v4, 3, v33
    v_add_u32 v33, 16384, v33
    v_bfe_u32 v34, v1, 3, 2
    s_lshr_b32 s28, s20, 1
    s_and_b32 s29, s28, 1
    s_lshl_b32 s29, s29, 1
    s_lshr_b32 s32, s28, 1
    s_lshl_b32 s32, s32, 13
    v_xor_b32 v35, s29, v34
    v_lshl_add_u32 v35, v35, 5, v33
    v_add_u32 v35, s32, v35
    v_xor_b32 v36, 32, v35
    v_xor_b32 v37, s28, v34
    v_lshl_add_u32 v37, v37, 5, v33
    v_add_u32 v37, 16384, v37
    v_mov_b32 v64, 0
    v_mov_b32 v65, 0
    v_mov_b32 v66, 0
    v_mov_b32 v67, 0
    v_mov_b32 v68, 0
    v_mov_b32 v69, 0
    v_mov_b32 v70, 0
    v_mov_b32 v71, 0
    v_mov_b32 v72, 0
    v_mov_b32 v73, 0
    v_mov_b32 v74, 0
    v_mov_b32 v75, 0
    v_mov_b32 v76, 0
    v_mov_b32 v77, 0
    v_mov_b32 v78, 0
    v_mov_b32 v79, 0
    v_mov_b32 v80, 0
    v_mov_b32 v81, 0
    v_mov_b32 v82, 0
    v_mov_b32 v83, 0
    v_mov_b32 v84, 0
    v_mov_b32 v85, 0
    v_mov_b32 v86, 0
    v_mov_b32 v87, 0
    v_mov_b32 v88, 0
    v_mov_b32 v89, 0
    v_mov_b32 v90, 0
    v_mov_b32 v91, 0
    v_mov_b32 v92, 0
    v_mov_b32 v93, 0
    v_mov_b32 v94, 0
    v_mov_b32 v95, 0
    v_mov_b32 v96, 0
    v_mov_b32 v97, 0
    v_mov_b32 v98, 0
    v_mov_b32 v99, 0
    v_mov_b32 v100, 0
    v_mov_b32 v101, 0
    v_mov_b32 v102, 0
    v_mov_b32 v103, 0
    v_mov_b32 v104, 0
    v_mov_b32 v105, 0
    v_mov_b32 v106, 0
    v_mov_b32 v107, 0
    v_mov_b32 v108, 0
    v_mov_b32 v109, 0
    v_mov_b32 v110, 0
    v_mov_b32 v111, 0
    s_cmp_lg_u32 s20, 0
    s_cbranch_scc1 wf_skip_2
    s_add_u32 s56, s6, 0x1a00000
    s_addc_u32 s57, s7, 0
    s_mov_b32 s58, 0x6000
    s_mov_b32 s59, 0x20000
    s_lshl_b32 s3, s21, 8
    s_add_u32 s3, s3, 0
    v_and_b32 v22, 15, v0
    v_lshlrev_b32 v22, 3, v22
    v_lshlrev_b32 v23, 3, v0
    s_mov_b32 s28, 262144
    buffer_load_dwordx2 v[252:253], v22, s[56:59], s3 offen sc1
wf_loop_3:
    s_waitcnt vmcnt(0)
    v_cmp_ne_u64 vcc, s[62:63], v[252:253]
    s_nop 1
    s_cmp_eq_u64 vcc, 0
    s_cbranch_scc1 wf_skip_2
    s_sleep 1
    buffer_load_dwordx2 v[252:253], v22, s[56:59], s3 offen sc1
    s_sub_u32 s28, s28, 1
    s_cmp_lg_u32 s28, 0
    s_cbranch_scc1 wf_loop_3
wf_skip_2:
    s_barrier
    s_cmp_ge_u32 s20, 4
    s_cbranch_scc1 qkv_B
    s_mov_b32 s24, 0
    s_add_u32 m0, s24, s30
    s_nop 0
    buffer_load_dwordx4 v6, s[8:11], s25 offen sc1 lds
    buffer_load_dwordx4 v6, s[8:11], s25 offen offset:1024 sc1 lds
    buffer_load_dwordx4 v6, s[8:11], s25 offen offset:2048 sc1 lds
    buffer_load_dwordx4 v6, s[8:11], s25 offen offset:3072 sc1 lds
    s_add_u32 s38, s38, 1
    s_add_u32 s3, s38, s39
    s_and_b32 s3, s3, 7
    s_andn2_b32 s25, s38, 7
    s_or_b32 s3, s3, s25
    s_mul_i32 s3, s3, 0x40000
    s_add_u32 s25, s3, s37
    s_barrier
    s_mov_b32 s24, 40960
    s_add_u32 m0, s24, s30
    s_nop 0
    buffer_load_dwordx4 v6, s[8:11], s25 offen sc1 lds
    buffer_load_dwordx4 v6, s[8:11], s25 offen offset:1024 sc1 lds
    buffer_load_dwordx4 v6, s[8:11], s25 offen offset:2048 sc1 lds
    buffer_load_dwordx4 v6, s[8:11], s25 offen offset:3072 sc1 lds
    s_add_u32 s38, s38, 1
    s_add_u32 s3, s38, s39
    s_and_b32 s3, s3, 7
    s_andn2_b32 s25, s38, 7
    s_or_b32 s3, s3, s25
    s_mul_i32 s3, s3, 0x40000
    s_add_u32 s25, s3, s37
    s_barrier
    s_mov_b32 s24, 81920
    s_add_u32 m0, s24, s30
    s_nop 0
    buffer_load_dwordx4 v6, s[8:11], s25 offen sc1 lds
    buffer_load_dwordx4 v6, s[8:11], s25 offen offset:1024 sc1 lds
    buffer_load_dwordx4 v6, s[8:11], s25 offen offset:2048 sc1 lds
    buffer_load_dwordx4 v6, s[8:11], s25 offen offset:3072 sc1 lds
    s_add_u32 s38, s38, 1
    s_add_u32 s3, s38, s39
    s_and_b32 s3, s3, 7
    s_andn2_b32 s25, s38, 7
    s_or_b32 s3, s3, s25
    s_mul_i32 s3, s3, 0x40000
    s_add_u32 s25, s3, s37
    s_barrier
    s_mov_b32 s24, 122880
    s_add_u32 m0, s24, s30
    s_nop 0
    buffer_load_dwordx4 v6, s[8:11], s25 offen sc1 lds
    buffer_load_dwordx4 v6, s[8:11], s25 offen offset:1024 sc1 lds
    buffer_load_dwordx4 v6, s[8:11], s25 offen offset:2048 sc1 lds
    buffer_load_dwordx4 v6, s[8:11], s25 offen offset:3072 sc1 lds
    s_add_u32 s38, s38, 1
    s_add_u32 s3, s38, s39
    s_and_b32 s3, s3, 7
    s_andn2_b32 s25, s38, 7
    s_or_b32 s3, s3, s25
    s_mul_i32 s3, s3, 0x40000
    s_add_u32 s25, s3, s37
    s_mov_b32 s23, 0
    v_add_u32 v16, s23, v32
    v_add_u32 v17, s23, v35
    v_add_u32 v18, s23, v36
    v_add_u32 v19, s23, v37
    s_waitcnt vmcnt(12)
    s_barrier
    ds_read_b64_tr_b16 v[144:145], v17 offset:0
    ds_read_b64_tr_b16 v[146:147], v17 offset:2048
    ds_read_b64_tr_b16 v[148:149], v18 offset:0
    ds_read_b64_tr_b16 v[150:151], v18 offset:2048
    ds_read_b64_tr_b16 v[152:153], v19 offset:0
    ds_read_b64_tr_b16 v[154:155], v19 offset:2048
    ds_read_b128 v[112:115], v16 offset:0
    ds_read_b128 v[116:119], v16 offset:1024
    ds_read_b128 v[120:123], v16 offset:2048
    ds_read_b128 v[124:127], v16 offset:3072
    ds_read_b64_tr_b16 v[156:157], v17 offset:4096
    ds_read_b64_tr_b16 v[158:159], v17 offset:6144
    ds_read_b64_tr_b16 v[160:161], v18 offset:4096
    ds_read_b64_tr_b16 v[162:163], v18 offset:6144
    ds_read_b64_tr_b16 v[164:165], v19 offset:4096
    ds_read_b64_tr_b16 v[166:167], v19 offset:6144
    ds_read_b128 v[128:131], v16 offset:8192
    ds_read_b128 v[132:135], v16 offset:9216
    ds_read_b128 v[136:139], v16 offset:10240
    ds_read_b128 v[140:143], v16 offset:11264
    s_mov_b32 s24, s23
    s_add_u32 s23, s23, 40960
    s_cmp_eq_u32 s23, 163840
    s_cselect_b32 s23, 0, s23
    v_add_u32 v16, s23, v32
    v_add_u32 v17, s23, v35
    v_add_u32 v18, s23, v36
    v_add_u32 v19, s23, v37
    s_mov_b32 s27, 6
.p2align 6
qkv_loopA:
    s_waitcnt vmcnt(8) lgkmcnt(0)
    s_barrier
    v_mfma_f32_16x16x32_bf16 v[64:67], v[144:147], v[112:115], v[64:67]
    ds_read_b64_tr_b16 v[200:201], v17 offset:0
    v_mfma_f32_16x16x32_bf16 v[68:71], v[144:147], v[116:119], v[68:71]
    ds_read_b64_tr_b16 v[202:203], v17 offset:2048
    v_mfma_f32_16x16x32_bf16 v[72:75], v[144:147], v[120:123], v[72:75]
    ds_read_b64_tr_b16 v[204:205], v18 offset:0
    v_mfma_f32_16x16x32_bf16 v[76:79], v[144:147], v[124:127], v[76:79]
    ds_read_b64_tr_b16 v[206:207], v18 offset:2048
    v_mfma_f32_16x16x32_bf16 v[92:95], v[148:151], v[124:127], v[92:95]
    ds_read_b64_tr_b16 v[208:209], v19 offset:0
    v_mfma_f32_16x16x32_bf16 v[88:91], v[148:151], v[120:123], v[88:91]
    ds_read_b64_tr_b16 v[210:211], v19 offset:2048
    v_mfma_f32_16x16x32_bf16 v[84:87], v[148:151], v[116:119], v[84:87]
    ds_read_b128 v[168:171], v16 offset:0
    v_mfma_f32_16x16x32_bf16 v[80:83], v[148:151], v[112:115], v[80:83]
    ds_read_b128 v[172:175], v16 offset:1024
    v_mfma_f32_16x16x32_bf16 v[96:99], v[112:115], v[152:155], v[96:99]
    ds_read_b128 v[176:179], v16 offset:2048
    v_mfma_f32_16x16x32_bf16 v[100:103], v[116:119], v[152:155], v[100:103]
    ds_read_b128 v[180:183], v16 offset:3072
    v_mfma_f32_16x16x32_bf16 v[104:107], v[120:123], v[152:155], v[104:107]
    v_mfma_f32_16x16x32_bf16 v[108:111], v[124:127], v[152:155], v[108:111]
    ds_read_b64_tr_b16 v[212:213], v17 offset:4096
    v_mfma_f32_16x16x32_bf16 v[64:67], v[156:159], v[128:131], v[64:67]
    ds_read_b64_tr_b16 v[214:215], v17 offset:6144
    v_mfma_f32_16x16x32_bf16 v[68:71], v[156:159], v[132:135], v[68:71]
    ds_read_b64_tr_b16 v[216:217], v18 offset:4096
    v_mfma_f32_16x16x32_bf16 v[72:75], v[156:159], v[136:139], v[72:75]
    ds_read_b64_tr_b16 v[218:219], v18 offset:6144
    v_mfma_f32_16x16x32_bf16 v[76:79], v[156:159], v[140:143], v[76:79]
    ds_read_b64_tr_b16 v[220:221], v19 offset:4096
    v_mfma_f32_16x16x32_bf16 v[92:95], v[160:163], v[140:143], v[92:95]
    ds_read_b64_tr_b16 v[222:223], v19 offset:6144
    v_mfma_f32_16x16x32_bf16 v[88:91], v[160:163], v[136:139], v[88:91]
    ds_read_b128 v[184:187], v16 offset:8192
    v_mfma_f32_16x16x32_bf16 v[84:87], v[160:163], v[132:135], v[84:87]
    ds_read_b128 v[188:191], v16 offset:9216
    v_mfma_f32_16x16x32_bf16 v[80:83], v[160:163], v[128:131], v[80:83]
    ds_read_b128 v[192:195], v16 offset:10240
    v_mfma_f32_16x16x32_bf16 v[96:99], v[128:131], v[164:167], v[96:99]
    ds_read_b128 v[196:199], v16 offset:11264
    v_mfma_f32_16x16x32_bf16 v[100:103], v[132:135], v[164:167], v[100:103]
    v_mfma_f32_16x16x32_bf16 v[104:107], v[136:139], v[164:167], v[104:107]
    v_mfma_f32_16x16x32_bf16 v[108:111], v[140:143], v[164:167], v[108:111]
    s_add_u32 m0, s24, s30
    s_mov_b32 s24, s23
    s_add_u32 s23, s23, 40960
    s_cmp_eq_u32 s23, 163840
    s_cselect_b32 s23, 0, s23
    v_add_u32 v16, s23, v32
    v_add_u32 v17, s23, v35
    v_add_u32 v18, s23, v36
    v_add_u32 v19, s23, v37
    buffer_load_dwordx4 v6, s[8:11], s25 offen sc1 lds
    buffer_load_dwordx4 v6, s[8:11], s25 offen offset:1024 sc1 lds
    buffer_load_dwordx4 v6, s[8:11], s25 offen offset:2048 sc1 lds
    buffer_load_dwordx4 v6, s[8:11], s25 offen offset:3072 sc1 lds
    s_add_u32 s38, s38, 1
    s_add_u32 s3, s38, s39
    s_and_b32 s3, s3, 7
    s_andn2_b32 s25, s38, 7
    s_or_b32 s3, s3, s25
    s_mul_i32 s3, s3, 0x40000
    s_add_u32 s25, s3, s37
    s_waitcnt vmcnt(8) lgkmcnt(0)
    s_barrier
    v_mfma_f32_16x16x32_bf16 v[64:67], v[200:203], v[168:171], v[64:67]
    ds_read_b64_tr_b16 v[144:145], v17 offset:0
    v_mfma_f32_16x16x32_bf16 v[68:71], v[200:203], v[172:175], v[68:71]
    ds_read_b64_tr_b16 v[146:147], v17 offset:2048
    v_mfma_f32_16x16x32_bf16 v[72:75], v[200:203], v[176:179], v[72:75]
    ds_read_b64_tr_b16 v[148:149], v18 offset:0
    v_mfma_f32_16x16x32_bf16 v[76:79], v[200:203], v[180:183], v[76:79]
    ds_read_b64_tr_b16 v[150:151], v18 offset:2048
    v_mfma_f32_16x16x32_bf16 v[92:95], v[204:207], v[180:183], v[92:95]
    ds_read_b64_tr_b16 v[152:153], v19 offset:0
    v_mfma_f32_16x16x32_bf16 v[88:91], v[204:207], v[176:179], v[88:91]
    ds_read_b64_tr_b16 v[154:155], v19 offset:2048
    v_mfma_f32_16x16x32_bf16 v[84:87], v[204:207], v[172:175], v[84:87]
    ds_read_b128 v[112:115], v16 offset:0
    v_mfma_f32_16x16x32_bf16 v[80:83], v[204:207], v[168:171], v[80:83]
    ds_read_b128 v[116:119], v16 offset:1024
    v_mfma_f32_16x16x32_bf16 v[96:99], v[168:171], v[208:211], v[96:99]
    ds_read_b128 v[120:123], v16 offset:2048
    v_mfma_f32_16x16x32_bf16 v[100:103], v[172:175], v[208:211], v[100:103]
    ds_read_b128 v[124:127], v16 offset:3072
    v_mfma_f32_16x16x32_bf16 v[104:107], v[176:179], v[208:211], v[104:107]
    v_mfma_f32_16x16x32_bf16 v[108:111], v[180:183], v[208:211], v[108:111]
    ds_read_b64_tr_b16 v[156:157], v17 offset:4096
    v_mfma_f32_16x16x32_bf16 v[64:67], v[212:215], v[184:187], v[64:67]
    ds_read_b64_tr_b16 v[158:159], v17 offset:6144
    v_mfma_f32_16x16x32_bf16 v[68:71], v[212:215], v[188:191], v[68:71]
    ds_read_b64_tr_b16 v[160:161], v18 offset:4096
    v_mfma_f32_16x16x32_bf16 v[72:75], v[212:215], v[192:195], v[72:75]
    ds_read_b64_tr_b16 v[162:163], v18 offset:6144
    v_mfma_f32_16x16x32_bf16 v[76:79], v[212:215], v[196:199], v[76:79]
    ds_read_b64_tr_b16 v[164:165], v19 offset:4096
    v_mfma_f32_16x16x32_bf16 v[92:95], v[216:219], v[196:199], v[92:95]
    ds_read_b64_tr_b16 v[166:167], v19 offset:6144
    v_mfma_f32_16x16x32_bf16 v[88:91], v[216:219], v[192:195], v[88:91]
    ds_read_b128 v[128:131], v16 offset:8192
    v_mfma_f32_16x16x32_bf16 v[84:87], v[216:219], v[188:191], v[84:87]
    ds_read_b128 v[132:135], v16 offset:9216
    v_mfma_f32_16x16x32_bf16 v[80:83], v[216:219], v[184:187], v[80:83]
    ds_read_b128 v[136:139], v16 offset:10240
    v_mfma_f32_16x16x32_bf16 v[96:99], v[184:187], v[220:223], v[96:99]
    ds_read_b128 v[140:143], v16 offset:11264
    v_mfma_f32_16x16x32_bf16 v[100:103], v[188:191], v[220:223], v[100:103]
    v_mfma_f32_16x16x32_bf16 v[104:107], v[192:195], v[220:223], v[104:107]
    v_mfma_f32_16x16x32_bf16 v[108:111], v[196:199], v[220:223], v[108:111]
    s_add_u32 m0, s24, s30
    s_mov_b32 s24, s23
    s_add_u32 s23, s23, 40960
    s_cmp_eq_u32 s23, 163840
    s_cselect_b32 s23, 0, s23
    v_add_u32 v16, s23, v32
    v_add_u32 v17, s23, v35
    v_add_u32 v18, s23, v36
    v_add_u32 v19, s23, v37
    buffer_load_dwordx4 v6, s[8:11], s25 offen sc1 lds
    buffer_load_dwordx4 v6, s[8:11], s25 offen offset:1024 sc1 lds
    buffer_load_dwordx4 v6, s[8:11], s25 offen offset:2048 sc1 lds
    buffer_load_dwordx4 v6, s[8:11], s25 offen offset:3072 sc1 lds
    s_add_u32 s38, s38, 1
    s_add_u32 s3, s38, s39
    s_and_b32 s3, s3, 7
    s_andn2_b32 s25, s38, 7
    s_or_b32 s3, s3, s25
    s_mul_i32 s3, s3, 0x40000
    s_add_u32 s25, s3, s37
    s_sub_u32 s27, s27, 1
    s_cmp_lg_u32 s27, 0
    s_cbranch_scc1 qkv_loopA
    s_waitcnt vmcnt(8) lgkmcnt(0)
    s_barrier
    v_mfma_f32_16x16x32_bf16 v[64:67], v[144:147], v[112:115], v[64:67]
    ds_read_b64_tr_b16 v[200:201], v17 offset:0
    ds_read_b64_tr_b16 v[202:203], v17 offset:2048
    v_mfma_f32_16x16x32_bf16 v[68:71], v[144:147], v[116:119], v[68:71]
    ds_read_b64_tr_b16 v[204:205], v18 offset:0
    v_mfma_f32_16x16x32_bf16 v[72:75], v[144:147], v[120:123], v[72:75]
    ds_read_b64_tr_b16 v[206:207], v18 offset:2048
    v_mfma_f32_16x16x32_bf16 v[76:79], v[144:147], v[124:127], v[76:79]
    ds_read_b64_tr_b16 v[208:209], v19 offset:0
    v_mfma_f32_16x16x32_bf16 v[92:95], v[148:151], v[124:127], v[92:95]
    ds_read_b64_tr_b16 v[210:211], v19 offset:2048
    ds_read_b128 v[168:171], v16 offset:0
    v_mfma_f32_16x16x32_bf16 v[88:91], v[148:151], v[120:123], v[88:91]
    ds_read_b128 v[172:175], v16 offset:1024
    v_mfma_f32_16x16x32_bf16 v[84:87], v[148:151], v[116:119], v[84:87]
    ds_read_b128 v[176:179], v16 offset:2048
    v_mfma_f32_16x16x32_bf16 v[80:83], v[148:151], v[112:115], v[80:83]
    ds_read_b128 v[180:183], v16 offset:3072
    v_mfma_f32_16x16x32_bf16 v[96:99], v[112:115], v[152:155], v[96:99]
    ds_read_b64_tr_b16 v[212:213], v17 offset:4096
    ds_read_b64_tr_b16 v[214:215], v17 offset:6144
    v_mfma_f32_16x16x32_bf16 v[100:103], v[116:119], v[152:155], v[100:103]
    ds_read_b64_tr_b16 v[216:217], v18 offset:4096
    v_mfma_f32_16x16x32_bf16 v[104:107], v[120:123], v[152:155], v[104:107]
    ds_read_b64_tr_b16 v[218:219], v18 offset:6144
    v_mfma_f32_16x16x32_bf16 v[108:111], v[124:127], v[152:155], v[108:111]
    ds_read_b64_tr_b16 v[220:221], v19 offset:4096
    v_mfma_f32_16x16x32_bf16 v[64:67], v[156:159], v[128:131], v[64:67]
    ds_read_b64_tr_b16 v[222:223], v19 offset:6144
    ds_read_b128 v[184:187], v16 offset:8192
    v_mfma_f32_16x16x32_bf16 v[68:71], v[156:159], v[132:135], v[68:71]
    ds_read_b128 v[188:191], v16 offset:9216
    v_mfma_f32_16x16x32_bf16 v[72:75], v[156:159], v[136:139], v[72:75]
    ds_read_b128 v[192:195], v16 offset:10240
    v_mfma_f32_16x16x32_bf16 v[76:79], v[156:159], v[140:143], v[76:79]
    ds_read_b128 v[196:199], v16 offset:11264
    v_mfma_f32_16x16x32_bf16 v[92:95], v[160:163], v[140:143], v[92:95]
    v_mfma_f32_16x16x32_bf16 v[88:91], v[160:163], v[136:139], v[88:91]
    v_mfma_f32_16x16x32_bf16 v[84:87], v[160:163], v[132:135], v[84:87]
    v_mfma_f32_16x16x32_bf16 v[80:83], v[160:163], v[128:131], v[80:83]
    v_mfma_f32_16x16x32_bf16 v[96:99], v[128:131], v[164:167], v[96:99]
    v_mfma_f32_16x16x32_bf16 v[100:103], v[132:135], v[164:167], v[100:103]
    v_mfma_f32_16x16x32_bf16 v[104:107], v[136:139], v[164:167], v[104:107]
    v_mfma_f32_16x16x32_bf16 v[108:111], v[140:143], v[164:167], v[108:111]
    s_getpc_b64 s[56:57]
    ct_5:
    s_add_u32 s56, s56, qkv_epi-ct_5
    s_addc_u32 s57, s57, 0
    s_and_b32 s56, s56, 0xffffff80
    s_mov_b32 s58, code_end-qkv_epi
    s_mov_b32 s59, 0x20000
    v_lshlrev_b32 v252, 7, v1
    s_lshl_b32 s28, s31, 13
    buffer_load_dword v251, v252, s[56:59], s28 offen
    s_mov_b32 s24, s23
    s_add_u32 s23, s23, 40960
    s_cmp_eq_u32 s23, 163840
    s_cselect_b32 s23, 0, s23
    v_add_u32 v16, s23, v32
    v_add_u32 v17, s23, v35
    v_add_u32 v18, s23, v36
    v_add_u32 v19, s23, v37
    s_waitcnt vmcnt(5) lgkmcnt(0)
    s_barrier
    v_mfma_f32_16x16x32_bf16 v[64:67], v[200:203], v[168:171], v[64:67]
    ds_read_b64_tr_b16 v[144:145], v17 offset:0
    ds_read_b64_tr_b16 v[146:147], v17 offset:2048
    v_mfma_f32_16x16x32_bf16 v[68:71], v[200:203], v[172:175], v[68:71]
    ds_read_b64_tr_b16 v[148:149], v18 offset:0
    v_mfma_f32_16x16x32_bf16 v[72:75], v[200:203], v[176:179], v[72:75]
    ds_read_b64_tr_b16 v[150:151], v18 offset:2048
    v_mfma_f32_16x16x32_bf16 v[76:79], v[200:203], v[180:183], v[76:79]
    ds_read_b64_tr_b16 v[152:153], v19 offset:0
    v_mfma_f32_16x16x32_bf16 v[92:95], v[204:207], v[180:183], v[92:95]
    ds_read_b64_tr_b16 v[154:155], v19 offset:2048
    ds_read_b128 v[112:115], v16 offset:0
    v_mfma_f32_16x16x32_bf16 v[88:91], v[204:207], v[176:179], v[88:91]
    ds_read_b128 v[116:119], v16 offset:1024
    v_mfma_f32_16x16x32_bf16 v[84:87], v[204:207], v[172:175], v[84:87]
    ds_read_b128 v[120:123], v16 offset:2048
    v_mfma_f32_16x16x32_bf16 v[80:83], v[204:207], v[168:171], v[80:83]
    ds_read_b128 v[124:127], v16 offset:3072
    v_mfma_f32_16x16x32_bf16 v[96:99], v[168:171], v[208:211], v[96:99]
    ds_read_b64_tr_b16 v[156:157], v17 offset:4096
    ds_read_b64_tr_b16 v[158:159], v17 offset:6144
    v_mfma_f32_16x16x32_bf16 v[100:103], v[172:175], v[208:211], v[100:103]
    ds_read_b64_tr_b16 v[160:161], v18 offset:4096
    v_mfma_f32_16x16x32_bf16 v[104:107], v[176:179], v[208:211], v[104:107]
    ds_read_b64_tr_b16 v[162:163], v18 offset:6144
    v_mfma_f32_16x16x32_bf16 v[108:111], v[180:183], v[208:211], v[108:111]
    ds_read_b64_tr_b16 v[164:165], v19 offset:4096
    v_mfma_f32_16x16x32_bf16 v[64:67], v[212:215], v[184:187], v[64:67]
    ds_read_b64_tr_b16 v[166:167], v19 offset:6144
    ds_read_b128 v[128:131], v16 offset:8192
    v_mfma_f32_16x16x32_bf16 v[68:71], v[212:215], v[188:191], v[68:71]
    ds_read_b128 v[132:135], v16 offset:9216
    v_mfma_f32_16x16x32_bf16 v[72:75], v[212:215], v[192:195], v[72:75]
    ds_read_b128 v[136:139], v16 offset:10240
    v_mfma_f32_16x16x32_bf16 v[76:79], v[212:215], v[196:199], v[76:79]
    ds_read_b128 v[140:143], v16 offset:11264
    v_mfma_f32_16x16x32_bf16 v[92:95], v[216:219], v[196:199], v[92:95]
    v_mfma_f32_16x16x32_bf16 v[88:91], v[216:219], v[192:195], v[88:91]
    v_mfma_f32_16x16x32_bf16 v[84:87], v[216:219], v[188:191], v[84:87]
    v_mfma_f32_16x16x32_bf16 v[80:83], v[216:219], v[184:187], v[80:83]
    v_mfma_f32_16x16x32_bf16 v[96:99], v[184:187], v[220:223], v[96:99]
    v_mfma_f32_16x16x32_bf16 v[100:103], v[188:191], v[220:223], v[100:103]
    v_mfma_f32_16x16x32_bf16 v[104:107], v[192:195], v[220:223], v[104:107]
    v_mfma_f32_16x16x32_bf16 v[108:111], v[196:199], v[220:223], v[108:111]
    s_mov_b32 s24, s23
    s_add_u32 s23, s23, 40960
    s_cmp_eq_u32 s23, 163840
    s_cselect_b32 s23, 0, s23
    v_add_u32 v16, s23, v32
    v_add_u32 v17, s23, v35
    v_add_u32 v18, s23, v36
    v_add_u32 v19, s23, v37
    s_waitcnt vmcnt(1) lgkmcnt(0)
    s_barrier
    v_mfma_f32_16x16x32_bf16 v[64:67], v[144:147], v[112:115], v[64:67]
    ds_read_b64_tr_b16 v[200:201], v17 offset:0
    ds_read_b64_tr_b16 v[202:203], v17 offset:2048
    v_mfma_f32_16x16x32_bf16 v[68:71], v[144:147], v[116:119], v[68:71]
    ds_read_b64_tr_b16 v[204:205], v18 offset:0
    v_mfma_f32_16x16x32_bf16 v[72:75], v[144:147], v[120:123], v[72:75]
    ds_read_b64_tr_b16 v[206:207], v18 offset:2048
    v_mfma_f32_16x16x32_bf16 v[76:79], v[144:147], v[124:127], v[76:79]
    ds_read_b64_tr_b16 v[208:209], v19 offset:0
    v_mfma_f32_16x16x32_bf16 v[92:95], v[148:151], v[124:127], v[92:95]
    ds_read_b64_tr_b16 v[210:211], v19 offset:2048
    ds_read_b128 v[168:171], v16 offset:0
    v_mfma_f32_16x16x32_bf16 v[88:91], v[148:151], v[120:123], v[88:91]
    ds_read_b128 v[172:175], v16 offset:1024
    v_mfma_f32_16x16x32_bf16 v[84:87], v[148:151], v[116:119], v[84:87]
    ds_read_b128 v[176:179], v16 offset:2048
    v_mfma_f32_16x16x32_bf16 v[80:83], v[148:151], v[112:115], v[80:83]
    ds_read_b128 v[180:183], v16 offset:3072
    v_mfma_f32_16x16x32_bf16 v[96:99], v[112:115], v[152:155], v[96:99]
    ds_read_b64_tr_b16 v[212:213], v17 offset:4096
    ds_read_b64_tr_b16 v[214:215], v17 offset:6144
    v_mfma_f32_16x16x32_bf16 v[100:103], v[116:119], v[152:155], v[100:103]
    ds_read_b64_tr_b16 v[216:217], v18 offset:4096
    v_mfma_f32_16x16x32_bf16 v[104:107], v[120:123], v[152:155], v[104:107]
    ds_read_b64_tr_b16 v[218:219], v18 offset:6144
    v_mfma_f32_16x16x32_bf16 v[108:111], v[124:127], v[152:155], v[108:111]
    ds_read_b64_tr_b16 v[220:221], v19 offset:4096
    v_mfma_f32_16x16x32_bf16 v[64:67], v[156:159], v[128:131], v[64:67]
    ds_read_b64_tr_b16 v[222:223], v19 offset:6144
    ds_read_b128 v[184:187], v16 offset:8192
    v_mfma_f32_16x16x32_bf16 v[68:71], v[156:159], v[132:135], v[68:71]
    ds_read_b128 v[188:191], v16 offset:9216
    v_mfma_f32_16x16x32_bf16 v[72:75], v[156:159], v[136:139], v[72:75]
    ds_read_b128 v[192:195], v16 offset:10240
    v_mfma_f32_16x16x32_bf16 v[76:79], v[156:159], v[140:143], v[76:79]
    ds_read_b128 v[196:199], v16 offset:11264
    v_mfma_f32_16x16x32_bf16 v[92:95], v[160:163], v[140:143], v[92:95]
    v_mfma_f32_16x16x32_bf16 v[88:91], v[160:163], v[136:139], v[88:91]
    v_mfma_f32_16x16x32_bf16 v[84:87], v[160:163], v[132:135], v[84:87]
    v_mfma_f32_16x16x32_bf16 v[80:83], v[160:163], v[128:131], v[80:83]
    v_mfma_f32_16x16x32_bf16 v[96:99], v[128:131], v[164:167], v[96:99]
    v_mfma_f32_16x16x32_bf16 v[100:103], v[132:135], v[164:167], v[100:103]
    v_mfma_f32_16x16x32_bf16 v[104:107], v[136:139], v[164:167], v[104:107]
    v_mfma_f32_16x16x32_bf16 v[108:111], v[140:143], v[164:167], v[108:111]
    s_mov_b32 s24, s23
    s_add_u32 s23, s23, 40960
    s_cmp_eq_u32 s23, 163840
    s_cselect_b32 s23, 0, s23
    v_add_u32 v16, s23, v32
    v_add_u32 v17, s23, v35
    v_add_u32 v18, s23, v36
    v_add_u32 v19, s23, v37
    s_waitcnt lgkmcnt(0)
    v_mfma_f32_16x16x32_bf16 v[64:67], v[200:203], v[168:171], v[64:67]
    v_mfma_f32_16x16x32_bf16 v[68:71], v[200:203], v[172:175], v[68:71]
    v_mfma_f32_16x16x32_bf16 v[72:75], v[200:203], v[176:179], v[72:75]
    v_mfma_f32_16x16x32_bf16 v[76:79], v[200:203], v[180:183], v[76:79]
    v_mfma_f32_16x16x32_bf16 v[92:95], v[204:207], v[180:183], v[92:95]
    v_mfma_f32_16x16x32_bf16 v[88:91], v[204:207], v[176:179], v[88:91]
    v_mfma_f32_16x16x32_bf16 v[84:87], v[204:207], v[172:175], v[84:87]
    v_mfma_f32_16x16x32_bf16 v[80:83], v[204:207], v[168:171], v[80:83]
    v_mfma_f32_16x16x32_bf16 v[96:99], v[168:171], v[208:211], v[96:99]
    v_mfma_f32_16x16x32_bf16 v[100:103], v[172:175], v[208:211], v[100:103]
    v_mfma_f32_16x16x32_bf16 v[104:107], v[176:179], v[208:211], v[104:107]
    v_mfma_f32_16x16x32_bf16 v[108:111], v[180:183], v[208:211], v[108:111]
    v_mfma_f32_16x16x32_bf16 v[64:67], v[212:215], v[184:187], v[64:67]
    v_mfma_f32_16x16x32_bf16 v[68:71], v[212:215], v[188:191], v[68:71]
    v_mfma_f32_16x16x32_bf16 v[72:75], v[212:215], v[192:195], v[72:75]
    v_mfma_f32_16x16x32_bf16 v[76:79], v[212:215], v[196:199], v[76:79]
    v_mfma_f32_16x16x32_bf16 v[92:95], v[216:219], v[196:199], v[92:95]
    v_mfma_f32_16x16x32_bf16 v[88:91], v[216:219], v[192:195], v[88:91]
    v_mfma_f32_16x16x32_bf16 v[84:87], v[216:219], v[188:191], v[84:87]
    v_mfma_f32_16x16x32_bf16 v[80:83], v[216:219], v[184:187], v[80:83]
    v_mfma_f32_16x16x32_bf16 v[96:99], v[184:187], v[220:223], v[96:99]
    v_mfma_f32_16x16x32_bf16 v[100:103], v[188:191], v[220:223], v[100:103]
    v_mfma_f32_16x16x32_bf16 v[104:107], v[192:195], v[220:223], v[104:107]
    v_mfma_f32_16x16x32_bf16 v[108:111], v[196:199], v[220:223], v[108:111]
    s_nop 7
    s_branch qkv_epi
qkv_B:
    s_barrier
    s_barrier
    s_barrier
    s_mov_b32 s23, 0
    v_add_u32 v16, s23, v32
    v_add_u32 v17, s23, v35
    v_add_u32 v18, s23, v36
    v_add_u32 v19, s23, v37
    s_waitcnt vmcnt(18)
    s_barrier
    ds_read_b64_tr_b16 v[144:145], v17 offset:0
    ds_read_b64_tr_b16 v[146:147], v17 offset:2048
    ds_read_b64_tr_b16 v[148:149], v18 offset:0
    ds_read_b64_tr_b16 v[150:151], v18 offset:2048
    ds_read_b64_tr_b16 v[152:153], v19 offset:0
    ds_read_b64_tr_b16 v[154:155], v19 offset:2048
    ds_read_b128 v[112:115], v16 offset:0
    ds_read_b128 v[116:119], v16 offset:1024
    ds_read_b128 v[120:123], v16 offset:2048
    ds_read_b128 v[124:127], v16 offset:3072
    ds_read_b64_tr_b16 v[156:157], v17 offset:4096
    ds_read_b64_tr_b16 v[158:159], v17 offset:6144
    ds_read_b64_tr_b16 v[160:161], v18 offset:4096
    ds_read_b64_tr_b16 v[162:163], v18 offset:6144
    ds_read_b64_tr_b16 v[164:165], v19 offset:4096
    ds_read_b64_tr_b16 v[166:167], v19 offset:6144
    ds_read_b128 v[128:131], v16 offset:8192
    ds_read_b128 v[132:135], v16 offset:9216
    ds_read_b128 v[136:139], v16 offset:10240
    ds_read_b128 v[140:143], v16 offset:11264
    s_mov_b32 s24, s23
    s_add_u32 s23, s23, 40960
    s_cmp_eq_u32 s23, 163840
    s_cselect_b32 s23, 0, s23
    v_add_u32 v16, s23, v32
    v_add_u32 v17, s23, v35
    v_add_u32 v18, s23, v36
    v_add_u32 v19, s23, v37
    s_mov_b32 s27, 6
.p2align 6
qkv_loopB:
    s_waitcnt vmcnt(12) lgkmcnt(0)
    s_barrier
    s_add_u32 m0, s24, s30
    s_nop 0
    buffer_load_dwordx4 v7, s[12:15], s25 offen lds
    buffer_load_dwordx4 v8, s[12:15], s25 offen offset:1024 lds
    s_add_u32 m0, m0, 8192
    s_nop 0
    buffer_load_dwordx4 v9, s[12:15], s25 offen lds
    buffer_load_dwordx4 v10, s[12:15], s25 offen offset:1024 lds
    s_add_u32 m0, m0, 8192
    s_nop 0
    buffer_load_dwordx4 v11, s[12:15], s25 offen lds
    buffer_load_dwordx4 v12, s[12:15], s25 offen offset:1024 lds
    s_add_u32 s38, s38, 1
    s_add_u32 s3, s38, s39
    s_and_b32 s3, s3, 7
    s_andn2_b32 s25, s38, 7
    s_or_b32 s3, s3, s25
    s_mul_i32 s3, s3, 0x60000
    s_add_u32 s25, s3, s37
    v_mfma_f32_16x16x32_bf16 v[64:67], v[144:147], v[112:115], v[64:67]
    ds_read_b64_tr_b16 v[200:201], v17 offset:0
    ds_read_b64_tr_b16 v[202:203], v17 offset:2048
    v_mfma_f32_16x16x32_bf16 v[68:71], v[144:147], v[116:119], v[68:71]
    ds_read_b64_tr_b16 v[204:205], v18 offset:0
    v_mfma_f32_16x16x32_bf16 v[72:75], v[144:147], v[120:123], v[72:75]
    ds_read_b64_tr_b16 v[206:207], v18 offset:2048
    v_mfma_f32_16x16x32_bf16 v[76:79], v[144:147], v[124:127], v[76:79]
    ds_read_b64_tr_b16 v[208:209], v19 offset:0
    v_mfma_f32_16x16x32_bf16 v[92:95], v[148:151], v[124:127], v[92:95]
    ds_read_b64_tr_b16 v[210:211], v19 offset:2048
    ds_read_b128 v[168:171], v16 offset:0
    v_mfma_f32_16x16x32_bf16 v[88:91], v[148:151], v[120:123], v[88:91]
    ds_read_b128 v[172:175], v16 offset:1024
    v_mfma_f32_16x16x32_bf16 v[84:87], v[148:151], v[116:119], v[84:87]
    ds_read_b128 v[176:179], v16 offset:2048
    v_mfma_f32_16x16x32_bf16 v[80:83], v[148:151], v[112:115], v[80:83]
    ds_read_b128 v[180:183], v16 offset:3072
    v_mfma_f32_16x16x32_bf16 v[96:99], v[112:115], v[152:155], v[96:99]
    ds_read_b64_tr_b16 v[212:213], v17 offset:4096
    ds_read_b64_tr_b16 v[214:215], v17 offset:6144
    v_mfma_f32_16x16x32_bf16 v[100:103], v[116:119], v[152:155], v[100:103]
    ds_read_b64_tr_b16 v[216:217], v18 offset:4096
    v_mfma_f32_16x16x32_bf16 v[104:107], v[120:123], v[152:155], v[104:107]
    ds_read_b64_tr_b16 v[218:219], v18 offset:6144
    v_mfma_f32_16x16x32_bf16 v[108:111], v[124:127], v[152:155], v[108:111]
    ds_read_b64_tr_b16 v[220:221], v19 offset:4096
    v_mfma_f32_16x16x32_bf16 v[64:67], v[156:159], v[128:131], v[64:67]
    ds_read_b64_tr_b16 v[222:223], v19 offset:6144
    ds_read_b128 v[184:187], v16 offset:8192
    v_mfma_f32_16x16x32_bf16 v[68:71], v[156:159], v[132:135], v[68:71]
    ds_read_b128 v[188:191], v16 offset:9216
    v_mfma_f32_16x16x32_bf16 v[72:75], v[156:159], v[136:139], v[72:75]
    ds_read_b128 v[192:195], v16 offset:10240
    v_mfma_f32_16x16x32_bf16 v[76:79], v[156:159], v[140:143], v[76:79]
    ds_read_b128 v[196:199], v16 offset:11264
    v_mfma_f32_16x16x32_bf16 v[92:95], v[160:163], v[140:143], v[92:95]
    s_mov_b32 s24, s23
    v_mfma_f32_16x16x32_bf16 v[88:91], v[160:163], v[136:139], v[88:91]
    s_add_u32 s23, s23, 40960
    v_mfma_f32_16x16x32_bf16 v[84:87], v[160:163], v[132:135], v[84:87]
    s_cmp_eq_u32 s23, 163840
    s_cselect_b32 s23, 0, s23
    v_mfma_f32_16x16x32_bf16 v[80:83], v[160:163], v[128:131], v[80:83]
    v_add_u32 v16, s23, v32
    v_mfma_f32_16x16x32_bf16 v[96:99], v[128:131], v[164:167], v[96:99]
    v_add_u32 v17, s23, v35
    v_mfma_f32_16x16x32_bf16 v[100:103], v[132:135], v[164:167], v[100:103]
    v_add_u32 v18, s23, v36
    v_mfma_f32_16x16x32_bf16 v[104:107], v[136:139], v[164:167], v[104:107]
    v_add_u32 v19, s23, v37
    v_mfma_f32_16x16x32_bf16 v[108:111], v[140:143], v[164:167], v[108:111]
    s_waitcnt vmcnt(12) lgkmcnt(0)
    s_barrier
    s_add_u32 m0, s24, s30
    s_nop 0
    buffer_load_dwordx4 v7, s[12:15], s25 offen lds
    buffer_load_dwordx4 v8, s[12:15], s25 offen offset:1024 lds
    s_add_u32 m0, m0, 8192
    s_nop 0
    buffer_load_dwordx4 v9, s[12:15], s25 offen lds
    buffer_load_dwordx4 v10, s[12:15], s25 offen offset:1024 lds
    s_add_u32 m0, m0, 8192
    s_nop 0
    buffer_load_dwordx4 v11, s[12:15], s25 offen lds
    buffer_load_dwordx4 v12, s[12:15], s25 offen offset:1024 lds
    s_add_u32 s38, s38, 1
    s_add_u32 s3, s38, s39
    s_and_b32 s3, s3, 7
    s_andn2_b32 s25, s38, 7
    s_or_b32 s3, s3, s25
    s_mul_i32 s3, s3, 0x60000
    s_add_u32 s25, s3, s37
    v_mfma_f32_16x16x32_bf16 v[64:67], v[200:203], v[168:171], v[64:67]
    ds_read_b64_tr_b16 v[144:145], v17 offset:0
    ds_read_b64_tr_b16 v[146:147], v17 offset:2048
    v_mfma_f32_16x16x32_bf16 v[68:71], v[200:203], v[172:175], v[68:71]
    ds_read_b64_tr_b16 v[148:149], v18 offset:0
    v_mfma_f32_16x16x32_bf16 v[72:75], v[200:203], v[176:179], v[72:75]
    ds_read_b64_tr_b16 v[150:151], v18 offset:2048
    v_mfma_f32_16x16x32_bf16 v[76:79], v[200:203], v[180:183], v[76:79]
    ds_read_b64_tr_b16 v[152:153], v19 offset:0
    v_mfma_f32_16x16x32_bf16 v[92:95], v[204:207], v[180:183], v[92:95]
    ds_read_b64_tr_b16 v[154:155], v19 offset:2048
    ds_read_b128 v[112:115], v16 offset:0
    v_mfma_f32_16x16x32_bf16 v[88:91], v[204:207], v[176:179], v[88:91]
    ds_read_b128 v[116:119], v16 offset:1024
    v_mfma_f32_16x16x32_bf16 v[84:87], v[204:207], v[172:175], v[84:87]
    ds_read_b128 v[120:123], v16 offset:2048
    v_mfma_f32_16x16x32_bf16 v[80:83], v[204:207], v[168:171], v[80:83]
    ds_read_b128 v[124:127], v16 offset:3072
    v_mfma_f32_16x16x32_bf16 v[96:99], v[168:171], v[208:211], v[96:99]
    ds_read_b64_tr_b16 v[156:157], v17 offset:4096
    ds_read_b64_tr_b16 v[158:159], v17 offset:6144
    v_mfma_f32_16x16x32_bf16 v[100:103], v[172:175], v[208:211], v[100:103]
    ds_read_b64_tr_b16 v[160:161], v18 offset:4096
    v_mfma_f32_16x16x32_bf16 v[104:107], v[176:179], v[208:211], v[104:107]
    ds_read_b64_tr_b16 v[162:163], v18 offset:6144
    v_mfma_f32_16x16x32_bf16 v[108:111], v[180:183], v[208:211], v[108:111]
    ds_read_b64_tr_b16 v[164:165], v19 offset:4096
    v_mfma_f32_16x16x32_bf16 v[64:67], v[212:215], v[184:187], v[64:67]
    ds_read_b64_tr_b16 v[166:167], v19 offset:6144
    ds_read_b128 v[128:131], v16 offset:8192
    v_mfma_f32_16x16x32_bf16 v[68:71], v[212:215], v[188:191], v[68:71]
    ds_read_b128 v[132:135], v16 offset:9216
    v_mfma_f32_16x16x32_bf16 v[72:75], v[212:215], v[192:195], v[72:75]
    ds_read_b128 v[136:139], v16 offset:10240
    v_mfma_f32_16x16x32_bf16 v[76:79], v[212:215], v[196:199], v[76:79]
    ds_read_b128 v[140:143], v16 offset:11264
    v_mfma_f32_16x16x32_bf16 v[92:95], v[216:219], v[196:199], v[92:95]
    s_mov_b32 s24, s23
    s_add_u32 s23, s23, 40960
    v_mfma_f32_16x16x32_bf16 v[88:91], v[216:219], v[192:195], v[88:91]
    s_cmp_eq_u32 s23, 163840
    s_cselect_b32 s23, 0, s23
    v_mfma_f32_16x16x32_bf16 v[84:87], v[216:219], v[188:191], v[84:87]
    v_add_u32 v16, s23, v32
    v_mfma_f32_16x16x32_bf16 v[80:83], v[216:219], v[184:187], v[80:83]
    v_add_u32 v17, s23, v35
    v_mfma_f32_16x16x32_bf16 v[96:99], v[184:187], v[220:223], v[96:99]
    v_add_u32 v18, s23, v36
    v_mfma_f32_16x16x32_bf16 v[100:103], v[188:191], v[220:223], v[100:103]
    v_add_u32 v19, s23, v37
    v_mfma_f32_16x16x32_bf16 v[104:107], v[192:195], v[220:223], v[104:107]
    s_sub_u32 s27, s27, 1
    s_cmp_lg_u32 s27, 0
    v_mfma_f32_16x16x32_bf16 v[108:111], v[196:199], v[220:223], v[108:111]
    s_cbranch_scc1 qkv_loopB
    s_waitcnt vmcnt(12) lgkmcnt(0)
    s_barrier
    v_mfma_f32_16x16x32_bf16 v[64:67], v[144:147], v[112:115], v[64:67]
    ds_read_b64_tr_b16 v[200:201], v17 offset:0
    ds_read_b64_tr_b16 v[202:203], v17 offset:2048
    v_mfma_f32_16x16x32_bf16 v[68:71], v[144:147], v[116:119], v[68:71]
    ds_read_b64_tr_b16 v[204:205], v18 offset:0
    v_mfma_f32_16x16x32_bf16 v[72:75], v[144:147], v[120:123], v[72:75]
    ds_read_b64_tr_b16 v[206:207], v18 offset:2048
    v_mfma_f32_16x16x32_bf16 v[76:79], v[144:147], v[124:127], v[76:79]
    ds_read_b64_tr_b16 v[208:209], v19 offset:0
    v_mfma_f32_16x16x32_bf16 v[92:95], v[148:151], v[124:127], v[92:95]
    ds_read_b64_tr_b16 v[210:211], v19 offset:2048
    ds_read_b128 v[168:171], v16 offset:0
    v_mfma_f32_16x16x32_bf16 v[88:91], v[148:151], v[120:123], v[88:91]
    ds_read_b128 v[172:175], v16 offset:1024
    v_mfma_f32_16x16x32_bf16 v[84:87], v[148:151], v[116:119], v[84:87]
    ds_read_b128 v[176:179], v16 offset:2048
    v_mfma_f32_16x16x32_bf16 v[80:83], v[148:151], v[112:115], v[80:83]
    ds_read_b128 v[180:183], v16 offset:3072
    v_mfma_f32_16x16x32_bf16 v[96:99], v[112:115], v[152:155], v[96:99]
    ds_read_b64_tr_b16 v[212:213], v17 offset:4096
    ds_read_b64_tr_b16 v[214:215], v17 offset:6144
    v_mfma_f32_16x16x32_bf16 v[100:103], v[116:119], v[152:155], v[100:103]
    ds_read_b64_tr_b16 v[216:217], v18 offset:4096
    v_mfma_f32_16x16x32_bf16 v[104:107], v[120:123], v[152:155], v[104:107]
    ds_read_b64_tr_b16 v[218:219], v18 offset:6144
    v_mfma_f32_16x16x32_bf16 v[108:111], v[124:127], v[152:155], v[108:111]
    ds_read_b64_tr_b16 v[220:221], v19 offset:4096
    v_mfma_f32_16x16x32_bf16 v[64:67], v[156:159], v[128:131], v[64:67]
    ds_read_b64_tr_b16 v[222:223], v19 offset:6144
    ds_read_b128 v[184:187], v16 offset:8192
    v_mfma_f32_16x16x32_bf16 v[68:71], v[156:159], v[132:135], v[68:71]
    ds_read_b128 v[188:191], v16 offset:9216
    v_mfma_f32_16x16x32_bf16 v[72:75], v[156:159], v[136:139], v[72:75]
    ds_read_b128 v[192:195], v16 offset:10240
    v_mfma_f32_16x16x32_bf16 v[76:79], v[156:159], v[140:143], v[76:79]
    ds_read_b128 v[196:199], v16 offset:11264
    v_mfma_f32_16x16x32_bf16 v[92:95], v[160:163], v[140:143], v[92:95]
    s_mov_b32 s24, s23
    v_mfma_f32_16x16x32_bf16 v[88:91], v[160:163], v[136:139], v[88:91]
    s_add_u32 s23, s23, 40960
    v_mfma_f32_16x16x32_bf16 v[84:87], v[160:163], v[132:135], v[84:87]
    s_cmp_eq_u32 s23, 163840
    s_cselect_b32 s23, 0, s23
    v_mfma_f32_16x16x32_bf16 v[80:83], v[160:163], v[128:131], v[80:83]
    v_add_u32 v16, s23, v32
    v_mfma_f32_16x16x32_bf16 v[96:99], v[128:131], v[164:167], v[96:99]
    v_add_u32 v17, s23, v35
    v_mfma_f32_16x16x32_bf16 v[100:103], v[132:135], v[164:167], v[100:103]
    v_add_u32 v18, s23, v36
    v_mfma_f32_16x16x32_bf16 v[104:107], v[136:139], v[164:167], v[104:107]
    v_add_u32 v19, s23, v37
    v_mfma_f32_16x16x32_bf16 v[108:111], v[140:143], v[164:167], v[108:111]
    s_waitcnt vmcnt(6) lgkmcnt(0)
    s_barrier
    v_mfma_f32_16x16x32_bf16 v[64:67], v[200:203], v[168:171], v[64:67]
    ds_read_b64_tr_b16 v[144:145], v17 offset:0
    ds_read_b64_tr_b16 v[146:147], v17 offset:2048
    v_mfma_f32_16x16x32_bf16 v[68:71], v[200:203], v[172:175], v[68:71]
    ds_read_b64_tr_b16 v[148:149], v18 offset:0
    v_mfma_f32_16x16x32_bf16 v[72:75], v[200:203], v[176:179], v[72:75]
    ds_read_b64_tr_b16 v[150:151], v18 offset:2048
    v_mfma_f32_16x16x32_bf16 v[76:79], v[200:203], v[180:183], v[76:79]
    ds_read_b64_tr_b16 v[152:153], v19 offset:0
    v_mfma_f32_16x16x32_bf16 v[92:95], v[204:207], v[180:183], v[92:95]
    ds_read_b64_tr_b16 v[154:155], v19 offset:2048
    ds_read_b128 v[112:115], v16 offset:0
    v_mfma_f32_16x16x32_bf16 v[88:91], v[204:207], v[176:179], v[88:91]
    ds_read_b128 v[116:119], v16 offset:1024
    v_mfma_f32_16x16x32_bf16 v[84:87], v[204:207], v[172:175], v[84:87]
    ds_read_b128 v[120:123], v16 offset:2048
    v_mfma_f32_16x16x32_bf16 v[80:83], v[204:207], v[168:171], v[80:83]
    ds_read_b128 v[124:127], v16 offset:3072
    v_mfma_f32_16x16x32_bf16 v[96:99], v[168:171], v[208:211], v[96:99]
    ds_read_b64_tr_b16 v[156:157], v17 offset:4096
    ds_read_b64_tr_b16 v[158:159], v17 offset:6144
    v_mfma_f32_16x16x32_bf16 v[100:103], v[172:175], v[208:211], v[100:103]
    ds_read_b64_tr_b16 v[160:161], v18 offset:4096
    v_mfma_f32_16x16x32_bf16 v[104:107], v[176:179], v[208:211], v[104:107]
    ds_read_b64_tr_b16 v[162:163], v18 offset:6144
    v_mfma_f32_16x16x32_bf16 v[108:111], v[180:183], v[208:211], v[108:111]
    ds_read_b64_tr_b16 v[164:165], v19 offset:4096
    v_mfma_f32_16x16x32_bf16 v[64:67], v[212:215], v[184:187], v[64:67]
    ds_read_b64_tr_b16 v[166:167], v19 offset:6144
    ds_read_b128 v[128:131], v16 offset:8192
    v_mfma_f32_16x16x32_bf16 v[68:71], v[212:215], v[188:191], v[68:71]
    ds_read_b128 v[132:135], v16 offset:9216
    v_mfma_f32_16x16x32_bf16 v[72:75], v[212:215], v[192:195], v[72:75]
    ds_read_b128 v[136:139], v16 offset:10240
    v_mfma_f32_16x16x32_bf16 v[76:79], v[212:215], v[196:199], v[76:79]
    ds_read_b128 v[140:143], v16 offset:11264
    v_mfma_f32_16x16x32_bf16 v[92:95], v[216:219], v[196:199], v[92:95]
    s_mov_b32 s24, s23
    v_mfma_f32_16x16x32_bf16 v[88:91], v[216:219], v[192:195], v[88:91]
    s_add_u32 s23, s23, 40960
    v_mfma_f32_16x16x32_bf16 v[84:87], v[216:219], v[188:191], v[84:87]
    s_cmp_eq_u32 s23, 163840
    s_cselect_b32 s23, 0, s23
    v_mfma_f32_16x16x32_bf16 v[80:83], v[216:219], v[184:187], v[80:83]
    v_add_u32 v16, s23, v32
    v_mfma_f32_16x16x32_bf16 v[96:99], v[184:187], v[220:223], v[96:99]
    v_add_u32 v17, s23, v35
    v_mfma_f32_16x16x32_bf16 v[100:103], v[188:191], v[220:223], v[100:103]
    v_add_u32 v18, s23, v36
    v_mfma_f32_16x16x32_bf16 v[104:107], v[192:195], v[220:223], v[104:107]
    v_add_u32 v19, s23, v37
    v_mfma_f32_16x16x32_bf16 v[108:111], v[196:199], v[220:223], v[108:111]
    s_waitcnt vmcnt(0) lgkmcnt(0)
    s_barrier
    v_mfma_f32_16x16x32_bf16 v[64:67], v[144:147], v[112:115], v[64:67]
    ds_read_b64_tr_b16 v[200:201], v17 offset:0
    ds_read_b64_tr_b16 v[202:203], v17 offset:2048
    v_mfma_f32_16x16x32_bf16 v[68:71], v[144:147], v[116:119], v[68:71]
    ds_read_b64_tr_b16 v[204:205], v18 offset:0
    v_mfma_f32_16x16x32_bf16 v[72:75], v[144:147], v[120:123], v[72:75]
    ds_read_b64_tr_b16 v[206:207], v18 offset:2048
    v_mfma_f32_16x16x32_bf16 v[76:79], v[144:147], v[124:127], v[76:79]
    ds_read_b64_tr_b16 v[208:209], v19 offset:0
    v_mfma_f32_16x16x32_bf16 v[92:95], v[148:151], v[124:127], v[92:95]
    ds_read_b64_tr_b16 v[210:211], v19 offset:2048
    ds_read_b128 v[168:171], v16 offset:0
    v_mfma_f32_16x16x32_bf16 v[88:91], v[148:151], v[120:123], v[88:91]
    ds_read_b128 v[172:175], v16 offset:1024
    v_mfma_f32_16x16x32_bf16 v[84:87], v[148:151], v[116:119], v[84:87]
    ds_read_b128 v[176:179], v16 offset:2048
    v_mfma_f32_16x16x32_bf16 v[80:83], v[148:151], v[112:115], v[80:83]
    ds_read_b128 v[180:183], v16 offset:3072
    v_mfma_f32_16x16x32_bf16 v[96:99], v[112:115], v[152:155], v[96:99]
    ds_read_b64_tr_b16 v[212:213], v17 offset:4096
    ds_read_b64_tr_b16 v[214:215], v17 offset:6144
    v_mfma_f32_16x16x32_bf16 v[100:103], v[116:119], v[152:155], v[100:103]
    ds_read_b64_tr_b16 v[216:217], v18 offset:4096
    v_mfma_f32_16x16x32_bf16 v[104:107], v[120:123], v[152:155], v[104:107]
    ds_read_b64_tr_b16 v[218:219], v18 offset:6144
    v_mfma_f32_16x16x32_bf16 v[108:111], v[124:127], v[152:155], v[108:111]
    ds_read_b64_tr_b16 v[220:221], v19 offset:4096
    v_mfma_f32_16x16x32_bf16 v[64:67], v[156:159], v[128:131], v[64:67]
    ds_read_b64_tr_b16 v[222:223], v19 offset:6144
    ds_read_b128 v[184:187], v16 offset:8192
    v_mfma_f32_16x16x32_bf16 v[68:71], v[156:159], v[132:135], v[68:71]
    ds_read_b128 v[188:191], v16 offset:9216
    v_mfma_f32_16x16x32_bf16 v[72:75], v[156:159], v[136:139], v[72:75]
    ds_read_b128 v[192:195], v16 offset:10240
    v_mfma_f32_16x16x32_bf16 v[76:79], v[156:159], v[140:143], v[76:79]
    ds_read_b128 v[196:199], v16 offset:11264
    v_mfma_f32_16x16x32_bf16 v[92:95], v[160:163], v[140:143], v[92:95]
    s_mov_b32 s24, s23
    v_mfma_f32_16x16x32_bf16 v[88:91], v[160:163], v[136:139], v[88:91]
    s_add_u32 s23, s23, 40960
    v_mfma_f32_16x16x32_bf16 v[84:87], v[160:163], v[132:135], v[84:87]
    s_cmp_eq_u32 s23, 163840
    s_cselect_b32 s23, 0, s23
    v_mfma_f32_16x16x32_bf16 v[80:83], v[160:163], v[128:131], v[80:83]
    v_add_u32 v16, s23, v32
    v_mfma_f32_16x16x32_bf16 v[96:99], v[128:131], v[164:167], v[96:99]
    v_add_u32 v17, s23, v35
    v_mfma_f32_16x16x32_bf16 v[100:103], v[132:135], v[164:167], v[100:103]
    v_add_u32 v18, s23, v36
    v_mfma_f32_16x16x32_bf16 v[104:107], v[136:139], v[164:167], v[104:107]
    v_add_u32 v19, s23, v37
    v_mfma_f32_16x16x32_bf16 v[108:111], v[140:143], v[164:167], v[108:111]
    s_waitcnt lgkmcnt(0)
    v_mfma_f32_16x16x32_bf16 v[64:67], v[200:203], v[168:171], v[64:67]
    v_mfma_f32_16x16x32_bf16 v[68:71], v[200:203], v[172:175], v[68:71]
    v_mfma_f32_16x16x32_bf16 v[72:75], v[200:203], v[176:179], v[72:75]
    v_mfma_f32_16x16x32_bf16 v[76:79], v[200:203], v[180:183], v[76:79]
    v_mfma_f32_16x16x32_bf16 v[92:95], v[204:207], v[180:183], v[92:95]
    v_mfma_f32_16x16x32_bf16 v[88:91], v[204:207], v[176:179], v[88:91]
    v_mfma_f32_16x16x32_bf16 v[84:87], v[204:207], v[172:175], v[84:87]
    v_mfma_f32_16x16x32_bf16 v[80:83], v[204:207], v[168:171], v[80:83]
    v_mfma_f32_16x16x32_bf16 v[96:99], v[168:171], v[208:211], v[96:99]
    v_mfma_f32_16x16x32_bf16 v[100:103], v[172:175], v[208:211], v[100:103]
    v_mfma_f32_16x16x32_bf16 v[104:107], v[176:179], v[208:211], v[104:107]
    v_mfma_f32_16x16x32_bf16 v[108:111], v[180:183], v[208:211], v[108:111]
    v_mfma_f32_16x16x32_bf16 v[64:67], v[212:215], v[184:187], v[64:67]
    v_mfma_f32_16x16x32_bf16 v[68:71], v[212:215], v[188:191], v[68:71]
    v_mfma_f32_16x16x32_bf16 v[72:75], v[212:215], v[192:195], v[72:75]
    v_mfma_f32_16x16x32_bf16 v[76:79], v[212:215], v[196:199], v[76:79]
    v_mfma_f32_16x16x32_bf16 v[92:95], v[216:219], v[196:199], v[92:95]
    v_mfma_f32_16x16x32_bf16 v[88:91], v[216:219], v[192:195], v[88:91]
    v_mfma_f32_16x16x32_bf16 v[84:87], v[216:219], v[188:191], v[84:87]
    v_mfma_f32_16x16x32_bf16 v[80:83], v[216:219], v[184:187], v[80:83]
    v_mfma_f32_16x16x32_bf16 v[96:99], v[184:187], v[220:223], v[96:99]
    v_mfma_f32_16x16x32_bf16 v[100:103], v[188:191], v[220:223], v[100:103]
    v_mfma_f32_16x16x32_bf16 v[104:107], v[192:195], v[220:223], v[104:107]
    v_mfma_f32_16x16x32_bf16 v[108:111], v[196:199], v[220:223], v[108:111]
    s_nop 7
qkv_epi:
    s_load_dwordx2 s[40:41], s[0:1], 16
    s_load_dwordx4 s[44:47], s[0:1], 32
    s_load_dwordx2 s[42:43], s[0:1], 48
    v_lshlrev_b32 v9, 9, v2
    v_lshrrev_b32 v7, 3, v5
    v_lshl_add_u32 v7, v7, 8, v9
    v_and_b32 v8, 7, v5
    v_lshl_add_u32 v7, v8, 4, v7
    v_lshl_add_u32 v8, v5, 4, v9
    s_lshr_b32 s28, s20, 1
    s_and_b32 s29, s28, 1
    s_lshr_b32 s32, s28, 1
    s_and_b32 s33, s20, 1
    s_lshl_b32 s34, s21, 2
    s_lshl_b32 s33, s33, 1
    s_add_u32 s34, s34, s33
    s_lshl_b32 s34, s34, 11
    s_lshl_b32 s35, s22, 1
    s_add_u32 s36, s35, s29
    s_lshl_b32 s36, s36, 17
    s_add_u32 s36, s36, s34
    s_lshl_b32 s37, s32, 22
    s_add_u32 s36, s36, s37
    s_add_u32 s38, s35, s32
    s_lshl_b32 s38, s38, 17
    s_add_u32 s38, s38, s34
    s_lshl_b32 s37, s29, 8
    s_add_u32 s38, s38, s37
    s_add_u32 s38, s38, 8388608
    s_cmp_eq_u32 s32, 0
    s_cselect_b32 s39, 0x3e8293ee, 1.0
    v_mov_b32 v20, s39
    v_mov_b32 v21, s39
    v_cvt_pk_bf16_f32 v128, v96, v97
    v_cvt_pk_bf16_f32 v129, v98, v99
    v_cvt_pk_bf16_f32 v130, v100, v101
    v_cvt_pk_bf16_f32 v131, v102, v103
    buffer_store_dwordx4 v[128:131], v8, s[16:19], s38 offen offset:0 sc1
    v_cvt_pk_bf16_f32 v132, v104, v105
    v_cvt_pk_bf16_f32 v133, v106, v107
    v_cvt_pk_bf16_f32 v134, v108, v109
    v_cvt_pk_bf16_f32 v135, v110, v111
    buffer_store_dwordx4 v[132:135], v8, s[16:19], s38 offen offset:2048 sc1
    v_mul_f32 v64, v64, v20
    v_mul_f32 v65, v65, v20
    v_mul_f32 v66, v66, v20
    v_mul_f32 v67, v67, v20
    v_mul_f32 v80, v80, v20
    v_mul_f32 v81, v81, v20
    v_mul_f32 v82, v82, v20
    v_mul_f32 v83, v83, v20
    v_cvt_pk_bf16_f32 v112, v64, v65
    v_cvt_pk_bf16_f32 v113, v66, v67
    v_cvt_pk_bf16_f32 v114, v80, v81
    v_cvt_pk_bf16_f32 v115, v82, v83
    buffer_store_dwordx4 v[112:115], v7, s[16:19], s36 offen offset:0 sc1
    v_mul_f32 v68, v68, v20
    v_mul_f32 v69, v69, v20
    v_mul_f32 v70, v70, v20
    v_mul_f32 v71, v71, v20
    v_mul_f32 v84, v84, v20
    v_mul_f32 v85, v85, v20
    v_mul_f32 v86, v86, v20
    v_mul_f32 v87, v87, v20
    v_cvt_pk_bf16_f32 v116, v68, v69
    v_cvt_pk_bf16_f32 v117, v70, v71
    v_cvt_pk_bf16_f32 v118, v84, v85
    v_cvt_pk_bf16_f32 v119, v86, v87
    buffer_store_dwordx4 v[116:119], v7, s[16:19], s36 offen offset:128 sc1
    v_mul_f32 v72, v72, v20
    v_mul_f32 v73, v73, v20
    v_mul_f32 v74, v74, v20
    v_mul_f32 v75, v75, v20
    v_mul_f32 v88, v88, v20
    v_mul_f32 v89, v89, v20
    v_mul_f32 v90, v90, v20
    v_mul_f32 v91, v91, v20
    v_cvt_pk_bf16_f32 v120, v72, v73
    v_cvt_pk_bf16_f32 v121, v74, v75
    v_cvt_pk_bf16_f32 v122, v88, v89
    v_cvt_pk_bf16_f32 v123, v90, v91
    buffer_store_dwordx4 v[120:123], v7, s[16:19], s36 offen offset:2048 sc1
    v_mul_f32 v76, v76, v20
    v_mul_f32 v77, v77, v20
    v_mul_f32 v78, v78, v20
    v_mul_f32 v79, v79, v20
    v_mul_f32 v92, v92, v20
    v_mul_f32 v93, v93, v20
    v_mul_f32 v94, v94, v20
    v_mul_f32 v95, v95, v20
    v_cvt_pk_bf16_f32 v124, v76, v77
    v_cvt_pk_bf16_f32 v125, v78, v79
    v_cvt_pk_bf16_f32 v126, v92, v93
    v_cvt_pk_bf16_f32 v127, v94, v95
    buffer_store_dwordx4 v[124:127], v7, s[16:19], s36 offen offset:2176 sc1
    s_lshl_b32 s3, s22, 8
    s_lshl_b32 s28, s21, 3
    s_add_u32 s3, s3, s28
    s_add_u32 s3, s3, 4096
    v_mov_b32 v250, s3
    s_waitcnt vmcnt(0)
    s_add_u32 s56, s6, 0x1a00000
    s_addc_u32 s57, s7, 0
    s_mov_b32 s58, 0x6000
    s_mov_b32 s59, 0x20000
    s_barrier
    s_cmp_lg_u32 s20, 0
    s_cbranch_scc1 pub_skip_6
    s_mov_b64 exec, 1
    buffer_store_dwordx2 v[248:249], v250, s[56:59], 0 offen sc1
    s_mov_b64 exec, -1
pub_skip_6:
    s_waitcnt lgkmcnt(0)
    s_and_b32 s21, s2, 7
    s_lshl_b32 s21, s21, 2
    s_bfe_u32 s28, s2, 0x20003
    s_add_u32 s21, s21, s28
    s_lshr_b32 s22, s2, 5
    s_lshr_b32 s32, s2, 1
    s_and_b32 s33, s2, 1
    s_cmp_ge_u32 s32, 56
    s_cselect_b32 s48, s46, s44
    s_cselect_b32 s49, s47, s45
    s_cselect_b32 s34, 56, 0
    s_sub_u32 s34, s32, s34
    s_mov_b32 s51, 0x20000
    s_lshl_b32 s34, s34, 7
    s_mul_i32 s35, s33, 3670016
    s_add_u32 s34, s34, s35
    s_add_u32 s35, s35, 3670016
    s_cmp_lt_u32 s2, 224
    s_cselect_b32 s50, s35, 0
    s_mul_i32 s35, s31, 114688
    s_add_u32 s26, s34, s35
    v_lshrrev_b32 v7, 3, v1
    v_mul_u32_u24 v7, 7168, v7
    v_and_b32 v20, 7, v1
    v_lshlrev_b32 v21, 1, v2
    v_xor_b32 v20, v20, v21
    v_lshl_add_u32 v7, v20, 4, v7
    v_add_u32 v129, 56320, v7
    s_mov_b32 s52, s40
    s_mov_b32 s53, s41
    s_mov_b32 s54, 0x200000
    s_mov_b32 s55, 0x20000
    s_mov_b32 s44, s42
    s_mov_b32 s45, s43
    s_mov_b32 s46, 0x700000
    s_mov_b32 s47, 0x20000
    s_lshl_b32 s35, s2, 2
    s_add_u32 s35, s35, s31
    v_lshlrev_b32 v8, 7, v1
    v_mov_b32 v9, 0x7fffffff
    s_lshl_b32 s34, s35, 11
    v_add_u32 v130, s34, v8
    v_cmp_gt_u32 vcc, 16, v1
    s_lshl_b32 s60, s35, 10
    s_nop 0
    v_cndmask_b32 v130, v9, v130, vcc
    s_and_b32 s34, s35, 1
    s_lshl_b32 s34, s34, 3
    v_lshrrev_b32 v8, 3, v1
    v_add_u32 v8, s34, v8
    v_mul_u32_u24 v8, 458752, v8
    s_bfe_u32 s34, s35, 0x20002
    s_lshl_b32 s34, s34, 1
    v_and_b32 v9, 7, v1
    v_xor_b32 v9, s34, v9
    v_lshl_add_u32 v131, v9, 4, v8
    s_lshr_b32 s61, s35, 1
    s_lshl_b32 s61, s61, 7
    s_sub_u32 s61, s61, 65536
    s_lshl_b32 s28, s21, 17
    s_add_u32 s4, s6, s28
    s_addc_u32 s5, s7, 0
    s_add_u32 s8, s4, 0x800000
    s_addc_u32 s9, s5, 0
    s_mov_b32 s10, 0x20000
    s_mov_b32 s11, 0x20000
    s_add_u32 s12, s4, 0xc00000
    s_addc_u32 s13, s5, 0
    s_mov_b32 s14, 0x20000
    s_mov_b32 s15, 0x20000
    s_add_u32 s16, s4, 0x400000
    s_addc_u32 s17, s5, 0
    s_mov_b32 s18, 0x20000
    s_mov_b32 s19, 0x20000
    s_add_u32 s36, s6, 0x1000000
    s_addc_u32 s37, s7, 0
    s_mov_b32 s38, 0x400000
    s_mov_b32 s39, 0x20000
    s_lshl_b32 s25, s31, 12
    s_lshl_b32 s30, s31, 12
    v_lshrrev_b32 v16, 2, v1
    v_xor_b32 v16, v16, v2
    v_and_b32 v16, 1, v16
    v_cmp_eq_u32 vcc, 0, v16
    v_mov_b32 v17, 0x3f803f80
    s_nop 1
    v_cndmask_b32 v124, 0, v17, vcc
    v_cndmask_b32 v125, 0, v17, vcc
    v_cndmask_b32 v126, 0, v17, vcc
    v_cndmask_b32 v127, 0, v17, vcc
    v_mov_b32 v104, 0
    v_mov_b32 v105, 0
    v_mov_b32 v106, 0
    v_mov_b32 v107, 0
    v_mov_b32 v108, 0
    v_mov_b32 v109, 0
    v_mov_b32 v110, 0
    v_mov_b32 v111, 0
    v_mov_b32 v112, 0
    v_mov_b32 v113, 0
    v_mov_b32 v114, 0
    v_mov_b32 v115, 0
    v_mov_b32 v116, 0
    v_mov_b32 v117, 0
    v_mov_b32 v118, 0
    v_mov_b32 v119, 0
    v_mov_b32 v120, 0
    v_mov_b32 v121, 0
    v_mov_b32 v122, 0
    v_mov_b32 v123, 0
    v_mov_b32 v84, 0
    v_mov_b32 v85, 0
    v_mov_b32 v86, 0
    v_mov_b32 v87, 0
    v_mov_b32 v100, 0
    v_mov_b32 v101, 0
    v_mov_b32 v102, 0
    v_mov_b32 v103, 0
    v_mov_b32 v16, v6
    v_add_u32 v17, 32768, v6
    s_mov_b32 s23, 32768
    s_lshr_b32 s34, s21, 1
    s_lshl_b32 s35, s22, 3
    s_add_u32 s35, s35, s20
    s_lshl_b32 s35, s35, 11
    s_cmp_lg_u32 s20, 0
    s_cbranch_scc1 wf_skip_7
    s_add_u32 s56, s6, 0x1a00000
    s_addc_u32 s57, s7, 0
    s_mov_b32 s58, 0x6000
    s_mov_b32 s59, 0x20000
    s_lshl_b32 s3, s34, 8
    s_add_u32 s3, s3, 4096
    v_and_b32 v22, 15, v0
    v_lshlrev_b32 v22, 3, v22
    v_lshlrev_b32 v23, 3, v0
    s_mov_b32 s28, 262144
    buffer_load_dwordx2 v[252:253], v22, s[56:59], s3 offen sc1
wf_loop_8:
    s_waitcnt vmcnt(0)
    v_cmp_ne_u64 vcc, s[62:63], v[252:253]
    s_nop 1
    s_cmp_eq_u64 vcc, 0
    s_cbranch_scc1 wf_skip_7
    s_sleep 1
    buffer_load_dwordx2 v[252:253], v22, s[56:59], s3 offen sc1
    s_sub_u32 s28, s28, 1
    s_cmp_lg_u32 s28, 0
    s_cbranch_scc1 wf_loop_8
wf_skip_7:
    s_barrier
    s_add_u32 s56, s6, 0x4000000
    s_addc_u32 s57, s7, 0
    s_mov_b32 s58, 0x700000
    s_mov_b32 s59, 0x20000
    s_mov_b32 s24, s30
    s_lshl_b32 s29, s31, 11
    s_add_u32 s29, s29, 98304
    s_cmp_eq_u32 s20, 0
    s_cbranch_scc1 at_W0
    buffer_load_dwordx4 v[8:11], v6, s[16:19], s35 offen sc1
    buffer_load_dwordx4 v[12:15], v6, s[16:19], s35 offen offset:1024 sc1
    s_cmp_ge_u32 s20, 4
    s_cbranch_scc1 at_B0
    s_add_u32 m0, s24, 0
    s_nop 0
    buffer_load_dwordx4 v6, s[8:11], s25 offen offset:0 sc1 lds
    buffer_load_dwordx4 v6, s[8:11], s25 offen offset:1024 sc1 lds
    buffer_load_dwordx4 v6, s[8:11], s25 offen offset:2048 sc1 lds
    buffer_load_dwordx4 v6, s[8:11], s25 offen offset:3072 sc1 lds
    s_waitcnt vmcnt(4)
    s_branch at_C0
at_B0:
    s_add_u32 m0, s24, 16384
    s_nop 0
    buffer_load_dwordx4 v6, s[12:15], s25 offen offset:0 sc1 lds
    buffer_load_dwordx4 v6, s[12:15], s25 offen offset:1024 sc1 lds
    buffer_load_dwordx4 v6, s[12:15], s25 offen offset:2048 sc1 lds
    buffer_load_dwordx4 v6, s[12:15], s25 offen offset:3072 sc1 lds
    s_waitcnt vmcnt(4)
    s_branch at_C0
at_W0:
    s_add_u32 m0, s24, 0
    s_nop 0
    buffer_load_dwordx4 v6, s[8:11], s25 offen offset:0 sc1 lds
    buffer_load_dwordx4 v6, s[8:11], s25 offen offset:1024 sc1 lds
    buffer_load_dwordx4 v6, s[8:11], s25 offen offset:2048 sc1 lds
    buffer_load_dwordx4 v6, s[8:11], s25 offen offset:3072 sc1 lds
    buffer_load_dwordx4 v[8:11], v6, s[16:19], s35 offen sc1
    buffer_load_dwordx4 v[12:15], v6, s[16:19], s35 offen offset:1024 sc1
    s_waitcnt vmcnt(0)
at_C0:
    s_add_u32 s25, s25, 16384
    s_add_u32 s24, s24, 32768
    s_cmp_ge_u32 s24, 98304
    s_cselect_b32 s24, s30, s24
    s_barrier
    ds_read_b128 v[64:67], v16 offset:0
    ds_read_b128 v[68:71], v16 offset:1024
    ds_read_b128 v[88:91], v16 offset:2048
    ds_read_b128 v[92:95], v16 offset:3072
    s_waitcnt lgkmcnt(2)
    v_mfma_f32_32x32x16_bf16 v[48:63], v[64:67], v[8:11], 0
    v_mfma_f32_32x32x16_bf16 v[48:63], v[68:71], v[12:15], v[48:63]
    s_nop 15
    s_nop 3
    v_max3_f32 v18, v48, v49, v50
    v_max3_f32 v18, v18, v51, v52
    v_max3_f32 v18, v18, v53, v54
    v_max3_f32 v18, v18, v55, v56
    v_max3_f32 v18, v18, v57, v58
    v_max3_f32 v18, v18, v59, v60
    v_max3_f32 v18, v18, v61, v62
    v_max_f32 v18, v18, v63
    v_mov_b32 v19, v18
    s_nop 1
    v_permlane32_swap_b32 v19, v18
    s_nop 1
    v_max_f32 v18, v18, v19
    v_sub_f32 v32, 0, v18
    v_sub_f32 v33, 0, v18
    v_sub_f32 v34, 0, v18
    v_sub_f32 v35, 0, v18
    v_sub_f32 v36, 0, v18
    v_sub_f32 v37, 0, v18
    v_sub_f32 v38, 0, v18
    v_sub_f32 v39, 0, v18
    v_sub_f32 v40, 0, v18
    v_sub_f32 v41, 0, v18
    v_sub_f32 v42, 0, v18
    v_sub_f32 v43, 0, v18
    v_sub_f32 v44, 0, v18
    v_sub_f32 v45, 0, v18
    v_sub_f32 v46, 0, v18
    v_sub_f32 v47, 0, v18
    v_sub_f32 v48, v48, v18
    v_sub_f32 v49, v49, v18
    v_sub_f32 v50, v50, v18
    v_sub_f32 v51, v51, v18
    v_sub_f32 v52, v52, v18
    v_sub_f32 v53, v53, v18
    v_sub_f32 v54, v54, v18
    v_sub_f32 v55, v55, v18
    v_sub_f32 v56, v56, v18
    v_sub_f32 v57, v57, v18
    v_sub_f32 v58, v58, v18
    v_sub_f32 v59, v59, v18
    v_sub_f32 v60, v60, v18
    v_sub_f32 v61, v61, v18
    v_sub_f32 v62, v62, v18
    v_sub_f32 v63, v63, v18
    s_mov_b32 s27, 8
    s_waitcnt vmcnt(0)
    s_barrier
    ds_read_b128 v[96:99], v16 offset:16384
    s_cmp_ge_u32 s20, 4
    s_cbranch_scc1 at_C1
    s_add_u32 m0, s24, 0
    s_nop 0
    buffer_load_dwordx4 v6, s[8:11], s25 offen offset:0 sc1 lds
    buffer_load_dwordx4 v6, s[8:11], s25 offen offset:1024 sc1 lds
    buffer_load_dwordx4 v6, s[8:11], s25 offen offset:2048 sc1 lds
    buffer_load_dwordx4 v6, s[8:11], s25 offen offset:3072 sc1 lds
    buffer_load_dword v128, v130, s[52:55], 0 offen
    s_mov_b32 m0, s29
    s_add_u32 s29, s29, 8192
    buffer_load_dwordx4 v7, s[48:51], s26 offen lds
    buffer_load_dwordx4 v129, s[48:51], s26 offen offset:1024 lds
    s_add_u32 s26, s26, 458752
at_C1:
    s_cmp_ge_u32 s20, 4
    s_cbranch_scc1 attn_preB
.p2align 6
attn_loopA:
    s_waitcnt lgkmcnt(2)
    v_mfma_f32_32x32x16_bf16 v[64:79], v[88:91], v[8:11], v[32:47]
    ds_read_b128 v[88:91], v16 offset:4096
    v_exp_f32 v48, v48
    v_exp_f32 v49, v49
    v_exp_f32 v50, v50
    v_mfma_f32_32x32x16_bf16 v[104:119], v[100:103], v[84:87], v[104:119]
    ds_read_b128 v[100:103], v16 offset:17408
    s_add_u32 m0, s24, 16384
    s_nop 0
    buffer_load_dwordx4 v6, s[12:15], s25 offen offset:0 sc1 lds
    v_exp_f32 v51, v51
    v_exp_f32 v52, v52
    v_exp_f32 v53, v53
    v_exp_f32 v54, v54
    s_waitcnt lgkmcnt(2)
    v_mfma_f32_32x32x16_bf16 v[64:79], v[92:95], v[12:15], v[64:79]
    ds_read_b128 v[92:95], v16 offset:5120
    v_exp_f32 v55, v55
    v_cvt_pk_bf16_f32 v80, v48, v49
    v_cvt_pk_bf16_f32 v81, v50, v51
    v_cvt_pk_bf16_f32 v82, v52, v53
    v_cvt_pk_bf16_f32 v83, v54, v55
    v_exp_f32 v56, v56
    v_mfma_f32_16x16x32_bf16 v[120:123], v[124:127], v[84:87], v[120:123]
    v_exp_f32 v57, v57
    v_exp_f32 v58, v58
    v_mfma_f32_32x32x16_bf16 v[104:119], v[96:99], v[80:83], v[104:119]
    ds_read_b128 v[96:99], v16 offset:18432
    buffer_load_dwordx4 v6, s[12:15], s25 offen offset:1024 sc1 lds
    v_exp_f32 v59, v59
    v_exp_f32 v60, v60
    v_exp_f32 v61, v61
    v_exp_f32 v62, v62
    v_mfma_f32_16x16x32_bf16 v[120:123], v[124:127], v[80:83], v[120:123]
    v_exp_f32 v63, v63
    v_cvt_pk_bf16_f32 v84, v56, v57
    v_cvt_pk_bf16_f32 v85, v58, v59
    v_cvt_pk_bf16_f32 v86, v60, v61
    v_cvt_pk_bf16_f32 v87, v62, v63
    s_waitcnt lgkmcnt(2)
    v_mfma_f32_32x32x16_bf16 v[48:63], v[88:91], v[8:11], v[32:47]
    ds_read_b128 v[88:91], v16 offset:6144
    v_exp_f32 v64, v64
    v_exp_f32 v65, v65
    v_exp_f32 v66, v66
    v_mfma_f32_32x32x16_bf16 v[104:119], v[100:103], v[84:87], v[104:119]
    ds_read_b128 v[100:103], v16 offset:19456
    buffer_load_dwordx4 v6, s[12:15], s25 offen offset:2048 sc1 lds
    v_exp_f32 v67, v67
    v_exp_f32 v68, v68
    v_exp_f32 v69, v69
    v_exp_f32 v70, v70
    s_waitcnt lgkmcnt(2)
    v_mfma_f32_32x32x16_bf16 v[48:63], v[92:95], v[12:15], v[48:63]
    ds_read_b128 v[92:95], v16 offset:7168
    v_exp_f32 v71, v71
    v_cvt_pk_bf16_f32 v80, v64, v65
    v_cvt_pk_bf16_f32 v81, v66, v67
    v_cvt_pk_bf16_f32 v82, v68, v69
    v_cvt_pk_bf16_f32 v83, v70, v71
    v_exp_f32 v72, v72
    v_mfma_f32_16x16x32_bf16 v[120:123], v[124:127], v[84:87], v[120:123]
    v_exp_f32 v73, v73
    v_exp_f32 v74, v74
    v_mfma_f32_32x32x16_bf16 v[104:119], v[96:99], v[80:83], v[104:119]
    ds_read_b128 v[96:99], v16 offset:20480
    buffer_load_dwordx4 v6, s[12:15], s25 offen offset:3072 sc1 lds
    s_add_u32 s25, s25, 16384
    s_add_u32 s24, s24, 32768
    s_cmp_ge_u32 s24, 98304
    s_cselect_b32 s24, s30, s24
    v_exp_f32 v75, v75
    v_exp_f32 v76, v76
    v_exp_f32 v77, v77
    v_exp_f32 v78, v78
    v_mfma_f32_16x16x32_bf16 v[120:123], v[124:127], v[80:83], v[120:123]
    v_exp_f32 v79, v79
    v_cvt_pk_bf16_f32 v84, v72, v73
    v_cvt_pk_bf16_f32 v85, v74, v75
    v_cvt_pk_bf16_f32 v86, v76, v77
    v_cvt_pk_bf16_f32 v87, v78, v79
    s_waitcnt lgkmcnt(2)
    v_mfma_f32_32x32x16_bf16 v[64:79], v[88:91], v[8:11], v[32:47]
    ds_read_b128 v[88:91], v16 offset:8192
    v_exp_f32 v48, v48
    v_exp_f32 v49, v49
    v_exp_f32 v50, v50
    v_mfma_f32_32x32x16_bf16 v[104:119], v[100:103], v[84:87], v[104:119]
    ds_read_b128 v[100:103], v16 offset:21504
    s_waitcnt vmcnt(10)
    s_cmp_lt_u32 s61, 458752
    s_cselect_b32 s58, 7340032, 0
    buffer_store_dwordx4 v[140:143], v131, s[56:59], s61 offen sc1
    s_add_u32 s61, s61, 65536
    v_exp_f32 v51, v51
    v_exp_f32 v52, v52
    v_exp_f32 v53, v53
    v_exp_f32 v54, v54
    s_waitcnt lgkmcnt(2)
    v_mfma_f32_32x32x16_bf16 v[64:79], v[92:95], v[12:15], v[64:79]
    ds_read_b128 v[92:95], v16 offset:9216
    v_exp_f32 v55, v55
    v_cvt_pk_bf16_f32 v80, v48, v49
    v_cvt_pk_bf16_f32 v81, v50, v51
    v_cvt_pk_bf16_f32 v82, v52, v53
    v_cvt_pk_bf16_f32 v83, v54, v55
    v_exp_f32 v56, v56
    v_mfma_f32_16x16x32_bf16 v[120:123], v[124:127], v[84:87], v[120:123]
    v_exp_f32 v57, v57
    v_exp_f32 v58, v58
    v_mfma_f32_32x32x16_bf16 v[104:119], v[96:99], v[80:83], v[104:119]
    ds_read_b128 v[96:99], v16 offset:22528
    buffer_load_dwordx4 v[140:143], v6, s[44:47], s60 offen
    s_add_u32 s60, s60, 1048576
    v_exp_f32 v59, v59
    v_exp_f32 v60, v60
    v_exp_f32 v61, v61
    v_exp_f32 v62, v62
    v_mfma_f32_16x16x32_bf16 v[120:123], v[124:127], v[80:83], v[120:123]
    v_exp_f32 v63, v63
    v_cvt_pk_bf16_f32 v84, v56, v57
    v_cvt_pk_bf16_f32 v85, v58, v59
    v_cvt_pk_bf16_f32 v86, v60, v61
    v_cvt_pk_bf16_f32 v87, v62, v63
    s_waitcnt lgkmcnt(2)
    v_mfma_f32_32x32x16_bf16 v[48:63], v[88:91], v[8:11], v[32:47]
    ds_read_b128 v[88:91], v16 offset:10240
    v_exp_f32 v64, v64
    v_exp_f32 v65, v65
    v_exp_f32 v66, v66
    v_mfma_f32_32x32x16_bf16 v[104:119], v[100:103], v[84:87], v[104:119]
    ds_read_b128 v[100:103], v16 offset:23552
    s_mov_b32 m0, s29
    s_add_u32 s29, s29, 8192
    buffer_load_dwordx4 v7, s[48:51], s26 offen lds
    v_exp_f32 v67, v67
    v_exp_f32 v68, v68
    v_exp_f32 v69, v69
    v_exp_f32 v70, v70
    s_waitcnt lgkmcnt(2)
    v_mfma_f32_32x32x16_bf16 v[48:63], v[92:95], v[12:15], v[48:63]
    ds_read_b128 v[92:95], v16 offset:11264
    v_exp_f32 v71, v71
    v_cvt_pk_bf16_f32 v80, v64, v65
    v_cvt_pk_bf16_f32 v81, v66, v67
    v_cvt_pk_bf16_f32 v82, v68, v69
    v_cvt_pk_bf16_f32 v83, v70, v71
    v_exp_f32 v72, v72
    v_mfma_f32_16x16x32_bf16 v[120:123], v[124:127], v[84:87], v[120:123]
    v_exp_f32 v73, v73
    v_exp_f32 v74, v74
    v_mfma_f32_32x32x16_bf16 v[104:119], v[96:99], v[80:83], v[104:119]
    ds_read_b128 v[96:99], v16 offset:24576
    buffer_load_dwordx4 v129, s[48:51], s26 offen offset:1024 lds
    s_add_u32 s26, s26, 458752
    v_exp_f32 v75, v75
    v_exp_f32 v76, v76
    v_exp_f32 v77, v77
    v_exp_f32 v78, v78
    v_mfma_f32_16x16x32_bf16 v[120:123], v[124:127], v[80:83], v[120:123]
    v_exp_f32 v79, v79
    v_cvt_pk_bf16_f32 v84, v72, v73
    v_cvt_pk_bf16_f32 v85, v74, v75
    v_cvt_pk_bf16_f32 v86, v76, v77
    v_cvt_pk_bf16_f32 v87, v78, v79
    s_waitcnt lgkmcnt(2)
    v_mfma_f32_32x32x16_bf16 v[64:79], v[88:91], v[8:11], v[32:47]
    ds_read_b128 v[88:91], v16 offset:12288
    v_exp_f32 v48, v48
    v_exp_f32 v49, v49
    v_exp_f32 v50, v50
    v_mfma_f32_32x32x16_bf16 v[104:119], v[100:103], v[84:87], v[104:119]
    ds_read_b128 v[100:103], v16 offset:25600
    v_exp_f32 v51, v51
    v_exp_f32 v52, v52
    v_exp_f32 v53, v53
    v_exp_f32 v54, v54
    s_waitcnt lgkmcnt(2)
    v_mfma_f32_32x32x16_bf16 v[64:79], v[92:95], v[12:15], v[64:79]
    ds_read_b128 v[92:95], v16 offset:13312
    v_exp_f32 v55, v55
    v_cvt_pk_bf16_f32 v80, v48, v49
    v_cvt_pk_bf16_f32 v81, v50, v51
    v_cvt_pk_bf16_f32 v82, v52, v53
    v_cvt_pk_bf16_f32 v83, v54, v55
    v_exp_f32 v56, v56
    v_mfma_f32_16x16x32_bf16 v[120:123], v[124:127], v[84:87], v[120:123]
    v_exp_f32 v57, v57
    v_exp_f32 v58, v58
    v_mfma_f32_32x32x16_bf16 v[104:119], v[96:99], v[80:83], v[104:119]
    ds_read_b128 v[96:99], v16 offset:26624
    v_exp_f32 v59, v59
    v_exp_f32 v60, v60
    v_exp_f32 v61, v61
    v_exp_f32 v62, v62
    v_mfma_f32_16x16x32_bf16 v[120:123], v[124:127], v[80:83], v[120:123]
    v_exp_f32 v63, v63
    v_cvt_pk_bf16_f32 v84, v56, v57
    v_cvt_pk_bf16_f32 v85, v58, v59
    v_cvt_pk_bf16_f32 v86, v60, v61
    v_cvt_pk_bf16_f32 v87, v62, v63
    s_waitcnt lgkmcnt(2)
    v_mfma_f32_32x32x16_bf16 v[48:63], v[88:91], v[8:11], v[32:47]
    ds_read_b128 v[88:91], v16 offset:14336
    v_exp_f32 v64, v64
    v_exp_f32 v65, v65
    v_exp_f32 v66, v66
    v_mfma_f32_32x32x16_bf16 v[104:119], v[100:103], v[84:87], v[104:119]
    ds_read_b128 v[100:103], v16 offset:27648
    v_exp_f32 v67, v67
    v_exp_f32 v68, v68
    v_exp_f32 v69, v69
    v_exp_f32 v70, v70
    s_waitcnt lgkmcnt(2)
    v_mfma_f32_32x32x16_bf16 v[48:63], v[92:95], v[12:15], v[48:63]
    ds_read_b128 v[92:95], v16 offset:15360
    v_exp_f32 v71, v71
    v_cvt_pk_bf16_f32 v80, v64, v65
    v_cvt_pk_bf16_f32 v81, v66, v67
    v_cvt_pk_bf16_f32 v82, v68, v69
    v_cvt_pk_bf16_f32 v83, v70, v71
    v_exp_f32 v72, v72
    v_mfma_f32_16x16x32_bf16 v[120:123], v[124:127], v[84:87], v[120:123]
    v_exp_f32 v73, v73
    v_exp_f32 v74, v74
    v_mfma_f32_32x32x16_bf16 v[104:119], v[96:99], v[80:83], v[104:119]
    ds_read_b128 v[96:99], v16 offset:28672
    v_exp_f32 v75, v75
    v_exp_f32 v76, v76
    v_exp_f32 v77, v77
    v_exp_f32 v78, v78
    v_mfma_f32_16x16x32_bf16 v[120:123], v[124:127], v[80:83], v[120:123]
    v_exp_f32 v79, v79
    v_cvt_pk_bf16_f32 v84, v72, v73
    v_cvt_pk_bf16_f32 v85, v74, v75
    v_cvt_pk_bf16_f32 v86, v76, v77
    v_cvt_pk_bf16_f32 v87, v78, v79
    s_waitcnt vmcnt(4)
    s_barrier
    s_waitcnt lgkmcnt(2)
    v_mfma_f32_32x32x16_bf16 v[64:79], v[88:91], v[8:11], v[32:47]
    ds_read_b128 v[88:91], v17 offset:0
    v_exp_f32 v48, v48
    v_exp_f32 v49, v49
    v_exp_f32 v50, v50
    v_mfma_f32_32x32x16_bf16 v[104:119], v[100:103], v[84:87], v[104:119]
    ds_read_b128 v[100:103], v16 offset:29696
    s_add_u32 m0, s24, 0
    s_nop 0
    buffer_load_dwordx4 v6, s[8:11], s25 offen offset:0 sc1 lds
    v_exp_f32 v51, v51
    v_exp_f32 v52, v52
    v_exp_f32 v53, v53
    v_exp_f32 v54, v54
    s_waitcnt lgkmcnt(2)
    v_mfma_f32_32x32x16_bf16 v[64:79], v[92:95], v[12:15], v[64:79]
    ds_read_b128 v[92:95], v17 offset:1024
    v_exp_f32 v55, v55
    v_cvt_pk_bf16_f32 v80, v48, v49
    v_cvt_pk_bf16_f32 v81, v50, v51
    v_cvt_pk_bf16_f32 v82, v52, v53
    v_cvt_pk_bf16_f32 v83, v54, v55
    v_exp_f32 v56, v56
    v_mfma_f32_16x16x32_bf16 v[120:123], v[124:127], v[84:87], v[120:123]
    v_exp_f32 v57, v57
    v_exp_f32 v58, v58
    v_mfma_f32_32x32x16_bf16 v[104:119], v[96:99], v[80:83], v[104:119]
    ds_read_b128 v[96:99], v16 offset:30720
    buffer_load_dwordx4 v6, s[8:11], s25 offen offset:1024 sc1 lds
    v_exp_f32 v59, v59
    v_exp_f32 v60, v60
    v_exp_f32 v61, v61
    v_exp_f32 v62, v62
    v_mfma_f32_16x16x32_bf16 v[120:123], v[124:127], v[80:83], v[120:123]
    v_exp_f32 v63, v63
    v_cvt_pk_bf16_f32 v84, v56, v57
    v_cvt_pk_bf16_f32 v85, v58, v59
    v_cvt_pk_bf16_f32 v86, v60, v61
    v_cvt_pk_bf16_f32 v87, v62, v63
    s_waitcnt lgkmcnt(2)
    v_mfma_f32_32x32x16_bf16 v[48:63], v[88:91], v[8:11], v[32:47]
    ds_read_b128 v[88:91], v17 offset:2048
    v_exp_f32 v64, v64
    v_exp_f32 v65, v65
    v_exp_f32 v66, v66
    v_mfma_f32_32x32x16_bf16 v[104:119], v[100:103], v[84:87], v[104:119]
    ds_read_b128 v[100:103], v16 offset:31744
    buffer_load_dwordx4 v6, s[8:11], s25 offen offset:2048 sc1 lds
    v_exp_f32 v67, v67
    v_exp_f32 v68, v68
    v_exp_f32 v69, v69
    v_exp_f32 v70, v70
    s_waitcnt lgkmcnt(2)
    v_mfma_f32_32x32x16_bf16 v[48:63], v[92:95], v[12:15], v[48:63]
    ds_read_b128 v[92:95], v17 offset:3072
    v_exp_f32 v71, v71
    v_cvt_pk_bf16_f32 v80, v64, v65
    v_cvt_pk_bf16_f32 v81, v66, v67
    v_cvt_pk_bf16_f32 v82, v68, v69
    v_cvt_pk_bf16_f32 v83, v70, v71
    v_exp_f32 v72, v72
    v_mfma_f32_16x16x32_bf16 v[120:123], v[124:127], v[84:87], v[120:123]
    v_exp_f32 v73, v73
    v_exp_f32 v74, v74
    v_mfma_f32_32x32x16_bf16 v[104:119], v[96:99], v[80:83], v[104:119]
    ds_read_b128 v[96:99], v17 offset:16384
    buffer_load_dwordx4 v6, s[8:11], s25 offen offset:3072 sc1 lds
    v_exp_f32 v75, v75
    v_exp_f32 v76, v76
    v_exp_f32 v77, v77
    v_exp_f32 v78, v78
    v_mfma_f32_16x16x32_bf16 v[120:123], v[124:127], v[80:83], v[120:123]
    s_add_u32 s23, s23, 32768
    s_cmp_eq_u32 s23, 98304
    s_cselect_b32 s23, 0, s23
    v_mov_b32 v16, v17
    v_add_u32 v17, s23, v6
    s_sub_u32 s27, s27, 1
    s_cmp_lg_u32 s27, 0
    v_exp_f32 v79, v79
    v_cvt_pk_bf16_f32 v84, v72, v73
    v_cvt_pk_bf16_f32 v85, v74, v75
    v_cvt_pk_bf16_f32 v86, v76, v77
    v_cvt_pk_bf16_f32 v87, v78, v79
    s_cbranch_scc1 attn_loopA
    s_branch attn_post
attn_preB:
    v_lshrrev_b32 v252, 3, v1
    v_lshlrev_b32 v252, 11, v252
    v_and_b32 v251, 7, v1
    v_lshl_add_u32 v252, v251, 7, v252
    s_lshr_b32 s60, s2, 3
    s_lshl_b32 s60, s60, 2
    s_add_u32 s60, s60, s31
    s_lshl_b32 s60, s60, 14
    s_bfe_u32 s28, s2, 0x10002
    s_lshl_b32 s28, s28, 10
    s_add_u32 s60, s60, s28
.p2align 6
attn_loopB:
    s_waitcnt lgkmcnt(2)
    v_mfma_f32_32x32x16_bf16 v[64:79], v[88:91], v[8:11], v[32:47]
    ds_read_b128 v[88:91], v16 offset:4096
    v_exp_f32 v48, v48
    v_exp_f32 v49, v49
    v_exp_f32 v50, v50
    v_mfma_f32_32x32x16_bf16 v[104:119], v[100:103], v[84:87], v[104:119]
    ds_read_b128 v[100:103], v16 offset:17408
    v_exp_f32 v51, v51
    v_exp_f32 v52, v52
    v_exp_f32 v53, v53
    v_exp_f32 v54, v54
    s_waitcnt lgkmcnt(2)
    v_mfma_f32_32x32x16_bf16 v[64:79], v[92:95], v[12:15], v[64:79]
    ds_read_b128 v[92:95], v16 offset:5120
    v_exp_f32 v55, v55
    v_cvt_pk_bf16_f32 v80, v48, v49
    v_cvt_pk_bf16_f32 v81, v50, v51
    v_cvt_pk_bf16_f32 v82, v52, v53
    v_cvt_pk_bf16_f32 v83, v54, v55
    v_exp_f32 v56, v56
    v_mfma_f32_16x16x32_bf16 v[120:123], v[124:127], v[84:87], v[120:123]
    v_exp_f32 v57, v57
    v_exp_f32 v58, v58
    v_mfma_f32_32x32x16_bf16 v[104:119], v[96:99], v[80:83], v[104:119]
    ds_read_b128 v[96:99], v16 offset:18432
    v_exp_f32 v59, v59
    v_exp_f32 v60, v60
    v_exp_f32 v61, v61
    v_exp_f32 v62, v62
    v_mfma_f32_16x16x32_bf16 v[120:123], v[124:127], v[80:83], v[120:123]
    v_exp_f32 v63, v63
    v_cvt_pk_bf16_f32 v84, v56, v57
    v_cvt_pk_bf16_f32 v85, v58, v59
    v_cvt_pk_bf16_f32 v86, v60, v61
    v_cvt_pk_bf16_f32 v87, v62, v63
    s_waitcnt lgkmcnt(2)
    v_mfma_f32_32x32x16_bf16 v[48:63], v[88:91], v[8:11], v[32:47]
    ds_read_b128 v[88:91], v16 offset:6144
    v_exp_f32 v64, v64
    v_exp_f32 v65, v65
    v_exp_f32 v66, v66
    v_mfma_f32_32x32x16_bf16 v[104:119], v[100:103], v[84:87], v[104:119]
    ds_read_b128 v[100:103], v16 offset:19456
    v_exp_f32 v67, v67
    v_exp_f32 v68, v68
    v_exp_f32 v69, v69
    v_exp_f32 v70, v70
    s_waitcnt lgkmcnt(2)
    v_mfma_f32_32x32x16_bf16 v[48:63], v[92:95], v[12:15], v[48:63]
    ds_read_b128 v[92:95], v16 offset:7168
    v_exp_f32 v71, v71
    v_cvt_pk_bf16_f32 v80, v64, v65
    v_cvt_pk_bf16_f32 v81, v66, v67
    v_cvt_pk_bf16_f32 v82, v68, v69
    v_cvt_pk_bf16_f32 v83, v70, v71
    v_exp_f32 v72, v72
    v_mfma_f32_16x16x32_bf16 v[120:123], v[124:127], v[84:87], v[120:123]
    v_exp_f32 v73, v73
    v_exp_f32 v74, v74
    v_mfma_f32_32x32x16_bf16 v[104:119], v[96:99], v[80:83], v[104:119]
    ds_read_b128 v[96:99], v16 offset:20480
    v_exp_f32 v75, v75
    v_exp_f32 v76, v76
    v_exp_f32 v77, v77
    v_exp_f32 v78, v78
    v_mfma_f32_16x16x32_bf16 v[120:123], v[124:127], v[80:83], v[120:123]
    v_exp_f32 v79, v79
    v_cvt_pk_bf16_f32 v84, v72, v73
    v_cvt_pk_bf16_f32 v85, v74, v75
    v_cvt_pk_bf16_f32 v86, v76, v77
    v_cvt_pk_bf16_f32 v87, v78, v79
    s_waitcnt lgkmcnt(2)
    v_mfma_f32_32x32x16_bf16 v[64:79], v[88:91], v[8:11], v[32:47]
    ds_read_b128 v[88:91], v16 offset:8192
    v_exp_f32 v48, v48
    v_exp_f32 v49, v49
    v_exp_f32 v50, v50
    v_mfma_f32_32x32x16_bf16 v[104:119], v[100:103], v[84:87], v[104:119]
    ds_read_b128 v[100:103], v16 offset:21504
    v_exp_f32 v51, v51
    v_exp_f32 v52, v52
    v_exp_f32 v53, v53
    v_exp_f32 v54, v54
    s_waitcnt lgkmcnt(2)
    v_mfma_f32_32x32x16_bf16 v[64:79], v[92:95], v[12:15], v[64:79]
    ds_read_b128 v[92:95], v16 offset:9216
    v_exp_f32 v55, v55
    v_cvt_pk_bf16_f32 v80, v48, v49
    v_cvt_pk_bf16_f32 v81, v50, v51
    v_cvt_pk_bf16_f32 v82, v52, v53
    v_cvt_pk_bf16_f32 v83, v54, v55
    v_exp_f32 v56, v56
    v_mfma_f32_16x16x32_bf16 v[120:123], v[124:127], v[84:87], v[120:123]
    v_exp_f32 v57, v57
    v_exp_f32 v58, v58
    v_mfma_f32_32x32x16_bf16 v[104:119], v[96:99], v[80:83], v[104:119]
    ds_read_b128 v[96:99], v16 offset:22528
    v_exp_f32 v59, v59
    v_exp_f32 v60, v60
    v_exp_f32 v61, v61
    v_exp_f32 v62, v62
    v_mfma_f32_16x16x32_bf16 v[120:123], v[124:127], v[80:83], v[120:123]
    v_exp_f32 v63, v63
    v_cvt_pk_bf16_f32 v84, v56, v57
    v_cvt_pk_bf16_f32 v85, v58, v59
    v_cvt_pk_bf16_f32 v86, v60, v61
    v_cvt_pk_bf16_f32 v87, v62, v63
    s_waitcnt lgkmcnt(2)
    v_mfma_f32_32x32x16_bf16 v[48:63], v[88:91], v[8:11], v[32:47]
    ds_read_b128 v[88:91], v16 offset:10240
    v_exp_f32 v64, v64
    v_exp_f32 v65, v65
    v_exp_f32 v66, v66
    v_mfma_f32_32x32x16_bf16 v[104:119], v[100:103], v[84:87], v[104:119]
    ds_read_b128 v[100:103], v16 offset:23552
    v_exp_f32 v67, v67
    v_exp_f32 v68, v68
    v_exp_f32 v69, v69
    v_exp_f32 v70, v70
    s_waitcnt lgkmcnt(2)
    v_mfma_f32_32x32x16_bf16 v[48:63], v[92:95], v[12:15], v[48:63]
    ds_read_b128 v[92:95], v16 offset:11264
    v_exp_f32 v71, v71
    v_cvt_pk_bf16_f32 v80, v64, v65
    v_cvt_pk_bf16_f32 v81, v66, v67
    v_cvt_pk_bf16_f32 v82, v68, v69
    v_cvt_pk_bf16_f32 v83, v70, v71
    v_exp_f32 v72, v72
    v_mfma_f32_16x16x32_bf16 v[120:123], v[124:127], v[84:87], v[120:123]
    v_exp_f32 v73, v73
    v_exp_f32 v74, v74
    v_mfma_f32_32x32x16_bf16 v[104:119], v[96:99], v[80:83], v[104:119]
    ds_read_b128 v[96:99], v16 offset:24576
    v_exp_f32 v75, v75
    v_exp_f32 v76, v76
    v_exp_f32 v77, v77
    v_exp_f32 v78, v78
    v_mfma_f32_16x16x32_bf16 v[120:123], v[124:127], v[80:83], v[120:123]
    v_exp_f32 v79, v79
    v_cvt_pk_bf16_f32 v84, v72, v73
    v_cvt_pk_bf16_f32 v85, v74, v75
    v_cvt_pk_bf16_f32 v86, v76, v77
    v_cvt_pk_bf16_f32 v87, v78, v79
    s_waitcnt lgkmcnt(2)
    v_mfma_f32_32x32x16_bf16 v[64:79], v[88:91], v[8:11], v[32:47]
    ds_read_b128 v[88:91], v16 offset:12288
    v_exp_f32 v48, v48
    v_exp_f32 v49, v49
    v_exp_f32 v50, v50
    v_mfma_f32_32x32x16_bf16 v[104:119], v[100:103], v[84:87], v[104:119]
    ds_read_b128 v[100:103], v16 offset:25600
    v_exp_f32 v51, v51
    v_exp_f32 v52, v52
    v_exp_f32 v53, v53
    v_exp_f32 v54, v54
    s_waitcnt lgkmcnt(2)
    v_mfma_f32_32x32x16_bf16 v[64:79], v[92:95], v[12:15], v[64:79]
    ds_read_b128 v[92:95], v16 offset:13312
    v_exp_f32 v55, v55
    v_cvt_pk_bf16_f32 v80, v48, v49
    v_cvt_pk_bf16_f32 v81, v50, v51
    v_cvt_pk_bf16_f32 v82, v52, v53
    v_cvt_pk_bf16_f32 v83, v54, v55
    v_exp_f32 v56, v56
    v_mfma_f32_16x16x32_bf16 v[120:123], v[124:127], v[84:87], v[120:123]
    v_exp_f32 v57, v57
    v_exp_f32 v58, v58
    v_mfma_f32_32x32x16_bf16 v[104:119], v[96:99], v[80:83], v[104:119]
    ds_read_b128 v[96:99], v16 offset:26624
    v_exp_f32 v59, v59
    v_exp_f32 v60, v60
    v_exp_f32 v61, v61
    v_exp_f32 v62, v62
    v_mfma_f32_16x16x32_bf16 v[120:123], v[124:127], v[80:83], v[120:123]
    v_exp_f32 v63, v63
    v_cvt_pk_bf16_f32 v84, v56, v57
    v_cvt_pk_bf16_f32 v85, v58, v59
    v_cvt_pk_bf16_f32 v86, v60, v61
    v_cvt_pk_bf16_f32 v87, v62, v63
    s_waitcnt lgkmcnt(2)
    v_mfma_f32_32x32x16_bf16 v[48:63], v[88:91], v[8:11], v[32:47]
    ds_read_b128 v[88:91], v16 offset:14336
    v_exp_f32 v64, v64
    v_exp_f32 v65, v65
    v_exp_f32 v66, v66
    v_mfma_f32_32x32x16_bf16 v[104:119], v[100:103], v[84:87], v[104:119]
    ds_read_b128 v[100:103], v16 offset:27648
    v_exp_f32 v67, v67
    v_exp_f32 v68, v68
    v_exp_f32 v69, v69
    v_exp_f32 v70, v70
    s_waitcnt lgkmcnt(2)
    v_mfma_f32_32x32x16_bf16 v[48:63], v[92:95], v[12:15], v[48:63]
    ds_read_b128 v[92:95], v16 offset:15360
    v_exp_f32 v71, v71
    v_cvt_pk_bf16_f32 v80, v64, v65
    v_cvt_pk_bf16_f32 v81, v66, v67
    v_cvt_pk_bf16_f32 v82, v68, v69
    v_cvt_pk_bf16_f32 v83, v70, v71
    v_exp_f32 v72, v72
    v_mfma_f32_16x16x32_bf16 v[120:123], v[124:127], v[84:87], v[120:123]
    v_exp_f32 v73, v73
    v_exp_f32 v74, v74
    v_mfma_f32_32x32x16_bf16 v[104:119], v[96:99], v[80:83], v[104:119]
    ds_read_b128 v[96:99], v16 offset:28672
    v_exp_f32 v75, v75
    v_exp_f32 v76, v76
    v_exp_f32 v77, v77
    v_exp_f32 v78, v78
    v_mfma_f32_16x16x32_bf16 v[120:123], v[124:127], v[80:83], v[120:123]
    v_exp_f32 v79, v79
    v_cvt_pk_bf16_f32 v84, v72, v73
    v_cvt_pk_bf16_f32 v85, v74, v75
    v_cvt_pk_bf16_f32 v86, v76, v77
    v_cvt_pk_bf16_f32 v87, v78, v79
    s_barrier
    s_waitcnt lgkmcnt(2)
    v_mfma_f32_32x32x16_bf16 v[64:79], v[88:91], v[8:11], v[32:47]
    ds_read_b128 v[88:91], v17 offset:0
    v_exp_f32 v48, v48
    v_exp_f32 v49, v49
    v_exp_f32 v50, v50
    v_mfma_f32_32x32x16_bf16 v[104:119], v[100:103], v[84:87], v[104:119]
    ds_read_b128 v[100:103], v16 offset:29696
    v_exp_f32 v51, v51
    v_exp_f32 v52, v52
    v_exp_f32 v53, v53
    v_exp_f32 v54, v54
    s_waitcnt lgkmcnt(2)
    v_mfma_f32_32x32x16_bf16 v[64:79], v[92:95], v[12:15], v[64:79]
    ds_read_b128 v[92:95], v17 offset:1024
    v_exp_f32 v55, v55
    v_cvt_pk_bf16_f32 v80, v48, v49
    v_cvt_pk_bf16_f32 v81, v50, v51
    v_cvt_pk_bf16_f32 v82, v52, v53
    v_cvt_pk_bf16_f32 v83, v54, v55
    v_exp_f32 v56, v56
    v_mfma_f32_16x16x32_bf16 v[120:123], v[124:127], v[84:87], v[120:123]
    v_exp_f32 v57, v57
    v_exp_f32 v58, v58
    v_mfma_f32_32x32x16_bf16 v[104:119], v[96:99], v[80:83], v[104:119]
    ds_read_b128 v[96:99], v16 offset:30720
    v_exp_f32 v59, v59
    v_exp_f32 v60, v60
    v_exp_f32 v61, v61
    v_exp_f32 v62, v62
    v_mfma_f32_16x16x32_bf16 v[120:123], v[124:127], v[80:83], v[120:123]
    v_exp_f32 v63, v63
    v_cvt_pk_bf16_f32 v84, v56, v57
    v_cvt_pk_bf16_f32 v85, v58, v59
    v_cvt_pk_bf16_f32 v86, v60, v61
    v_cvt_pk_bf16_f32 v87, v62, v63
    s_waitcnt lgkmcnt(2)
    v_mfma_f32_32x32x16_bf16 v[48:63], v[88:91], v[8:11], v[32:47]
    ds_read_b128 v[88:91], v17 offset:2048
    v_exp_f32 v64, v64
    v_exp_f32 v65, v65
    v_exp_f32 v66, v66
    v_mfma_f32_32x32x16_bf16 v[104:119], v[100:103], v[84:87], v[104:119]
    ds_read_b128 v[100:103], v16 offset:31744
    s_cmp_lg_u32 s27, 2
    s_cbranch_scc1 at_nt
    buffer_load_dword v251, v252, s[52:55], s60 offen
    at_nt:
    v_exp_f32 v67, v67
    v_exp_f32 v68, v68
    v_exp_f32 v69, v69
    v_exp_f32 v70, v70
    s_waitcnt lgkmcnt(2)
    v_mfma_f32_32x32x16_bf16 v[48:63], v[92:95], v[12:15], v[48:63]
    ds_read_b128 v[92:95], v17 offset:3072
    v_exp_f32 v71, v71
    v_cvt_pk_bf16_f32 v80, v64, v65
    v_cvt_pk_bf16_f32 v81, v66, v67
    v_cvt_pk_bf16_f32 v82, v68, v69
    v_cvt_pk_bf16_f32 v83, v70, v71
    v_exp_f32 v72, v72
    v_mfma_f32_16x16x32_bf16 v[120:123], v[124:127], v[84:87], v[120:123]
    v_exp_f32 v73, v73
    v_exp_f32 v74, v74
    v_mfma_f32_32x32x16_bf16 v[104:119], v[96:99], v[80:83], v[104:119]
    ds_read_b128 v[96:99], v17 offset:16384
    v_exp_f32 v75, v75
    v_exp_f32 v76, v76
    v_exp_f32 v77, v77
    v_exp_f32 v78, v78
    v_mfma_f32_16x16x32_bf16 v[120:123], v[124:127], v[80:83], v[120:123]
    s_add_u32 s23, s23, 32768
    s_cmp_eq_u32 s23, 98304
    s_cselect_b32 s23, 0, s23
    v_mov_b32 v16, v17
    v_add_u32 v17, s23, v6
    s_sub_u32 s27, s27, 1
    s_cmp_lg_u32 s27, 0
    v_exp_f32 v79, v79
    v_cvt_pk_bf16_f32 v84, v72, v73
    v_cvt_pk_bf16_f32 v85, v74, v75
    v_cvt_pk_bf16_f32 v86, v76, v77
    v_cvt_pk_bf16_f32 v87, v78, v79
    s_cbranch_scc1 attn_loopB
attn_post:
    s_waitcnt lgkmcnt(0)
    s_nop 0
    v_mfma_f32_32x32x16_bf16 v[104:119], v[100:103], v[84:87], v[104:119]
    v_mfma_f32_16x16x32_bf16 v[120:123], v[124:127], v[84:87], v[120:123]
    s_nop 10
    v_add_f32 v18, |v104|, v120
    v_add_f32 v18, |v105|, v18
    v_add_f32 v18, |v106|, v18
    v_add_f32 v18, |v107|, v18
    v_add_f32 v18, |v108|, v18
    v_add_f32 v18, |v109|, v18
    v_add_f32 v18, |v110|, v18
    v_add_f32 v18, |v111|, v18
    v_add_f32 v18, |v112|, v18
    v_add_f32 v18, |v113|, v18
    v_add_f32 v18, |v114|, v18
    v_add_f32 v18, |v115|, v18
    v_add_f32 v18, |v116|, v18
    v_add_f32 v18, |v117|, v18
    v_add_f32 v18, |v118|, v18
    v_add_f32 v18, |v119|, v18
    v_mov_b32 v19, 0x7b800000
    v_cmp_nlt_f32 vcc, v18, v19
    s_nop 1
    s_cmp_eq_u64 vcc, 0
    s_cbranch_scc0 attn_slow
attn_fin:
    s_load_dwordx2 s[44:45], s[0:1], 0
    v_rcp_f32 v18, v120
    s_nop 0
    v_mul_f32 v104, v104, v18
    v_mul_f32 v105, v105, v18
    v_mul_f32 v106, v106, v18
    v_mul_f32 v107, v107, v18
    v_mul_f32 v108, v108, v18
    v_mul_f32 v109, v109, v18
    v_mul_f32 v110, v110, v18
    v_mul_f32 v111, v111, v18
    v_mul_f32 v112, v112, v18
    v_mul_f32 v113, v113, v18
    v_mul_f32 v114, v114, v18
    v_mul_f32 v115, v115, v18
    v_mul_f32 v116, v116, v18
    v_mul_f32 v117, v117, v18
    v_mul_f32 v118, v118, v18
    v_mul_f32 v119, v119, v18
    v_cvt_pk_bf16_f32 v80, v104, v105
    v_cvt_pk_bf16_f32 v81, v106, v107
    v_cvt_pk_bf16_f32 v82, v112, v113
    v_cvt_pk_bf16_f32 v83, v114, v115
    v_cvt_pk_bf16_f32 v84, v108, v109
    v_cvt_pk_bf16_f32 v85, v110, v111
    v_cvt_pk_bf16_f32 v86, v116, v117
    v_cvt_pk_bf16_f32 v87, v118, v119
    v_bfe_u32 v18, v1, 3, 1
    v_lshlrev_b32 v18, 10, v18
    v_bfe_u32 v19, v1, 4, 1
    v_lshl_add_u32 v18, v19, 7, v18
    v_and_b32 v19, 7, v1
    v_lshl_add_u32 v18, v19, 4, v18
    v_lshrrev_b32 v19, 5, v1
    v_lshl_add_u32 v18, v19, 8, v18
    s_lshl_b32 s28, s21, 17
    s_add_u32 s28, s28, s35
    buffer_store_dwordx4 v[80:83], v18, s[36:39], s28 offen sc1
    buffer_store_dwordx4 v[84:87], v18, s[36:39], s28 offen offset:512 sc1
    s_cmp_ge_u32 s20, 4
    s_cbranch_scc1 attn_nocs
    v_lshrrev_b32 v18, 2, v1
    v_lshlrev_b32 v18, 7, v18
    v_lshl_add_u32 v18, v4, 3, v18
    v_bfe_u32 v19, v1, 3, 2
    v_xor_b32 v19, s31, v19
    v_lshl_add_u32 v18, v19, 5, v18
    v_add_u32 v18, 98304, v18
    ds_read_b64_tr_b16 v[144:145], v18 offset:0
    ds_read_b64_tr_b16 v[146:147], v18 offset:2048
    ds_read_b64_tr_b16 v[148:149], v18 offset:4096
    ds_read_b64_tr_b16 v[150:151], v18 offset:6144
    ds_read_b64_tr_b16 v[152:153], v18 offset:8192
    ds_read_b64_tr_b16 v[154:155], v18 offset:10240
    ds_read_b64_tr_b16 v[156:157], v18 offset:12288
    ds_read_b64_tr_b16 v[158:159], v18 offset:14336
    ds_read_b64_tr_b16 v[160:161], v18 offset:16384
    ds_read_b64_tr_b16 v[162:163], v18 offset:18432
    ds_read_b64_tr_b16 v[164:165], v18 offset:20480
    ds_read_b64_tr_b16 v[166:167], v18 offset:22528
    ds_read_b64_tr_b16 v[168:169], v18 offset:24576
    ds_read_b64_tr_b16 v[170:171], v18 offset:26624
    ds_read_b64_tr_b16 v[172:173], v18 offset:28672
    ds_read_b64_tr_b16 v[174:175], v18 offset:30720
    ds_read_b64_tr_b16 v[176:177], v18 offset:32768
    ds_read_b64_tr_b16 v[178:179], v18 offset:34816
    ds_read_b64_tr_b16 v[180:181], v18 offset:36864
    ds_read_b64_tr_b16 v[182:183], v18 offset:38912
    ds_read_b64_tr_b16 v[184:185], v18 offset:40960
    ds_read_b64_tr_b16 v[186:187], v18 offset:43008
    ds_read_b64_tr_b16 v[188:189], v18 offset:45056
    ds_read_b64_tr_b16 v[190:191], v18 offset:47104
    ds_read_b64_tr_b16 v[192:193], v18 offset:49152
    ds_read_b64_tr_b16 v[194:195], v18 offset:51200
    ds_read_b64_tr_b16 v[196:197], v18 offset:53248
    ds_read_b64_tr_b16 v[198:199], v18 offset:55296
    ds_read_b64_tr_b16 v[200:201], v18 offset:57344
    ds_read_b64_tr_b16 v[202:203], v18 offset:59392
    ds_read_b64_tr_b16 v[204:205], v18 offset:61440
    ds_read_b64_tr_b16 v[206:207], v18 offset:63488
    v_mov_b32 v132, 0x3f803f80
    v_mov_b32 v133, 0x3f803f80
    v_mov_b32 v134, 0x3f803f80
    v_mov_b32 v135, 0x3f803f80
    s_add_u32 s48, s6, 0x1900000
    s_addc_u32 s49, s7, 0
    s_mov_b32 s50, 0x1c000
    s_mov_b32 s51, 0x20000
    s_mul_i32 s33, s33, 57344
    s_lshl_b32 s34, s32, 8
    s_add_u32 s33, s33, s34
    s_lshl_b32 s34, s31, 6
    s_add_u32 s33, s33, s34
    s_add_u32 s34, s33, 28672
    v_cmp_ne_u32 vcc, 0, v5
    v_mov_b32 v19, 0x7fffffff
    s_cmp_lt_u32 s2, 224
    s_cselect_b32 s50, 114688, 0
    v_cndmask_b32 v19, v1, v19, vcc
    s_waitcnt lgkmcnt(0)
    v_mfma_f32_16x16x32_bf16 v[136:139], v[144:147], v[132:135], 0
    v_mfma_f32_16x16x32_bf16 v[208:211], v[176:179], v[132:135], 0
    v_mfma_f32_16x16x32_bf16 v[136:139], v[148:151], v[132:135], v[136:139]
    v_mfma_f32_16x16x32_bf16 v[208:211], v[180:183], v[132:135], v[208:211]
    v_mfma_f32_16x16x32_bf16 v[136:139], v[152:155], v[132:135], v[136:139]
    v_mfma_f32_16x16x32_bf16 v[208:211], v[184:187], v[132:135], v[208:211]
    v_mfma_f32_16x16x32_bf16 v[136:139], v[156:159], v[132:135], v[136:139]
    v_mfma_f32_16x16x32_bf16 v[208:211], v[188:191], v[132:135], v[208:211]
    v_mfma_f32_16x16x32_bf16 v[136:139], v[160:163], v[132:135], v[136:139]
    v_mfma_f32_16x16x32_bf16 v[208:211], v[192:195], v[132:135], v[208:211]
    v_mfma_f32_16x16x32_bf16 v[136:139], v[164:167], v[132:135], v[136:139]
    v_mfma_f32_16x16x32_bf16 v[208:211], v[196:199], v[132:135], v[208:211]
    v_mfma_f32_16x16x32_bf16 v[136:139], v[168:171], v[132:135], v[136:139]
    v_mfma_f32_16x16x32_bf16 v[208:211], v[200:203], v[132:135], v[208:211]
    v_mfma_f32_16x16x32_bf16 v[136:139], v[172:175], v[132:135], v[136:139]
    v_mfma_f32_16x16x32_bf16 v[208:211], v[204:207], v[132:135], v[208:211]
    s_nop 7
    buffer_store_dwordx4 v[136:139], v19, s[48:51], s33 offen sc1
    buffer_store_dwordx4 v[208:211], v19, s[48:51], s34 offen sc1
attn_nocs:
    s_lshl_b32 s3, s22, 8
    s_lshl_b32 s28, s21, 3
    s_add_u32 s3, s3, s28
    s_add_u32 s3, s3, 8192
    v_mov_b32 v250, s3
    s_waitcnt vmcnt(0)
    s_add_u32 s56, s6, 0x1a00000
    s_addc_u32 s57, s7, 0
    s_mov_b32 s58, 0x6000
    s_mov_b32 s59, 0x20000
    s_barrier
    s_cmp_lg_u32 s20, 0
    s_cbranch_scc1 pub_skip_10
    s_mov_b64 exec, 1
    buffer_store_dwordx2 v[248:249], v250, s[56:59], 0 offen sc1
    s_mov_b64 exec, -1
pub_skip_10:
    s_waitcnt lgkmcnt(0)
    s_and_b32 s21, s2, 3
    s_lshl_b32 s21, s21, 2
    s_bfe_u32 s28, s2, 0x20003
    s_add_u32 s21, s21, s28
    s_bfe_u32 s22, s2, 0x10002
    s_lshl_b32 s22, s22, 3
    s_lshr_b32 s28, s2, 5
    s_add_u32 s22, s22, s28
    s_lshr_b32 s33, s20, 2
    s_lshl_b32 s34, s22, 1
    s_add_u32 s34, s34, s33
    s_lshl_b32 s34, s34, 7
    s_lshl_b32 s35, s21, 3
    s_add_u32 s34, s34, s35
    s_lshl_b32 s35, s31, 1
    s_add_u32 s34, s34, s35
    s_lshl_b32 s34, s34, 10
    s_lshl_b32 s35, s21, 18
    s_lshl_b32 s36, s31, 16
    s_add_u32 s35, s35, s36
    s_lshl_b32 s36, s22, 7
    s_add_u32 s35, s35, s36
    s_lshl_b32 s36, s33, 6
    s_add_u32 s35, s35, s36
    s_add_u32 s36, s35, 32768
    s_add_u32 s16, s6, 0x1400000
    s_addc_u32 s17, s7, 0
    s_mov_b32 s18, 0x400000
    s_mov_b32 s19, 0x20000
    s_mov_b32 s48, s44
    s_mov_b32 s49, s45
    s_mov_b32 s50, 0x400000
    s_mov_b32 s51, 0x20000
    s_mov_b32 s12, s40
    s_mov_b32 s13, s41
    s_mov_b32 s14, 0x200000
    s_mov_b32 s15, 0x20000
    s_add_u32 s8, s6, 0x1000000
    s_addc_u32 s9, s7, 0
    s_mov_b32 s10, 0x400000
    s_mov_b32 s11, 0x20000
    v_lshlrev_b32 v9, 11, v5
    v_and_b32 v15, 1, v2
    v_lshl_add_u32 v9, v15, 5, v9
    v_lshrrev_b32 v15, 1, v2
    v_lshl_add_u32 v9, v15, 4, v9
    s_lshl_b32 s28, s31, 11
    v_add_u32 v10, s28, v6
    v_lshl_add_u32 v11, v2, 2, v3
    v_lshlrev_b32 v11, 7, v11
    v_lshl_add_u32 v11, v4, 3, v11
    v_add_u32 v11, 16384, v11
    v_bfe_u32 v12, v1, 3, 2
    s_lshl_b32 s29, s33, 1
    v_xor_b32 v13, s29, v12
    v_lshl_add_u32 v13, v13, 5, v11
    v_xor_b32 v14, 32, v13
    s_lshr_b32 s32, s21, 1
    s_cmp_lt_u32 s20, 4
    s_cbranch_scc1 wo_A0
    v_lshrrev_b32 v7, 3, v1
    v_mul_u32_u24 v7, 2048, v7
    v_and_b32 v20, 7, v1
    v_lshlrev_b32 v21, 1, v2
    v_xor_b32 v20, v20, v21
    v_lshl_add_u32 v7, v20, 4, v7
    v_add_u32 v8, 15360, v7
    s_lshl_b32 s28, s31, 15
    s_lshl_b32 s29, s22, 7
    s_add_u32 s25, s28, s29
    s_lshl_b32 s30, s31, 11
    s_add_u32 s30, s30, 16384
    buffer_load_dwordx4 v[240:243], v9, s[48:51], s35 offen
    buffer_load_dwordx4 v[244:247], v9, s[48:51], s36 offen
    s_mov_b32 s24, 0
    s_add_u32 m0, s24, s30
    s_nop 0
    buffer_load_dwordx4 v7, s[12:15], s25 offen lds
    buffer_load_dwordx4 v8, s[12:15], s25 offen offset:1024 lds
    s_add_u32 s25, s25, 0x20000
    s_mov_b32 s24, 24576
    s_add_u32 m0, s24, s30
    s_nop 0
    buffer_load_dwordx4 v7, s[12:15], s25 offen lds
    buffer_load_dwordx4 v8, s[12:15], s25 offen offset:1024 lds
    s_add_u32 s25, s25, 0x20000
    s_mov_b32 s24, 49152
    s_add_u32 m0, s24, s30
    s_nop 0
    buffer_load_dwordx4 v7, s[12:15], s25 offen lds
    buffer_load_dwordx4 v8, s[12:15], s25 offen offset:1024 lds
    s_add_u32 s25, s25, 0x20000
    s_mov_b32 s24, 73728
    s_add_u32 m0, s24, s30
    s_nop 0
    buffer_load_dwordx4 v7, s[12:15], s25 offen lds
    buffer_load_dwordx4 v8, s[12:15], s25 offen offset:1024 lds
    s_add_u32 s25, s25, 0x20000
    s_mov_b32 s24, 98304
    s_add_u32 m0, s24, s30
    s_nop 0
    buffer_load_dwordx4 v7, s[12:15], s25 offen lds
    buffer_load_dwordx4 v8, s[12:15], s25 offen offset:1024 lds
    s_add_u32 s25, s25, 0x20000
    s_mov_b32 s24, 122880
    s_add_u32 m0, s24, s30
    s_nop 0
    buffer_load_dwordx4 v7, s[12:15], s25 offen lds
    buffer_load_dwordx4 v8, s[12:15], s25 offen offset:1024 lds
    s_add_u32 s25, s25, 0x20000
    s_branch wo_C0
wo_A0:
    s_lshr_b32 s28, s31, 1
    s_lshl_b32 s28, s28, 7
    s_lshl_b32 s29, s21, 3
    s_add_u32 s28, s28, s29
    s_and_b32 s29, s31, 1
    s_lshl_b32 s29, s29, 2
    s_add_u32 s28, s28, s29
    s_lshl_b32 s25, s28, 10
    s_lshl_b32 s30, s31, 12
    buffer_load_dwordx4 v[240:243], v9, s[48:51], s35 offen
    buffer_load_dwordx4 v[244:247], v9, s[48:51], s36 offen
wo_C0:
    s_cmp_lg_u32 s20, 0
    s_cbranch_scc1 wf_skip_11
    s_add_u32 s56, s6, 0x1a00000
    s_addc_u32 s57, s7, 0
    s_mov_b32 s58, 0x6000
    s_mov_b32 s59, 0x20000
    s_lshl_b32 s3, s32, 8
    s_add_u32 s3, s3, 8192
    v_and_b32 v22, 31, v0
    v_lshlrev_b32 v22, 3, v22
    v_lshlrev_b32 v23, 3, v0
    s_mov_b32 s28, 262144
    buffer_load_dwordx2 v[252:253], v22, s[56:59], s3 offen sc1
wf_loop_12:
    s_waitcnt vmcnt(0)
    v_cmp_ne_u64 vcc, s[62:63], v[252:253]
    s_nop 1
    s_cmp_eq_u64 vcc, 0
    s_cbranch_scc1 wf_skip_11
    s_sleep 1
    buffer_load_dwordx2 v[252:253], v22, s[56:59], s3 offen sc1
    s_sub_u32 s28, s28, 1
    s_cmp_lg_u32 s28, 0
    s_cbranch_scc1 wf_loop_12
wf_skip_11:
    s_barrier
    s_cmp_ge_u32 s20, 4
    s_cbranch_scc1 wo_B
    s_mov_b32 s24, 0
    s_add_u32 m0, s24, s30
    s_nop 0
    buffer_load_dwordx4 v6, s[8:11], s25 offen sc1 lds
    buffer_load_dwordx4 v6, s[8:11], s25 offen offset:1024 sc1 lds
    buffer_load_dwordx4 v6, s[8:11], s25 offen offset:2048 sc1 lds
    buffer_load_dwordx4 v6, s[8:11], s25 offen offset:3072 sc1 lds
    s_add_u32 s25, s25, 0x40000
    s_barrier
    s_mov_b32 s24, 24576
    s_add_u32 m0, s24, s30
    s_nop 0
    buffer_load_dwordx4 v6, s[8:11], s25 offen sc1 lds
    buffer_load_dwordx4 v6, s[8:11], s25 offen offset:1024 sc1 lds
    buffer_load_dwordx4 v6, s[8:11], s25 offen offset:2048 sc1 lds
    buffer_load_dwordx4 v6, s[8:11], s25 offen offset:3072 sc1 lds
    s_add_u32 s25, s25, 0x40000
    s_barrier
    s_mov_b32 s24, 49152
    s_add_u32 m0, s24, s30
    s_nop 0
    buffer_load_dwordx4 v6, s[8:11], s25 offen sc1 lds
    buffer_load_dwordx4 v6, s[8:11], s25 offen offset:1024 sc1 lds
    buffer_load_dwordx4 v6, s[8:11], s25 offen offset:2048 sc1 lds
    buffer_load_dwordx4 v6, s[8:11], s25 offen offset:3072 sc1 lds
    s_add_u32 s25, s25, 0x40000
    s_barrier
    s_mov_b32 s24, 73728
    s_add_u32 m0, s24, s30
    s_nop 0
    buffer_load_dwordx4 v6, s[8:11], s25 offen sc1 lds
    buffer_load_dwordx4 v6, s[8:11], s25 offen offset:1024 sc1 lds
    buffer_load_dwordx4 v6, s[8:11], s25 offen offset:2048 sc1 lds
    buffer_load_dwordx4 v6, s[8:11], s25 offen offset:3072 sc1 lds
    s_add_u32 s25, s25, 0x40000
    s_barrier
    s_mov_b32 s24, 98304
    s_add_u32 m0, s24, s30
    s_nop 0
    buffer_load_dwordx4 v6, s[8:11], s25 offen sc1 lds
    buffer_load_dwordx4 v6, s[8:11], s25 offen offset:1024 sc1 lds
    buffer_load_dwordx4 v6, s[8:11], s25 offen offset:2048 sc1 lds
    buffer_load_dwordx4 v6, s[8:11], s25 offen offset:3072 sc1 lds
    s_add_u32 s25, s25, 0x40000
    s_barrier
    s_mov_b32 s24, 122880
    s_add_u32 m0, s24, s30
    s_nop 0
    buffer_load_dwordx4 v6, s[8:11], s25 offen sc1 lds
    buffer_load_dwordx4 v6, s[8:11], s25 offen offset:1024 sc1 lds
    buffer_load_dwordx4 v6, s[8:11], s25 offen offset:2048 sc1 lds
    buffer_load_dwordx4 v6, s[8:11], s25 offen offset:3072 sc1 lds
    s_add_u32 s25, s25, 0x40000
    s_waitcnt vmcnt(24)
    v_permlane16_swap_b32 v240, v242
    v_permlane16_swap_b32 v241, v243
    v_permlane16_swap_b32 v244, v246
    v_permlane16_swap_b32 v245, v247
    s_nop 1
    v_lshlrev_b32 v32, 16, v240
    v_and_b32 v33, 0xffff0000, v240
    v_lshlrev_b32 v34, 16, v241
    v_and_b32 v35, 0xffff0000, v241
    v_lshlrev_b32 v36, 16, v242
    v_and_b32 v37, 0xffff0000, v242
    v_lshlrev_b32 v38, 16, v243
    v_and_b32 v39, 0xffff0000, v243
    v_lshlrev_b32 v40, 16, v244
    v_and_b32 v41, 0xffff0000, v244
    v_lshlrev_b32 v42, 16, v245
    v_and_b32 v43, 0xffff0000, v245
    v_lshlrev_b32 v44, 16, v246
    v_and_b32 v45, 0xffff0000, v246
    v_lshlrev_b32 v46, 16, v247
    v_and_b32 v47, 0xffff0000, v247
    s_mov_b32 s23, 0
    v_add_u32 v16, s23, v10
    v_add_u32 v17, s23, v13
    v_add_u32 v18, s23, v14
    s_waitcnt vmcnt(20)
    s_barrier
    ds_read_b64_tr_b16 v[64:65], v17 offset:0
    ds_read_b64_tr_b16 v[66:67], v17 offset:2048
    ds_read_b64_tr_b16 v[68:69], v18 offset:0
    ds_read_b64_tr_b16 v[70:71], v18 offset:2048
    ds_read_b128 v[48:51], v16 offset:0
    ds_read_b128 v[52:55], v16 offset:1024
    ds_read_b64_tr_b16 v[72:73], v17 offset:4096
    ds_read_b64_tr_b16 v[74:75], v17 offset:6144
    ds_read_b64_tr_b16 v[76:77], v18 offset:4096
    ds_read_b64_tr_b16 v[78:79], v18 offset:6144
    ds_read_b128 v[56:59], v16 offset:8192
    ds_read_b128 v[60:63], v16 offset:9216
    s_mov_b32 s24, s23
    s_add_u32 s23, s23, 24576
    s_cmp_eq_u32 s23, 147456
    s_cselect_b32 s23, 0, s23
    v_add_u32 v16, s23, v10
    v_add_u32 v17, s23, v13
    v_add_u32 v18, s23, v14
    s_mov_b32 s27, 5
.p2align 6
wo_loopA:
    s_waitcnt vmcnt(16) lgkmcnt(0)
    s_barrier
    v_mfma_f32_16x16x32_bf16 v[32:35], v[64:67], v[48:51], v[32:35]
    ds_read_b64_tr_b16 v[96:97], v17 offset:0
    ds_read_b64_tr_b16 v[98:99], v17 offset:2048
    v_mfma_f32_16x16x32_bf16 v[40:43], v[64:67], v[52:55], v[40:43]
    ds_read_b64_tr_b16 v[100:101], v18 offset:0
    ds_read_b64_tr_b16 v[102:103], v18 offset:2048
    v_mfma_f32_16x16x32_bf16 v[44:47], v[68:71], v[52:55], v[44:47]
    ds_read_b128 v[80:83], v16 offset:0
    ds_read_b128 v[84:87], v16 offset:1024
    v_mfma_f32_16x16x32_bf16 v[36:39], v[68:71], v[48:51], v[36:39]
    ds_read_b64_tr_b16 v[104:105], v17 offset:4096
    ds_read_b64_tr_b16 v[106:107], v17 offset:6144
    v_mfma_f32_16x16x32_bf16 v[32:35], v[72:75], v[56:59], v[32:35]
    ds_read_b64_tr_b16 v[108:109], v18 offset:4096
    ds_read_b64_tr_b16 v[110:111], v18 offset:6144
    v_mfma_f32_16x16x32_bf16 v[40:43], v[72:75], v[60:63], v[40:43]
    ds_read_b128 v[88:91], v16 offset:8192
    ds_read_b128 v[92:95], v16 offset:9216
    v_mfma_f32_16x16x32_bf16 v[44:47], v[76:79], v[60:63], v[44:47]
    v_mfma_f32_16x16x32_bf16 v[36:39], v[76:79], v[56:59], v[36:39]
    s_add_u32 m0, s24, s30
    s_mov_b32 s24, s23
    s_add_u32 s23, s23, 24576
    s_cmp_eq_u32 s23, 147456
    s_cselect_b32 s23, 0, s23
    v_add_u32 v16, s23, v10
    v_add_u32 v17, s23, v13
    v_add_u32 v18, s23, v14
    buffer_load_dwordx4 v6, s[8:11], s25 offen sc1 lds
    buffer_load_dwordx4 v6, s[8:11], s25 offen offset:1024 sc1 lds
    buffer_load_dwordx4 v6, s[8:11], s25 offen offset:2048 sc1 lds
    buffer_load_dwordx4 v6, s[8:11], s25 offen offset:3072 sc1 lds
    s_add_u32 s25, s25, 0x40000
    s_waitcnt vmcnt(16) lgkmcnt(0)
    s_barrier
    v_mfma_f32_16x16x32_bf16 v[32:35], v[96:99], v[80:83], v[32:35]
    ds_read_b64_tr_b16 v[64:65], v17 offset:0
    ds_read_b64_tr_b16 v[66:67], v17 offset:2048
    v_mfma_f32_16x16x32_bf16 v[40:43], v[96:99], v[84:87], v[40:43]
    ds_read_b64_tr_b16 v[68:69], v18 offset:0
    ds_read_b64_tr_b16 v[70:71], v18 offset:2048
    v_mfma_f32_16x16x32_bf16 v[44:47], v[100:103], v[84:87], v[44:47]
    ds_read_b128 v[48:51], v16 offset:0
    ds_read_b128 v[52:55], v16 offset:1024
    v_mfma_f32_16x16x32_bf16 v[36:39], v[100:103], v[80:83], v[36:39]
    ds_read_b64_tr_b16 v[72:73], v17 offset:4096
    ds_read_b64_tr_b16 v[74:75], v17 offset:6144
    v_mfma_f32_16x16x32_bf16 v[32:35], v[104:107], v[88:91], v[32:35]
    ds_read_b64_tr_b16 v[76:77], v18 offset:4096
    ds_read_b64_tr_b16 v[78:79], v18 offset:6144
    v_mfma_f32_16x16x32_bf16 v[40:43], v[104:107], v[92:95], v[40:43]
    ds_read_b128 v[56:59], v16 offset:8192
    ds_read_b128 v[60:63], v16 offset:9216
    v_mfma_f32_16x16x32_bf16 v[44:47], v[108:111], v[92:95], v[44:47]
    v_mfma_f32_16x16x32_bf16 v[36:39], v[108:111], v[88:91], v[36:39]
    s_add_u32 m0, s24, s30
    s_mov_b32 s24, s23
    s_add_u32 s23, s23, 24576
    s_cmp_eq_u32 s23, 147456
    s_cselect_b32 s23, 0, s23
    v_add_u32 v16, s23, v10
    v_add_u32 v17, s23, v13
    v_add_u32 v18, s23, v14
    buffer_load_dwordx4 v6, s[8:11], s25 offen sc1 lds
    buffer_load_dwordx4 v6, s[8:11], s25 offen offset:1024 sc1 lds
    buffer_load_dwordx4 v6, s[8:11], s25 offen offset:2048 sc1 lds
    buffer_load_dwordx4 v6, s[8:11], s25 offen offset:3072 sc1 lds
    s_add_u32 s25, s25, 0x40000
    s_sub_u32 s27, s27, 1
    s_cmp_lg_u32 s27, 0
    s_cbranch_scc1 wo_loopA
    s_waitcnt vmcnt(16) lgkmcnt(0)
    s_barrier
    v_mfma_f32_16x16x32_bf16 v[32:35], v[64:67], v[48:51], v[32:35]
    ds_read_b64_tr_b16 v[96:97], v17 offset:0
    ds_read_b64_tr_b16 v[98:99], v17 offset:2048
    ds_read_b64_tr_b16 v[100:101], v18 offset:0
    v_mfma_f32_16x16x32_bf16 v[40:43], v[64:67], v[52:55], v[40:43]
    ds_read_b64_tr_b16 v[102:103], v18 offset:2048
    ds_read_b128 v[80:83], v16 offset:0
    v_mfma_f32_16x16x32_bf16 v[44:47], v[68:71], v[52:55], v[44:47]
    ds_read_b128 v[84:87], v16 offset:1024
    ds_read_b64_tr_b16 v[104:105], v17 offset:4096
    ds_read_b64_tr_b16 v[106:107], v17 offset:6144
    v_mfma_f32_16x16x32_bf16 v[36:39], v[68:71], v[48:51], v[36:39]
    ds_read_b64_tr_b16 v[108:109], v18 offset:4096
    ds_read_b64_tr_b16 v[110:111], v18 offset:6144
    v_mfma_f32_16x16x32_bf16 v[32:35], v[72:75], v[56:59], v[32:35]
    ds_read_b128 v[88:91], v16 offset:8192
    ds_read_b128 v[92:95], v16 offset:9216
    v_mfma_f32_16x16x32_bf16 v[40:43], v[72:75], v[60:63], v[40:43]
    v_mfma_f32_16x16x32_bf16 v[44:47], v[76:79], v[60:63], v[44:47]
    v_mfma_f32_16x16x32_bf16 v[36:39], v[76:79], v[56:59], v[36:39]
    s_getpc_b64 s[56:57]
    ct_14:
    s_add_u32 s56, s56, wo_epi-ct_14
    s_addc_u32 s57, s57, 0
    s_and_b32 s56, s56, 0xffffff80
    s_mov_b32 s58, code_end-wo_epi
    s_mov_b32 s59, 0x20000
    v_lshlrev_b32 v252, 7, v1
    s_lshl_b32 s28, s31, 13
    buffer_load_dword v251, v252, s[56:59], s28 offen
    s_mov_b32 s24, s23
    s_add_u32 s23, s23, 24576
    s_cmp_eq_u32 s23, 147456
    s_cselect_b32 s23, 0, s23
    v_add_u32 v16, s23, v10
    v_add_u32 v17, s23, v13
    v_add_u32 v18, s23, v14
    s_waitcnt vmcnt(13) lgkmcnt(0)
    s_barrier
    v_mfma_f32_16x16x32_bf16 v[32:35], v[96:99], v[80:83], v[32:35]
    ds_read_b64_tr_b16 v[64:65], v17 offset:0
    ds_read_b64_tr_b16 v[66:67], v17 offset:2048
    ds_read_b64_tr_b16 v[68:69], v18 offset:0
    v_mfma_f32_16x16x32_bf16 v[40:43], v[96:99], v[84:87], v[40:43]
    ds_read_b64_tr_b16 v[70:71], v18 offset:2048
    ds_read_b128 v[48:51], v16 offset:0
    v_mfma_f32_16x16x32_bf16 v[44:47], v[100:103], v[84:87], v[44:47]
    ds_read_b128 v[52:55], v16 offset:1024
    ds_read_b64_tr_b16 v[72:73], v17 offset:4096
    ds_read_b64_tr_b16 v[74:75], v17 offset:6144
    v_mfma_f32_16x16x32_bf16 v[36:39], v[100:103], v[80:83], v[36:39]
    ds_read_b64_tr_b16 v[76:77], v18 offset:4096
    ds_read_b64_tr_b16 v[78:79], v18 offset:6144
    v_mfma_f32_16x16x32_bf16 v[32:35], v[104:107], v[88:91], v[32:35]
    ds_read_b128 v[56:59], v16 offset:8192
    ds_read_b128 v[60:63], v16 offset:9216
    v_mfma_f32_16x16x32_bf16 v[40:43], v[104:107], v[92:95], v[40:43]
    v_mfma_f32_16x16x32_bf16 v[44:47], v[108:111], v[92:95], v[44:47]
    v_mfma_f32_16x16x32_bf16 v[36:39], v[108:111], v[88:91], v[36:39]
    s_mov_b32 s24, s23
    s_add_u32 s23, s23, 24576
    s_cmp_eq_u32 s23, 147456
    s_cselect_b32 s23, 0, s23
    v_add_u32 v16, s23, v10
    v_add_u32 v17, s23, v13
    v_add_u32 v18, s23, v14
    s_waitcnt vmcnt(9) lgkmcnt(0)
    s_barrier
    v_mfma_f32_16x16x32_bf16 v[32:35], v[64:67], v[48:51], v[32:35]
    ds_read_b64_tr_b16 v[96:97], v17 offset:0
    ds_read_b64_tr_b16 v[98:99], v17 offset:2048
    ds_read_b64_tr_b16 v[100:101], v18 offset:0
    v_mfma_f32_16x16x32_bf16 v[40:43], v[64:67], v[52:55], v[40:43]
    ds_read_b64_tr_b16 v[102:103], v18 offset:2048
    ds_read_b128 v[80:83], v16 offset:0
    v_mfma_f32_16x16x32_bf16 v[44:47], v[68:71], v[52:55], v[44:47]
    ds_read_b128 v[84:87], v16 offset:1024
    ds_read_b64_tr_b16 v[104:105], v17 offset:4096
    ds_read_b64_tr_b16 v[106:107], v17 offset:6144
    v_mfma_f32_16x16x32_bf16 v[36:39], v[68:71], v[48:51], v[36:39]
    ds_read_b64_tr_b16 v[108:109], v18 offset:4096
    ds_read_b64_tr_b16 v[110:111], v18 offset:6144
    v_mfma_f32_16x16x32_bf16 v[32:35], v[72:75], v[56:59], v[32:35]
    ds_read_b128 v[88:91], v16 offset:8192
    ds_read_b128 v[92:95], v16 offset:9216
    v_mfma_f32_16x16x32_bf16 v[40:43], v[72:75], v[60:63], v[40:43]
    v_mfma_f32_16x16x32_bf16 v[44:47], v[76:79], v[60:63], v[44:47]
    v_mfma_f32_16x16x32_bf16 v[36:39], v[76:79], v[56:59], v[36:39]
    s_mov_b32 s24, s23
    s_add_u32 s23, s23, 24576
    s_cmp_eq_u32 s23, 147456
    s_cselect_b32 s23, 0, s23
    v_add_u32 v16, s23, v10
    v_add_u32 v17, s23, v13
    v_add_u32 v18, s23, v14
    s_waitcnt vmcnt(5) lgkmcnt(0)
    s_barrier
    v_mfma_f32_16x16x32_bf16 v[32:35], v[96:99], v[80:83], v[32:35]
    ds_read_b64_tr_b16 v[64:65], v17 offset:0
    ds_read_b64_tr_b16 v[66:67], v17 offset:2048
    ds_read_b64_tr_b16 v[68:69], v18 offset:0
    v_mfma_f32_16x16x32_bf16 v[40:43], v[96:99], v[84:87], v[40:43]
    ds_read_b64_tr_b16 v[70:71], v18 offset:2048
    ds_read_b128 v[48:51], v16 offset:0
    v_mfma_f32_16x16x32_bf16 v[44:47], v[100:103], v[84:87], v[44:47]
    ds_read_b128 v[52:55], v16 offset:1024
    ds_read_b64_tr_b16 v[72:73], v17 offset:4096
    ds_read_b64_tr_b16 v[74:75], v17 offset:6144
    v_mfma_f32_16x16x32_bf16 v[36:39], v[100:103], v[80:83], v[36:39]
    ds_read_b64_tr_b16 v[76:77], v18 offset:4096
    ds_read_b64_tr_b16 v[78:79], v18 offset:6144
    v_mfma_f32_16x16x32_bf16 v[32:35], v[104:107], v[88:91], v[32:35]
    ds_read_b128 v[56:59], v16 offset:8192
    ds_read_b128 v[60:63], v16 offset:9216
    v_mfma_f32_16x16x32_bf16 v[40:43], v[104:107], v[92:95], v[40:43]
    v_mfma_f32_16x16x32_bf16 v[44:47], v[108:111], v[92:95], v[44:47]
    v_mfma_f32_16x16x32_bf16 v[36:39], v[108:111], v[88:91], v[36:39]
    s_mov_b32 s24, s23
    s_add_u32 s23, s23, 24576
    s_cmp_eq_u32 s23, 147456
    s_cselect_b32 s23, 0, s23
    v_add_u32 v16, s23, v10
    v_add_u32 v17, s23, v13
    v_add_u32 v18, s23, v14
    s_waitcnt vmcnt(1) lgkmcnt(0)
    s_barrier
    v_mfma_f32_16x16x32_bf16 v[32:35], v[64:67], v[48:51], v[32:35]
    ds_read_b64_tr_b16 v[96:97], v17 offset:0
    ds_read_b64_tr_b16 v[98:99], v17 offset:2048
    ds_read_b64_tr_b16 v[100:101], v18 offset:0
    v_mfma_f32_16x16x32_bf16 v[40:43], v[64:67], v[52:55], v[40:43]
    ds_read_b64_tr_b16 v[102:103], v18 offset:2048
    ds_read_b128 v[80:83], v16 offset:0
    v_mfma_f32_16x16x32_bf16 v[44:47], v[68:71], v[52:55], v[44:47]
    ds_read_b128 v[84:87], v16 offset:1024
    ds_read_b64_tr_b16 v[104:105], v17 offset:4096
    ds_read_b64_tr_b16 v[106:107], v17 offset:6144
    v_mfma_f32_16x16x32_bf16 v[36:39], v[68:71], v[48:51], v[36:39]
    ds_read_b64_tr_b16 v[108:109], v18 offset:4096
    ds_read_b64_tr_b16 v[110:111], v18 offset:6144
    v_mfma_f32_16x16x32_bf16 v[32:35], v[72:75], v[56:59], v[32:35]
    ds_read_b128 v[88:91], v16 offset:8192
    ds_read_b128 v[92:95], v16 offset:9216
    v_mfma_f32_16x16x32_bf16 v[40:43], v[72:75], v[60:63], v[40:43]
    v_mfma_f32_16x16x32_bf16 v[44:47], v[76:79], v[60:63], v[44:47]
    v_mfma_f32_16x16x32_bf16 v[36:39], v[76:79], v[56:59], v[36:39]
    s_mov_b32 s24, s23
    s_add_u32 s23, s23, 24576
    s_cmp_eq_u32 s23, 147456
    s_cselect_b32 s23, 0, s23
    v_add_u32 v16, s23, v10
    v_add_u32 v17, s23, v13
    v_add_u32 v18, s23, v14
    s_waitcnt lgkmcnt(0)
    v_mfma_f32_16x16x32_bf16 v[32:35], v[96:99], v[80:83], v[32:35]
    v_mfma_f32_16x16x32_bf16 v[40:43], v[96:99], v[84:87], v[40:43]
    v_mfma_f32_16x16x32_bf16 v[44:47], v[100:103], v[84:87], v[44:47]
    v_mfma_f32_16x16x32_bf16 v[36:39], v[100:103], v[80:83], v[36:39]
    v_mfma_f32_16x16x32_bf16 v[32:35], v[104:107], v[88:91], v[32:35]
    v_mfma_f32_16x16x32_bf16 v[40:43], v[104:107], v[92:95], v[40:43]
    v_mfma_f32_16x16x32_bf16 v[44:47], v[108:111], v[92:95], v[44:47]
    v_mfma_f32_16x16x32_bf16 v[36:39], v[108:111], v[88:91], v[36:39]
    s_nop 7
    s_branch wo_epi
wo_B:
    s_barrier
    s_barrier
    s_barrier
    s_barrier
    s_barrier
    s_waitcnt vmcnt(12)
    v_permlane16_swap_b32 v240, v242
    v_permlane16_swap_b32 v241, v243
    v_permlane16_swap_b32 v244, v246
    v_permlane16_swap_b32 v245, v247
    s_nop 1
    v_lshlrev_b32 v32, 16, v240
    v_and_b32 v33, 0xffff0000, v240
    v_lshlrev_b32 v34, 16, v241
    v_and_b32 v35, 0xffff0000, v241
    v_lshlrev_b32 v36, 16, v242
    v_and_b32 v37, 0xffff0000, v242
    v_lshlrev_b32 v38, 16, v243
    v_and_b32 v39, 0xffff0000, v243
    v_lshlrev_b32 v40, 16, v244
    v_and_b32 v41, 0xffff0000, v244
    v_lshlrev_b32 v42, 16, v245
    v_and_b32 v43, 0xffff0000, v245
    v_lshlrev_b32 v44, 16, v246
    v_and_b32 v45, 0xffff0000, v246
    v_lshlrev_b32 v46, 16, v247
    v_and_b32 v47, 0xffff0000, v247
    s_mov_b32 s23, 0
    v_add_u32 v16, s23, v10
    v_add_u32 v17, s23, v13
    v_add_u32 v18, s23, v14
    s_waitcnt vmcnt(10)
    s_barrier
    ds_read_b64_tr_b16 v[64:65], v17 offset:0
    ds_read_b64_tr_b16 v[66:67], v17 offset:2048
    ds_read_b64_tr_b16 v[68:69], v18 offset:0
    ds_read_b64_tr_b16 v[70:71], v18 offset:2048
    ds_read_b128 v[48:51], v16 offset:0
    ds_read_b128 v[52:55], v16 offset:1024
    ds_read_b64_tr_b16 v[72:73], v17 offset:4096
    ds_read_b64_tr_b16 v[74:75], v17 offset:6144
    ds_read_b64_tr_b16 v[76:77], v18 offset:4096
    ds_read_b64_tr_b16 v[78:79], v18 offset:6144
    ds_read_b128 v[56:59], v16 offset:8192
    ds_read_b128 v[60:63], v16 offset:9216
    s_mov_b32 s24, s23
    s_add_u32 s23, s23, 24576
    s_cmp_eq_u32 s23, 147456
    s_cselect_b32 s23, 0, s23
    v_add_u32 v16, s23, v10
    v_add_u32 v17, s23, v13
    v_add_u32 v18, s23, v14
    s_mov_b32 s27, 5
.p2align 6
wo_loopB:
    s_waitcnt vmcnt(8) lgkmcnt(0)
    s_barrier
    s_add_u32 m0, s24, s30
    s_nop 0
    buffer_load_dwordx4 v7, s[12:15], s25 offen lds
    buffer_load_dwordx4 v8, s[12:15], s25 offen offset:1024 lds
    s_add_u32 s25, s25, 0x20000
    v_mfma_f32_16x16x32_bf16 v[32:35], v[64:67], v[48:51], v[32:35]
    ds_read_b64_tr_b16 v[96:97], v17 offset:0
    ds_read_b64_tr_b16 v[98:99], v17 offset:2048
    ds_read_b64_tr_b16 v[100:101], v18 offset:0
    v_mfma_f32_16x16x32_bf16 v[40:43], v[64:67], v[52:55], v[40:43]
    ds_read_b64_tr_b16 v[102:103], v18 offset:2048
    ds_read_b128 v[80:83], v16 offset:0
    v_mfma_f32_16x16x32_bf16 v[44:47], v[68:71], v[52:55], v[44:47]
    ds_read_b128 v[84:87], v16 offset:1024
    ds_read_b64_tr_b16 v[104:105], v17 offset:4096
    ds_read_b64_tr_b16 v[106:107], v17 offset:6144
    v_mfma_f32_16x16x32_bf16 v[36:39], v[68:71], v[48:51], v[36:39]
    ds_read_b64_tr_b16 v[108:109], v18 offset:4096
    ds_read_b64_tr_b16 v[110:111], v18 offset:6144
    v_mfma_f32_16x16x32_bf16 v[32:35], v[72:75], v[56:59], v[32:35]
    ds_read_b128 v[88:91], v16 offset:8192
    ds_read_b128 v[92:95], v16 offset:9216
    v_mfma_f32_16x16x32_bf16 v[40:43], v[72:75], v[60:63], v[40:43]
    s_mov_b32 s24, s23
    s_add_u32 s23, s23, 24576
    s_cmp_eq_u32 s23, 147456
    s_cselect_b32 s23, 0, s23
    v_mfma_f32_16x16x32_bf16 v[44:47], v[76:79], v[60:63], v[44:47]
    v_add_u32 v16, s23, v10
    v_add_u32 v17, s23, v13
    v_add_u32 v18, s23, v14
    v_mfma_f32_16x16x32_bf16 v[36:39], v[76:79], v[56:59], v[36:39]
    s_waitcnt vmcnt(8) lgkmcnt(0)
    s_barrier
    s_add_u32 m0, s24, s30
    s_nop 0
    buffer_load_dwordx4 v7, s[12:15], s25 offen lds
    buffer_load_dwordx4 v8, s[12:15], s25 offen offset:1024 lds
    s_add_u32 s25, s25, 0x20000
    v_mfma_f32_16x16x32_bf16 v[32:35], v[96:99], v[80:83], v[32:35]
    ds_read_b64_tr_b16 v[64:65], v17 offset:0
    ds_read_b64_tr_b16 v[66:67], v17 offset:2048
    ds_read_b64_tr_b16 v[68:69], v18 offset:0
    v_mfma_f32_16x16x32_bf16 v[40:43], v[96:99], v[84:87], v[40:43]
    ds_read_b64_tr_b16 v[70:71], v18 offset:2048
    ds_read_b128 v[48:51], v16 offset:0
    v_mfma_f32_16x16x32_bf16 v[44:47], v[100:103], v[84:87], v[44:47]
    ds_read_b128 v[52:55], v16 offset:1024
    ds_read_b64_tr_b16 v[72:73], v17 offset:4096
    ds_read_b64_tr_b16 v[74:75], v17 offset:6144
    v_mfma_f32_16x16x32_bf16 v[36:39], v[100:103], v[80:83], v[36:39]
    ds_read_b64_tr_b16 v[76:77], v18 offset:4096
    ds_read_b64_tr_b16 v[78:79], v18 offset:6144
    v_mfma_f32_16x16x32_bf16 v[32:35], v[104:107], v[88:91], v[32:35]
    ds_read_b128 v[56:59], v16 offset:8192
    ds_read_b128 v[60:63], v16 offset:9216
    v_mfma_f32_16x16x32_bf16 v[40:43], v[104:107], v[92:95], v[40:43]
    s_mov_b32 s24, s23
    s_add_u32 s23, s23, 24576
    s_cmp_eq_u32 s23, 147456
    s_cselect_b32 s23, 0, s23
    v_add_u32 v16, s23, v10
    v_mfma_f32_16x16x32_bf16 v[44:47], v[108:111], v[92:95], v[44:47]
    v_add_u32 v17, s23, v13
    v_add_u32 v18, s23, v14
    s_sub_u32 s27, s27, 1
    s_cmp_lg_u32 s27, 0
    v_mfma_f32_16x16x32_bf16 v[36:39], v[108:111], v[88:91], v[36:39]
    s_cbranch_scc1 wo_loopB
    s_waitcnt vmcnt(8) lgkmcnt(0)
    s_barrier
    v_mfma_f32_16x16x32_bf16 v[32:35], v[64:67], v[48:51], v[32:35]
    ds_read_b64_tr_b16 v[96:97], v17 offset:0
    ds_read_b64_tr_b16 v[98:99], v17 offset:2048
    ds_read_b64_tr_b16 v[100:101], v18 offset:0
    v_mfma_f32_16x16x32_bf16 v[40:43], v[64:67], v[52:55], v[40:43]
    ds_read_b64_tr_b16 v[102:103], v18 offset:2048
    ds_read_b128 v[80:83], v16 offset:0
    v_mfma_f32_16x16x32_bf16 v[44:47], v[68:71], v[52:55], v[44:47]
    ds_read_b128 v[84:87], v16 offset:1024
    ds_read_b64_tr_b16 v[104:105], v17 offset:4096
    ds_read_b64_tr_b16 v[106:107], v17 offset:6144
    v_mfma_f32_16x16x32_bf16 v[36:39], v[68:71], v[48:51], v[36:39]
    ds_read_b64_tr_b16 v[108:109], v18 offset:4096
    ds_read_b64_tr_b16 v[110:111], v18 offset:6144
    v_mfma_f32_16x16x32_bf16 v[32:35], v[72:75], v[56:59], v[32:35]
    ds_read_b128 v[88:91], v16 offset:8192
    ds_read_b128 v[92:95], v16 offset:9216
    v_mfma_f32_16x16x32_bf16 v[40:43], v[72:75], v[60:63], v[40:43]
    s_mov_b32 s24, s23
    s_add_u32 s23, s23, 24576
    s_cmp_eq_u32 s23, 147456
    s_cselect_b32 s23, 0, s23
    v_mfma_f32_16x16x32_bf16 v[44:47], v[76:79], v[60:63], v[44:47]
    v_add_u32 v16, s23, v10
    v_add_u32 v17, s23, v13
    v_add_u32 v18, s23, v14
    v_mfma_f32_16x16x32_bf16 v[36:39], v[76:79], v[56:59], v[36:39]
    s_waitcnt vmcnt(6) lgkmcnt(0)
    s_barrier
    v_mfma_f32_16x16x32_bf16 v[32:35], v[96:99], v[80:83], v[32:35]
    ds_read_b64_tr_b16 v[64:65], v17 offset:0
    ds_read_b64_tr_b16 v[66:67], v17 offset:2048
    ds_read_b64_tr_b16 v[68:69], v18 offset:0
    v_mfma_f32_16x16x32_bf16 v[40:43], v[96:99], v[84:87], v[40:43]
    ds_read_b64_tr_b16 v[70:71], v18 offset:2048
    ds_read_b128 v[48:51], v16 offset:0
    v_mfma_f32_16x16x32_bf16 v[44:47], v[100:103], v[84:87], v[44:47]
    ds_read_b128 v[52:55], v16 offset:1024
    ds_read_b64_tr_b16 v[72:73], v17 offset:4096
    ds_read_b64_tr_b16 v[74:75], v17 offset:6144
    v_mfma_f32_16x16x32_bf16 v[36:39], v[100:103], v[80:83], v[36:39]
    ds_read_b64_tr_b16 v[76:77], v18 offset:4096
    ds_read_b64_tr_b16 v[78:79], v18 offset:6144
    v_mfma_f32_16x16x32_bf16 v[32:35], v[104:107], v[88:91], v[32:35]
    ds_read_b128 v[56:59], v16 offset:8192
    ds_read_b128 v[60:63], v16 offset:9216
    v_mfma_f32_16x16x32_bf16 v[40:43], v[104:107], v[92:95], v[40:43]
    s_mov_b32 s24, s23
    s_add_u32 s23, s23, 24576
    s_cmp_eq_u32 s23, 147456
    s_cselect_b32 s23, 0, s23
    v_mfma_f32_16x16x32_bf16 v[44:47], v[108:111], v[92:95], v[44:47]
    v_add_u32 v16, s23, v10
    v_add_u32 v17, s23, v13
    v_add_u32 v18, s23, v14
    v_mfma_f32_16x16x32_bf16 v[36:39], v[108:111], v[88:91], v[36:39]
    s_waitcnt vmcnt(4) lgkmcnt(0)
    s_barrier
    v_mfma_f32_16x16x32_bf16 v[32:35], v[64:67], v[48:51], v[32:35]
    ds_read_b64_tr_b16 v[96:97], v17 offset:0
    ds_read_b64_tr_b16 v[98:99], v17 offset:2048
    ds_read_b64_tr_b16 v[100:101], v18 offset:0
    v_mfma_f32_16x16x32_bf16 v[40:43], v[64:67], v[52:55], v[40:43]
    ds_read_b64_tr_b16 v[102:103], v18 offset:2048
    ds_read_b128 v[80:83], v16 offset:0
    v_mfma_f32_16x16x32_bf16 v[44:47], v[68:71], v[52:55], v[44:47]
    ds_read_b128 v[84:87], v16 offset:1024
    ds_read_b64_tr_b16 v[104:105], v17 offset:4096
    ds_read_b64_tr_b16 v[106:107], v17 offset:6144
    v_mfma_f32_16x16x32_bf16 v[36:39], v[68:71], v[48:51], v[36:39]
    ds_read_b64_tr_b16 v[108:109], v18 offset:4096
    ds_read_b64_tr_b16 v[110:111], v18 offset:6144
    v_mfma_f32_16x16x32_bf16 v[32:35], v[72:75], v[56:59], v[32:35]
    ds_read_b128 v[88:91], v16 offset:8192
    ds_read_b128 v[92:95], v16 offset:9216
    v_mfma_f32_16x16x32_bf16 v[40:43], v[72:75], v[60:63], v[40:43]
    s_mov_b32 s24, s23
    s_add_u32 s23, s23, 24576
    s_cmp_eq_u32 s23, 147456
    s_cselect_b32 s23, 0, s23
    v_mfma_f32_16x16x32_bf16 v[44:47], v[76:79], v[60:63], v[44:47]
    v_add_u32 v16, s23, v10
    v_add_u32 v17, s23, v13
    v_add_u32 v18, s23, v14
    v_mfma_f32_16x16x32_bf16 v[36:39], v[76:79], v[56:59], v[36:39]
    s_waitcnt vmcnt(2) lgkmcnt(0)
    s_barrier
    v_mfma_f32_16x16x32_bf16 v[32:35], v[96:99], v[80:83], v[32:35]
    ds_read_b64_tr_b16 v[64:65], v17 offset:0
    ds_read_b64_tr_b16 v[66:67], v17 offset:2048
    ds_read_b64_tr_b16 v[68:69], v18 offset:0
    v_mfma_f32_16x16x32_bf16 v[40:43], v[96:99], v[84:87], v[40:43]
    ds_read_b64_tr_b16 v[70:71], v18 offset:2048
    ds_read_b128 v[48:51], v16 offset:0
    v_mfma_f32_16x16x32_bf16 v[44:47], v[100:103], v[84:87], v[44:47]
    ds_read_b128 v[52:55], v16 offset:1024
    ds_read_b64_tr_b16 v[72:73], v17 offset:4096
    ds_read_b64_tr_b16 v[74:75], v17 offset:6144
    v_mfma_f32_16x16x32_bf16 v[36:39], v[100:103], v[80:83], v[36:39]
    ds_read_b64_tr_b16 v[76:77], v18 offset:4096
    ds_read_b64_tr_b16 v[78:79], v18 offset:6144
    v_mfma_f32_16x16x32_bf16 v[32:35], v[104:107], v[88:91], v[32:35]
    ds_read_b128 v[56:59], v16 offset:8192
    ds_read_b128 v[60:63], v16 offset:9216
    v_mfma_f32_16x16x32_bf16 v[40:43], v[104:107], v[92:95], v[40:43]
    s_mov_b32 s24, s23
    s_add_u32 s23, s23, 24576
    s_cmp_eq_u32 s23, 147456
    s_cselect_b32 s23, 0, s23
    v_mfma_f32_16x16x32_bf16 v[44:47], v[108:111], v[92:95], v[44:47]
    v_add_u32 v16, s23, v10
    v_add_u32 v17, s23, v13
    v_add_u32 v18, s23, v14
    v_mfma_f32_16x16x32_bf16 v[36:39], v[108:111], v[88:91], v[36:39]
    s_waitcnt vmcnt(0) lgkmcnt(0)
    s_barrier
    v_mfma_f32_16x16x32_bf16 v[32:35], v[64:67], v[48:51], v[32:35]
    ds_read_b64_tr_b16 v[96:97], v17 offset:0
    ds_read_b64_tr_b16 v[98:99], v17 offset:2048
    ds_read_b64_tr_b16 v[100:101], v18 offset:0
    v_mfma_f32_16x16x32_bf16 v[40:43], v[64:67], v[52:55], v[40:43]
    ds_read_b64_tr_b16 v[102:103], v18 offset:2048
    ds_read_b128 v[80:83], v16 offset:0
    v_mfma_f32_16x16x32_bf16 v[44:47], v[68:71], v[52:55], v[44:47]
    ds_read_b128 v[84:87], v16 offset:1024
    ds_read_b64_tr_b16 v[104:105], v17 offset:4096
    ds_read_b64_tr_b16 v[106:107], v17 offset:6144
    v_mfma_f32_16x16x32_bf16 v[36:39], v[68:71], v[48:51], v[36:39]
    ds_read_b64_tr_b16 v[108:109], v18 offset:4096
    ds_read_b64_tr_b16 v[110:111], v18 offset:6144
    v_mfma_f32_16x16x32_bf16 v[32:35], v[72:75], v[56:59], v[32:35]
    ds_read_b128 v[88:91], v16 offset:8192
    ds_read_b128 v[92:95], v16 offset:9216
    v_mfma_f32_16x16x32_bf16 v[40:43], v[72:75], v[60:63], v[40:43]
    s_mov_b32 s24, s23
    s_add_u32 s23, s23, 24576
    s_cmp_eq_u32 s23, 147456
    s_cselect_b32 s23, 0, s23
    v_mfma_f32_16x16x32_bf16 v[44:47], v[76:79], v[60:63], v[44:47]
    v_add_u32 v16, s23, v10
    v_add_u32 v17, s23, v13
    v_add_u32 v18, s23, v14
    v_mfma_f32_16x16x32_bf16 v[36:39], v[76:79], v[56:59], v[36:39]
    s_waitcnt lgkmcnt(0)
    v_mfma_f32_16x16x32_bf16 v[32:35], v[96:99], v[80:83], v[32:35]
    v_mfma_f32_16x16x32_bf16 v[40:43], v[96:99], v[84:87], v[40:43]
    v_mfma_f32_16x16x32_bf16 v[44:47], v[100:103], v[84:87], v[44:47]
    v_mfma_f32_16x16x32_bf16 v[36:39], v[100:103], v[80:83], v[36:39]
    v_mfma_f32_16x16x32_bf16 v[32:35], v[104:107], v[88:91], v[32:35]
    v_mfma_f32_16x16x32_bf16 v[40:43], v[104:107], v[92:95], v[40:43]
    v_mfma_f32_16x16x32_bf16 v[44:47], v[108:111], v[92:95], v[44:47]
    v_mfma_f32_16x16x32_bf16 v[36:39], v[108:111], v[88:91], v[36:39]
    s_nop 7
wo_epi:
    v_cvt_pk_bf16_f32 v112, v32, v33
    v_cvt_pk_bf16_f32 v113, v34, v35
    v_cvt_pk_bf16_f32 v114, v36, v37
    v_cvt_pk_bf16_f32 v115, v38, v39
    v_cvt_pk_bf16_f32 v116, v40, v41
    v_cvt_pk_bf16_f32 v117, v42, v43
    v_cvt_pk_bf16_f32 v118, v44, v45
    v_cvt_pk_bf16_f32 v119, v46, v47
    buffer_store_dwordx4 v[112:115], v6, s[16:19], s34 offen offset:0 sc1
    buffer_store_dwordx4 v[116:119], v6, s[16:19], s34 offen offset:1024 sc1
    v_add_f32 v20, v32, v33
    v_mul_f32 v21, v32, v32
    v_fmac_f32 v21, v33, v33
    v_add_f32 v20, v20, v34
    v_fmac_f32 v21, v34, v34
    v_add_f32 v20, v20, v35
    v_fmac_f32 v21, v35, v35
    v_add_f32 v20, v20, v36
    v_fmac_f32 v21, v36, v36
    v_add_f32 v20, v20, v37
    v_fmac_f32 v21, v37, v37
    v_add_f32 v20, v20, v38
    v_fmac_f32 v21, v38, v38
    v_add_f32 v20, v20, v39
    v_fmac_f32 v21, v39, v39
    v_add_f32 v22, v40, v41
    v_mul_f32 v23, v40, v40
    v_fmac_f32 v23, v41, v41
    v_add_f32 v22, v22, v42
    v_fmac_f32 v23, v42, v42
    v_add_f32 v22, v22, v43
    v_fmac_f32 v23, v43, v43
    v_add_f32 v22, v22, v44
    v_fmac_f32 v23, v44, v44
    v_add_f32 v22, v22, v45
    v_fmac_f32 v23, v45, v45
    v_add_f32 v22, v22, v46
    v_fmac_f32 v23, v46, v46
    v_add_f32 v22, v22, v47
    v_fmac_f32 v23, v47, v47
    v_mov_b32 v24, v20
    v_mov_b32 v25, v21
    v_mov_b32 v26, v22
    v_mov_b32 v27, v23
    s_nop 1
    v_permlane16_swap_b32 v24, v20
    v_permlane16_swap_b32 v25, v21
    v_permlane16_swap_b32 v26, v22
    v_permlane16_swap_b32 v27, v23
    s_nop 1
    v_add_f32 v20, v20, v24
    v_add_f32 v21, v21, v25
    v_add_f32 v22, v22, v26
    v_add_f32 v23, v23, v27
    v_mov_b32 v24, v20
    v_mov_b32 v25, v21
    v_mov_b32 v26, v22
    v_mov_b32 v27, v23
    s_nop 1
    v_permlane32_swap_b32 v24, v20
    v_permlane32_swap_b32 v25, v21
    v_permlane32_swap_b32 v26, v22
    v_permlane32_swap_b32 v27, v23
    s_nop 1
    v_add_f32 v20, v20, v24
    v_add_f32 v21, v21, v25
    v_add_f32 v22, v22, v26
    v_add_f32 v23, v23, v27
    s_lshl_b32 s28, s31, 9
    s_lshl_b32 s29, s33, 3
    s_add_u32 s28, s28, s29
    s_add_u32 s28, s28, 147456
    v_lshlrev_b32 v24, 4, v5
    v_add_u32 v24, s28, v24
    ds_write_b64 v24, v[20:21]
    ds_write_b64 v24, v[22:23] offset:256
    s_load_dwordx4 s[44:47], s[0:1], 32
    s_waitcnt lgkmcnt(0)
    s_barrier
    s_cmp_ge_u32 s20, 2
    s_cbranch_scc1 wo_end2
    v_lshlrev_b32 v24, 4, v0
    v_add_u32 v24, 147456, v24
    ds_read_b128 v[20:23], v24
    s_add_u32 s8, s6, 0x1800000
    s_addc_u32 s9, s7, 0
    s_mov_b32 s10, 0x40000
    s_mov_b32 s11, 0x20000
    v_lshlrev_b32 v24, 3, v0
    s_lshl_b32 s28, s21, 10
    s_lshl_b32 s29, s22, 14
    s_add_u32 s28, s28, s29
    s_waitcnt lgkmcnt(0)
    v_add_f32 v20, v20, v22
    v_add_f32 v21, v21, v23
    buffer_store_dwordx2 v[20:21], v24, s[8:11], s28 offen sc1
wo_end2:
    s_and_b32 s38, s21, 1
    s_lshl_b32 s38, s38, 4
    s_add_u32 s38, s38, s22
    s_lshl_b32 s3, s32, 8
    s_lshl_b32 s28, s38, 3
    s_add_u32 s3, s3, s28
    s_add_u32 s3, s3, 12288
    v_mov_b32 v250, s3
    s_waitcnt vmcnt(0)
    s_add_u32 s56, s6, 0x1a00000
    s_addc_u32 s57, s7, 0
    s_mov_b32 s58, 0x6000
    s_mov_b32 s59, 0x20000
    s_barrier
    s_cmp_lg_u32 s20, 0
    s_cbranch_scc1 pub_skip_15
    s_mov_b64 exec, 1
    buffer_store_dwordx2 v[248:249], v250, s[56:59], 0 offen sc1
    s_mov_b64 exec, -1
pub_skip_15:
    s_and_b32 s21, s2, 1
    s_lshl_b32 s21, s21, 2
    s_bfe_u32 s28, s2, 0x20003
    s_add_u32 s21, s21, s28
    s_bfe_u32 s22, s2, 0x20001
    s_lshl_b32 s22, s22, 3
    s_lshr_b32 s28, s2, 5
    s_add_u32 s22, s22, s28
    s_mov_b32 s12, s44
    s_mov_b32 s13, s45
    s_mov_b32 s14, 0x700000
    s_mov_b32 s15, 0x20000
    s_mov_b32 s16, s46
    s_mov_b32 s17, s47
    s_mov_b32 s18, 0x700000
    s_mov_b32 s19, 0x20000
    s_add_u32 s8, s6, 0x1400000
    s_addc_u32 s9, s7, 0
    s_mov_b32 s10, 0x400000
    s_mov_b32 s11, 0x20000
    s_cmp_lt_u32 s20, 4
    s_cbranch_scc1 gu_A0
    v_mul_u32_u24 v7, 4682, v1
    v_lshrrev_b32 v7, 16, v7
    v_mul_u32_u24 v8, 14, v7
    v_sub_u32 v8, v1, v8
    v_mul_u32_u24 v7, 7168, v7
    v_lshl_add_u32 v7, v8, 4, v7
    v_add_u32 v8, 27776, v7
    s_mov_b32 s34, -1
    s_mov_b32 s35, 0x00ffffff
    s_mul_i32 s28, s31, 57344
    s_mul_i32 s29, s22, 224
    s_add_u32 s25, s28, s29
    s_mul_i32 s30, s31, 1792
    s_add_u32 s30, s30, 16384
    s_mov_b32 s24, 0
    s_add_u32 m0, s24, s30
    s_mov_b64 exec, s[34:35]
    buffer_load_dwordx4 v7, s[12:15], s25 offen lds
    buffer_load_dwordx4 v8, s[12:15], s25 offen offset:896 lds
    s_add_u32 m0, m0, 7168
    s_nop 0
    buffer_load_dwordx4 v7, s[16:19], s25 offen lds
    buffer_load_dwordx4 v8, s[16:19], s25 offen offset:896 lds
    s_mov_b64 exec, -1
    s_add_u32 s25, s25, 229376
    s_mov_b32 s24, 30720
    s_add_u32 m0, s24, s30
    s_mov_b64 exec, s[34:35]
    buffer_load_dwordx4 v7, s[12:15], s25 offen lds
    buffer_load_dwordx4 v8, s[12:15], s25 offen offset:896 lds
    s_add_u32 m0, m0, 7168
    s_nop 0
    buffer_load_dwordx4 v7, s[16:19], s25 offen lds
    buffer_load_dwordx4 v8, s[16:19], s25 offen offset:896 lds
    s_mov_b64 exec, -1
    s_add_u32 s25, s25, 229376
    s_mov_b32 s24, 61440
    s_add_u32 m0, s24, s30
    s_mov_b64 exec, s[34:35]
    buffer_load_dwordx4 v7, s[12:15], s25 offen lds
    buffer_load_dwordx4 v8, s[12:15], s25 offen offset:896 lds
    s_add_u32 m0, m0, 7168
    s_nop 0
    buffer_load_dwordx4 v7, s[16:19], s25 offen lds
    buffer_load_dwordx4 v8, s[16:19], s25 offen offset:896 lds
    s_mov_b64 exec, -1
    s_add_u32 s25, s25, 229376
    s_mov_b32 s24, 92160
    s_add_u32 m0, s24, s30
    s_mov_b64 exec, s[34:35]
    buffer_load_dwordx4 v7, s[12:15], s25 offen lds
    buffer_load_dwordx4 v8, s[12:15], s25 offen offset:896 lds
    s_add_u32 m0, m0, 7168
    s_nop 0
    buffer_load_dwordx4 v7, s[16:19], s25 offen lds
    buffer_load_dwordx4 v8, s[16:19], s25 offen offset:896 lds
    s_mov_b64 exec, -1
    s_add_u32 s25, s25, 229376
    s_mov_b32 s24, 122880
    s_add_u32 m0, s24, s30
    s_mov_b64 exec, s[34:35]
    buffer_load_dwordx4 v7, s[12:15], s25 offen lds
    buffer_load_dwordx4 v8, s[12:15], s25 offen offset:896 lds
    s_add_u32 m0, m0, 7168
    s_nop 0
    buffer_load_dwordx4 v7, s[16:19], s25 offen lds
    buffer_load_dwordx4 v8, s[16:19], s25 offen offset:896 lds
    s_mov_b64 exec, -1
    s_add_u32 s25, s25, 229376
    s_branch gu_C0
gu_A0:
    s_lshl_b32 s28, s21, 4
    s_lshl_b32 s29, s31, 2
    s_add_u32 s28, s28, s29
    s_lshl_b32 s25, s28, 10
    s_lshl_b32 s30, s31, 12
    v_mov_b32 v32, 0
    v_mov_b32 v33, 0
    v_mov_b32 v34, 0
    v_mov_b32 v35, 0
    v_mov_b32 v36, 0
    v_mov_b32 v37, 0
    v_mov_b32 v38, 0
    v_mov_b32 v39, 0
    v_mov_b32 v40, 0
    v_mov_b32 v41, 0
    v_mov_b32 v42, 0
    v_mov_b32 v43, 0
    v_mov_b32 v44, 0
    v_mov_b32 v45, 0
    v_mov_b32 v46, 0
    v_mov_b32 v47, 0
    v_mov_b32 v48, 0
    v_mov_b32 v49, 0
    v_mov_b32 v50, 0
    v_mov_b32 v51, 0
    v_mov_b32 v52, 0
    v_mov_b32 v53, 0
    v_mov_b32 v54, 0
    v_mov_b32 v55, 0
    v_mov_b32 v56, 0
    v_mov_b32 v57, 0
    v_mov_b32 v58, 0
    v_mov_b32 v59, 0
    v_mov_b32 v60, 0
    v_mov_b32 v61, 0
    v_mov_b32 v62, 0
    v_mov_b32 v63, 0
    v_mov_b32 v64, 0
    v_mov_b32 v65, 0
    v_mov_b32 v66, 0
    v_mov_b32 v67, 0
    v_mov_b32 v68, 0
    v_mov_b32 v69, 0
    v_mov_b32 v70, 0
    v_mov_b32 v71, 0
    v_mov_b32 v72, 0
    v_mov_b32 v73, 0
    v_mov_b32 v74, 0
    v_mov_b32 v75, 0
    v_mov_b32 v76, 0
    v_mov_b32 v77, 0
    v_mov_b32 v78, 0
    v_mov_b32 v79, 0
    v_mov_b32 v80, 0
    v_mov_b32 v81, 0
    v_mov_b32 v82, 0
    v_mov_b32 v83, 0
    v_mov_b32 v84, 0
    v_mov_b32 v85, 0
    v_mov_b32 v86, 0
    v_mov_b32 v87, 0
    v_mov_b32 v88, 0
    v_mov_b32 v89, 0
    v_mov_b32 v90, 0
    v_mov_b32 v91, 0
    v_mov_b32 v92, 0
    v_mov_b32 v93, 0
    v_mov_b32 v94, 0
    v_mov_b32 v95, 0
    v_mov_b32 v96, 0
    v_mov_b32 v97, 0
    v_mov_b32 v98, 0
    v_mov_b32 v99, 0
    v_mov_b32 v100, 0
    v_mov_b32 v101, 0
    v_mov_b32 v102, 0
    v_mov_b32 v103, 0
    v_mov_b32 v104, 0
    v_mov_b32 v105, 0
    v_mov_b32 v106, 0
    v_mov_b32 v107, 0
    v_mov_b32 v108, 0
    v_mov_b32 v109, 0
    v_mov_b32 v110, 0
    v_mov_b32 v111, 0
    v_mov_b32 v112, 0
    v_mov_b32 v113, 0
    v_mov_b32 v114, 0
    v_mov_b32 v115, 0
    v_mov_b32 v116, 0
    v_mov_b32 v117, 0
    v_mov_b32 v118, 0
    v_mov_b32 v119, 0
    v_mov_b32 v120, 0
    v_mov_b32 v121, 0
    v_mov_b32 v122, 0
    v_mov_b32 v123, 0
    v_mov_b32 v124, 0
    v_mov_b32 v125, 0
    v_mov_b32 v126, 0
    v_mov_b32 v127, 0
    v_mov_b32 v128, 0
    v_mov_b32 v129, 0
    v_mov_b32 v130, 0
    v_mov_b32 v131, 0
    v_mov_b32 v132, 0
    v_mov_b32 v133, 0
    v_mov_b32 v134, 0
    v_mov_b32 v135, 0
    v_mov_b32 v136, 0
    v_mov_b32 v137, 0
    v_mov_b32 v138, 0
    v_mov_b32 v139, 0
    v_mov_b32 v140, 0
    v_mov_b32 v141, 0
    v_mov_b32 v142, 0
    v_mov_b32 v143, 0
    v_mov_b32 v144, 0
    v_mov_b32 v145, 0
    v_mov_b32 v146, 0
    v_mov_b32 v147, 0
    v_mov_b32 v148, 0
    v_mov_b32 v149, 0
    v_mov_b32 v150, 0
    v_mov_b32 v151, 0
gu_C0:
    s_add_u32 s44, s6, 0x1800000
    s_addc_u32 s45, s7, 0
    s_mov_b32 s46, 0x40000
    s_mov_b32 s47, 0x20000
    s_add_u32 s48, s6, 0x1900000
    s_addc_u32 s49, s7, 0
    s_mov_b32 s50, 0x1c000
    s_mov_b32 s51, 0x20000
    s_mov_b32 s52, s6
    s_mov_b32 s53, s7
    s_mov_b32 s54, 0xe00000
    s_mov_b32 s55, 0x20000
    s_and_b32 s36, s22, 1
    s_cmp_eq_u32 s36, 1
    s_cselect_b32 s37, 3, 0
    s_cselect_b32 s38, 1, 4
    s_cselect_b32 s39, 0, 6
    s_cmp_ge_u32 s20, 4
    s_cselect_b32 s37, s38, s37
    s_lshl_b32 s28, s31, 12
    v_add_u32 v10, s28, v6
    v_lshl_add_u32 v11, v2, 2, v3
    v_mul_u32_u24 v11, 224, v11
    v_lshl_add_u32 v11, v4, 3, v11
    v_add_u32 v11, 16384, v11
    s_lshl_b32 s28, s39, 5
    v_add_u32 v12, s28, v11
    s_lshl_b32 s28, s37, 5
    v_add_u32 v11, s28, v11
    v_and_b32 v13, 255, v0
    v_lshlrev_b32 v14, 3, v13
    s_lshl_b32 s32, s21, 11
    v_lshlrev_b32 v15, 2, v13
    v_add_u32 v9, 13888, v15
    v_cmp_gt_u32 vcc, 112, v13
    v_mov_b32 v19, 0x7fffffff
    s_mul_i32 s33, s22, 448
    v_cndmask_b32 v15, v9, v15, vcc
    v_cmp_gt_u32 vcc, 224, v13
    s_nop 1
    v_cndmask_b32 v15, v19, v15, vcc
    s_cmp_lt_u32 s20, 4
    s_cbranch_scc1 gu_Z
    v_mov_b32 v32, 0
    v_mov_b32 v33, 0
    v_mov_b32 v34, 0
    v_mov_b32 v35, 0
    v_mov_b32 v36, 0
    v_mov_b32 v37, 0
    v_mov_b32 v38, 0
    v_mov_b32 v39, 0
    v_mov_b32 v40, 0
    v_mov_b32 v41, 0
    v_mov_b32 v42, 0
    v_mov_b32 v43, 0
    v_mov_b32 v44, 0
    v_mov_b32 v45, 0
    v_mov_b32 v46, 0
    v_mov_b32 v47, 0
    v_mov_b32 v48, 0
    v_mov_b32 v49, 0
    v_mov_b32 v50, 0
    v_mov_b32 v51, 0
    v_mov_b32 v52, 0
    v_mov_b32 v53, 0
    v_mov_b32 v54, 0
    v_mov_b32 v55, 0
    v_mov_b32 v56, 0
    v_mov_b32 v57, 0
    v_mov_b32 v58, 0
    v_mov_b32 v59, 0
    v_mov_b32 v60, 0
    v_mov_b32 v61, 0
    v_mov_b32 v62, 0
    v_mov_b32 v63, 0
    v_mov_b32 v64, 0
    v_mov_b32 v65, 0
    v_mov_b32 v66, 0
    v_mov_b32 v67, 0
    v_mov_b32 v68, 0
    v_mov_b32 v69, 0
    v_mov_b32 v70, 0
    v_mov_b32 v71, 0
    v_mov_b32 v72, 0
    v_mov_b32 v73, 0
    v_mov_b32 v74, 0
    v_mov_b32 v75, 0
    v_mov_b32 v76, 0
    v_mov_b32 v77, 0
    v_mov_b32 v78, 0
    v_mov_b32 v79, 0
    v_mov_b32 v80, 0
    v_mov_b32 v81, 0
    v_mov_b32 v82, 0
    v_mov_b32 v83, 0
    v_mov_b32 v84, 0
    v_mov_b32 v85, 0
    v_mov_b32 v86, 0
    v_mov_b32 v87, 0
    v_mov_b32 v88, 0
    v_mov_b32 v89, 0
    v_mov_b32 v90, 0
    v_mov_b32 v91, 0
    v_mov_b32 v92, 0
    v_mov_b32 v93, 0
    v_mov_b32 v94, 0
    v_mov_b32 v95, 0
    v_mov_b32 v96, 0
    v_mov_b32 v97, 0
    v_mov_b32 v98, 0
    v_mov_b32 v99, 0
    v_mov_b32 v100, 0
    v_mov_b32 v101, 0
    v_mov_b32 v102, 0
    v_mov_b32 v103, 0
    v_mov_b32 v104, 0
    v_mov_b32 v105, 0
    v_mov_b32 v106, 0
    v_mov_b32 v107, 0
    v_mov_b32 v108, 0
    v_mov_b32 v109, 0
    v_mov_b32 v110, 0
    v_mov_b32 v111, 0
    v_mov_b32 v112, 0
    v_mov_b32 v113, 0
    v_mov_b32 v114, 0
    v_mov_b32 v115, 0
    v_mov_b32 v116, 0
    v_mov_b32 v117, 0
    v_mov_b32 v118, 0
    v_mov_b32 v119, 0
gu_Z:
    s_cmp_lg_u32 s20, 0
    s_cbranch_scc1 wf_skip_16
    s_add_u32 s56, s6, 0x1a00000
    s_addc_u32 s57, s7, 0
    s_mov_b32 s58, 0x6000
    s_mov_b32 s59, 0x20000
    s_lshl_b32 s3, s21, 8
    s_add_u32 s3, s3, 12288
    v_and_b32 v22, 31, v0
    v_lshlrev_b32 v22, 3, v22
    v_lshlrev_b32 v23, 3, v0
    s_mov_b32 s29, 8192
    s_mov_b32 s28, 262144
wf_all_19:
    buffer_load_dwordx2 v[24:25], v23, s[56:59], s29 offen offset:0 sc1
    buffer_load_dwordx2 v[26:27], v23, s[56:59], s29 offen offset:512 sc1
    buffer_load_dwordx2 v[28:29], v23, s[56:59], s29 offen offset:1024 sc1
    buffer_load_dwordx2 v[30:31], v23, s[56:59], s29 offen offset:1536 sc1
    buffer_load_dwordx2 v[252:253], v22, s[56:59], s3 offen sc1
    s_waitcnt vmcnt(1)
    v_cmp_ne_u64 vcc, s[62:63], v[24:25]
    v_cmp_ne_u64 s[60:61], s[62:63], v[26:27]
    s_nop 1
    s_or_b64 vcc, vcc, s[60:61]
    v_cmp_ne_u64 s[60:61], s[62:63], v[28:29]
    s_nop 1
    s_or_b64 vcc, vcc, s[60:61]
    v_cmp_ne_u64 s[60:61], s[62:63], v[30:31]
    s_nop 1
    s_or_b64 vcc, vcc, s[60:61]
    s_sub_u32 s28, s28, 1
    s_cmp_eq_u32 s28, 0
    s_cbranch_scc1 wf_skip_16
    s_cmp_eq_u64 vcc, 0
    s_cbranch_scc0 wf_all_19
wf_loop_17:
    s_waitcnt vmcnt(0)
    v_cmp_ne_u64 vcc, s[62:63], v[252:253]
    s_nop 1
    s_cmp_eq_u64 vcc, 0
    s_cbranch_scc1 wf_skip_16
    s_sleep 1
    buffer_load_dwordx2 v[252:253], v22, s[56:59], s3 offen sc1
    s_sub_u32 s28, s28, 1
    s_cmp_lg_u32 s28, 0
    s_cbranch_scc1 wf_loop_17
wf_skip_16:
    s_barrier
    v_mov_b32 v24, 0
    v_mov_b32 v25, 0
    v_mov_b32 v26, 0
    v_mov_b32 v27, 0
    v_mov_b32 v28, 0
    v_mov_b32 v29, 0
    v_mov_b32 v30, 0
    v_mov_b32 v31, 0
    s_cmp_ge_u32 s20, 4
    s_cbranch_scc1 gu_B
    s_mov_b32 s24, 0
    s_add_u32 m0, s24, s30
    s_nop 0
    buffer_load_dwordx4 v6, s[8:11], s25 offen sc1 lds
    buffer_load_dwordx4 v6, s[8:11], s25 offen offset:1024 sc1 lds
    buffer_load_dwordx4 v6, s[8:11], s25 offen offset:2048 sc1 lds
    buffer_load_dwordx4 v6, s[8:11], s25 offen offset:3072 sc1 lds
    s_add_u32 s25, s25, 0x20000
    s_barrier
    s_mov_b32 s24, 30720
    s_add_u32 m0, s24, s30
    s_nop 0
    buffer_load_dwordx4 v6, s[8:11], s25 offen sc1 lds
    buffer_load_dwordx4 v6, s[8:11], s25 offen offset:1024 sc1 lds
    buffer_load_dwordx4 v6, s[8:11], s25 offen offset:2048 sc1 lds
    buffer_load_dwordx4 v6, s[8:11], s25 offen offset:3072 sc1 lds
    s_add_u32 s25, s25, 0x20000
    s_barrier
    s_mov_b32 s24, 61440
    s_add_u32 m0, s24, s30
    s_nop 0
    buffer_load_dwordx4 v6, s[8:11], s25 offen sc1 lds
    buffer_load_dwordx4 v6, s[8:11], s25 offen offset:1024 sc1 lds
    buffer_load_dwordx4 v6, s[8:11], s25 offen offset:2048 sc1 lds
    buffer_load_dwordx4 v6, s[8:11], s25 offen offset:3072 sc1 lds
    s_add_u32 s25, s25, 0x20000
    s_barrier
    s_mov_b32 s24, 92160
    s_add_u32 m0, s24, s30
    s_nop 0
    buffer_load_dwordx4 v6, s[8:11], s25 offen sc1 lds
    buffer_load_dwordx4 v6, s[8:11], s25 offen offset:1024 sc1 lds
    buffer_load_dwordx4 v6, s[8:11], s25 offen offset:2048 sc1 lds
    buffer_load_dwordx4 v6, s[8:11], s25 offen offset:3072 sc1 lds
    s_add_u32 s25, s25, 0x20000
    s_barrier
    s_mov_b32 s24, 122880
    s_add_u32 m0, s24, s30
    s_nop 0
    buffer_load_dwordx4 v6, s[8:11], s25 offen sc1 lds
    buffer_load_dwordx4 v6, s[8:11], s25 offen offset:1024 sc1 lds
    buffer_load_dwordx4 v6, s[8:11], s25 offen offset:2048 sc1 lds
    buffer_load_dwordx4 v6, s[8:11], s25 offen offset:3072 sc1 lds
    s_add_u32 s25, s25, 0x20000
    s_mov_b32 s23, 0
    v_add_u32 v16, s23, v10
    v_add_u32 v17, s23, v11
    s_waitcnt vmcnt(16)
    s_barrier
    ds_read_b128 v[152:155], v16 offset:0
    ds_read_b128 v[156:159], v16 offset:1024
    ds_read_b128 v[160:163], v16 offset:2048
    ds_read_b128 v[164:167], v16 offset:3072
    ds_read_b64_tr_b16 v[168:169], v17 offset:0
    ds_read_b64_tr_b16 v[170:171], v17 offset:3584
    ds_read_b64_tr_b16 v[172:173], v17 offset:7168
    ds_read_b64_tr_b16 v[174:175], v17 offset:10752
    ds_read_b64_tr_b16 v[176:177], v17 offset:32
    ds_read_b64_tr_b16 v[178:179], v17 offset:3616
    ds_read_b64_tr_b16 v[180:181], v17 offset:7200
    ds_read_b64_tr_b16 v[182:183], v17 offset:10784
    ds_read_b64_tr_b16 v[184:185], v17 offset:64
    ds_read_b64_tr_b16 v[186:187], v17 offset:3648
    ds_read_b64_tr_b16 v[188:189], v17 offset:7232
    ds_read_b64_tr_b16 v[190:191], v17 offset:10816
    ds_read_b64_tr_b16 v[192:193], v17 offset:96
    ds_read_b64_tr_b16 v[194:195], v17 offset:3680
    ds_read_b64_tr_b16 v[196:197], v17 offset:7264
    ds_read_b64_tr_b16 v[198:199], v17 offset:10848
    s_mov_b32 s24, s23
    s_add_u32 s23, s23, 30720
    s_cmp_eq_u32 s23, 153600
    s_cselect_b32 s23, 0, s23
    v_add_u32 v16, s23, v10
    v_add_u32 v17, s23, v11
    s_mov_b32 s27, 13
.p2align 6
gu_loopA:
    s_waitcnt vmcnt(12) lgkmcnt(0)
    s_barrier
    v_mfma_f32_16x16x32_bf16 v[24:27], v[168:171], v[152:155], v[24:27]
    ds_read_b128 v[200:203], v16 offset:0
    v_mfma_f32_16x16x32_bf16 v[28:31], v[168:171], v[156:159], v[28:31]
    ds_read_b128 v[204:207], v16 offset:1024
    v_mfma_f32_16x16x32_bf16 v[32:35], v[168:171], v[160:163], v[32:35]
    v_mfma_f32_16x16x32_bf16 v[36:39], v[168:171], v[164:167], v[36:39]
    ds_read_b128 v[208:211], v16 offset:2048
    v_mfma_f32_16x16x32_bf16 v[52:55], v[172:175], v[164:167], v[52:55]
    ds_read_b128 v[212:215], v16 offset:3072
    v_mfma_f32_16x16x32_bf16 v[48:51], v[172:175], v[160:163], v[48:51]
    v_mfma_f32_16x16x32_bf16 v[44:47], v[172:175], v[156:159], v[44:47]
    ds_read_b64_tr_b16 v[216:217], v17 offset:0
    v_mfma_f32_16x16x32_bf16 v[40:43], v[172:175], v[152:155], v[40:43]
    ds_read_b64_tr_b16 v[218:219], v17 offset:3584
    v_mfma_f32_16x16x32_bf16 v[56:59], v[176:179], v[152:155], v[56:59]
    v_mfma_f32_16x16x32_bf16 v[60:63], v[176:179], v[156:159], v[60:63]
    ds_read_b64_tr_b16 v[220:221], v17 offset:7168
    v_mfma_f32_16x16x32_bf16 v[64:67], v[176:179], v[160:163], v[64:67]
    ds_read_b64_tr_b16 v[222:223], v17 offset:10752
    v_mfma_f32_16x16x32_bf16 v[68:71], v[176:179], v[164:167], v[68:71]
    v_mfma_f32_16x16x32_bf16 v[84:87], v[180:183], v[164:167], v[84:87]
    ds_read_b64_tr_b16 v[224:225], v17 offset:32
    v_mfma_f32_16x16x32_bf16 v[80:83], v[180:183], v[160:163], v[80:83]
    ds_read_b64_tr_b16 v[226:227], v17 offset:3616
    v_mfma_f32_16x16x32_bf16 v[76:79], v[180:183], v[156:159], v[76:79]
    v_mfma_f32_16x16x32_bf16 v[72:75], v[180:183], v[152:155], v[72:75]
    ds_read_b64_tr_b16 v[228:229], v17 offset:7200
    v_mfma_f32_16x16x32_bf16 v[88:91], v[184:187], v[152:155], v[88:91]
    ds_read_b64_tr_b16 v[230:231], v17 offset:10784
    v_mfma_f32_16x16x32_bf16 v[92:95], v[184:187], v[156:159], v[92:95]
    v_mfma_f32_16x16x32_bf16 v[96:99], v[184:187], v[160:163], v[96:99]
    ds_read_b64_tr_b16 v[232:233], v17 offset:64
    v_mfma_f32_16x16x32_bf16 v[100:103], v[184:187], v[164:167], v[100:103]
    ds_read_b64_tr_b16 v[234:235], v17 offset:3648
    v_mfma_f32_16x16x32_bf16 v[116:119], v[188:191], v[164:167], v[116:119]
    v_mfma_f32_16x16x32_bf16 v[112:115], v[188:191], v[160:163], v[112:115]
    ds_read_b64_tr_b16 v[236:237], v17 offset:7232
    v_mfma_f32_16x16x32_bf16 v[108:111], v[188:191], v[156:159], v[108:111]
    ds_read_b64_tr_b16 v[238:239], v17 offset:10816
    v_mfma_f32_16x16x32_bf16 v[104:107], v[188:191], v[152:155], v[104:107]
    v_mfma_f32_16x16x32_bf16 v[120:123], v[192:195], v[152:155], v[120:123]
    ds_read_b64_tr_b16 v[240:241], v17 offset:96
    v_mfma_f32_16x16x32_bf16 v[124:127], v[192:195], v[156:159], v[124:127]
    ds_read_b64_tr_b16 v[242:243], v17 offset:3680
    v_mfma_f32_16x16x32_bf16 v[128:131], v[192:195], v[160:163], v[128:131]
    v_mfma_f32_16x16x32_bf16 v[132:135], v[192:195], v[164:167], v[132:135]
    ds_read_b64_tr_b16 v[244:245], v17 offset:7264
    v_mfma_f32_16x16x32_bf16 v[148:151], v[196:199], v[164:167], v[148:151]
    ds_read_b64_tr_b16 v[246:247], v17 offset:10848
    v_mfma_f32_16x16x32_bf16 v[144:147], v[196:199], v[160:163], v[144:147]
    v_mfma_f32_16x16x32_bf16 v[140:143], v[196:199], v[156:159], v[140:143]
    v_mfma_f32_16x16x32_bf16 v[136:139], v[196:199], v[152:155], v[136:139]
    s_add_u32 m0, s24, s30
    s_mov_b32 s24, s23
    s_add_u32 s23, s23, 30720
    s_cmp_eq_u32 s23, 153600
    s_cselect_b32 s23, 0, s23
    v_add_u32 v16, s23, v10
    v_add_u32 v17, s23, v11
    buffer_load_dwordx4 v6, s[8:11], s25 offen sc1 lds
    buffer_load_dwordx4 v6, s[8:11], s25 offen offset:1024 sc1 lds
    buffer_load_dwordx4 v6, s[8:11], s25 offen offset:2048 sc1 lds
    buffer_load_dwordx4 v6, s[8:11], s25 offen offset:3072 sc1 lds
    s_add_u32 s25, s25, 0x20000
    s_waitcnt vmcnt(12) lgkmcnt(0)
    s_barrier
    v_mfma_f32_16x16x32_bf16 v[24:27], v[216:219], v[200:203], v[24:27]
    ds_read_b128 v[152:155], v16 offset:0
    v_mfma_f32_16x16x32_bf16 v[28:31], v[216:219], v[204:207], v[28:31]
    ds_read_b128 v[156:159], v16 offset:1024
    v_mfma_f32_16x16x32_bf16 v[32:35], v[216:219], v[208:211], v[32:35]
    v_mfma_f32_16x16x32_bf16 v[36:39], v[216:219], v[212:215], v[36:39]
    ds_read_b128 v[160:163], v16 offset:2048
    v_mfma_f32_16x16x32_bf16 v[52:55], v[220:223], v[212:215], v[52:55]
    ds_read_b128 v[164:167], v16 offset:3072
    v_mfma_f32_16x16x32_bf16 v[48:51], v[220:223], v[208:211], v[48:51]
    v_mfma_f32_16x16x32_bf16 v[44:47], v[220:223], v[204:207], v[44:47]
    ds_read_b64_tr_b16 v[168:169], v17 offset:0
    v_mfma_f32_16x16x32_bf16 v[40:43], v[220:223], v[200:203], v[40:43]
    ds_read_b64_tr_b16 v[170:171], v17 offset:3584
    v_mfma_f32_16x16x32_bf16 v[56:59], v[224:227], v[200:203], v[56:59]
    v_mfma_f32_16x16x32_bf16 v[60:63], v[224:227], v[204:207], v[60:63]
    ds_read_b64_tr_b16 v[172:173], v17 offset:7168
    v_mfma_f32_16x16x32_bf16 v[64:67], v[224:227], v[208:211], v[64:67]
    ds_read_b64_tr_b16 v[174:175], v17 offset:10752
    v_mfma_f32_16x16x32_bf16 v[68:71], v[224:227], v[212:215], v[68:71]
    v_mfma_f32_16x16x32_bf16 v[84:87], v[228:231], v[212:215], v[84:87]
    ds_read_b64_tr_b16 v[176:177], v17 offset:32
    v_mfma_f32_16x16x32_bf16 v[80:83], v[228:231], v[208:211], v[80:83]
    ds_read_b64_tr_b16 v[178:179], v17 offset:3616
    v_mfma_f32_16x16x32_bf16 v[76:79], v[228:231], v[204:207], v[76:79]
    v_mfma_f32_16x16x32_bf16 v[72:75], v[228:231], v[200:203], v[72:75]
    ds_read_b64_tr_b16 v[180:181], v17 offset:7200
    v_mfma_f32_16x16x32_bf16 v[88:91], v[232:235], v[200:203], v[88:91]
    ds_read_b64_tr_b16 v[182:183], v17 offset:10784
    v_mfma_f32_16x16x32_bf16 v[92:95], v[232:235], v[204:207], v[92:95]
    v_mfma_f32_16x16x32_bf16 v[96:99], v[232:235], v[208:211], v[96:99]
    ds_read_b64_tr_b16 v[184:185], v17 offset:64
    v_mfma_f32_16x16x32_bf16 v[100:103], v[232:235], v[212:215], v[100:103]
    ds_read_b64_tr_b16 v[186:187], v17 offset:3648
    v_mfma_f32_16x16x32_bf16 v[116:119], v[236:239], v[212:215], v[116:119]
    v_mfma_f32_16x16x32_bf16 v[112:115], v[236:239], v[208:211], v[112:115]
    ds_read_b64_tr_b16 v[188:189], v17 offset:7232
    v_mfma_f32_16x16x32_bf16 v[108:111], v[236:239], v[204:207], v[108:111]
    ds_read_b64_tr_b16 v[190:191], v17 offset:10816
    v_mfma_f32_16x16x32_bf16 v[104:107], v[236:239], v[200:203], v[104:107]
    v_mfma_f32_16x16x32_bf16 v[120:123], v[240:243], v[200:203], v[120:123]
    ds_read_b64_tr_b16 v[192:193], v17 offset:96
    v_mfma_f32_16x16x32_bf16 v[124:127], v[240:243], v[204:207], v[124:127]
    ds_read_b64_tr_b16 v[194:195], v17 offset:3680
    v_mfma_f32_16x16x32_bf16 v[128:131], v[240:243], v[208:211], v[128:131]
    v_mfma_f32_16x16x32_bf16 v[132:135], v[240:243], v[212:215], v[132:135]
    ds_read_b64_tr_b16 v[196:197], v17 offset:7264
    v_mfma_f32_16x16x32_bf16 v[148:151], v[244:247], v[212:215], v[148:151]
    ds_read_b64_tr_b16 v[198:199], v17 offset:10848
    v_mfma_f32_16x16x32_bf16 v[144:147], v[244:247], v[208:211], v[144:147]
    v_mfma_f32_16x16x32_bf16 v[140:143], v[244:247], v[204:207], v[140:143]
    v_mfma_f32_16x16x32_bf16 v[136:139], v[244:247], v[200:203], v[136:139]
    s_add_u32 m0, s24, s30
    s_mov_b32 s24, s23
    s_add_u32 s23, s23, 30720
    s_cmp_eq_u32 s23, 153600
    s_cselect_b32 s23, 0, s23
    v_add_u32 v16, s23, v10
    v_add_u32 v17, s23, v11
    buffer_load_dwordx4 v6, s[8:11], s25 offen sc1 lds
    buffer_load_dwordx4 v6, s[8:11], s25 offen offset:1024 sc1 lds
    buffer_load_dwordx4 v6, s[8:11], s25 offen offset:2048 sc1 lds
    buffer_load_dwordx4 v6, s[8:11], s25 offen offset:3072 sc1 lds
    s_add_u32 s25, s25, 0x20000
    s_sub_u32 s27, s27, 1
    s_cmp_lg_u32 s27, 0
    s_cbranch_scc1 gu_loopA
    s_waitcnt vmcnt(12) lgkmcnt(0)
    s_barrier
    v_mfma_f32_16x16x32_bf16 v[24:27], v[168:171], v[152:155], v[24:27]
    ds_read_b128 v[200:203], v16 offset:0
    v_mfma_f32_16x16x32_bf16 v[28:31], v[168:171], v[156:159], v[28:31]
    ds_read_b128 v[204:207], v16 offset:1024
    v_mfma_f32_16x16x32_bf16 v[32:35], v[168:171], v[160:163], v[32:35]
    v_mfma_f32_16x16x32_bf16 v[36:39], v[168:171], v[164:167], v[36:39]
    ds_read_b128 v[208:211], v16 offset:2048
    v_mfma_f32_16x16x32_bf16 v[52:55], v[172:175], v[164:167], v[52:55]
    ds_read_b128 v[212:215], v16 offset:3072
    v_mfma_f32_16x16x32_bf16 v[48:51], v[172:175], v[160:163], v[48:51]
    v_mfma_f32_16x16x32_bf16 v[44:47], v[172:175], v[156:159], v[44:47]
    ds_read_b64_tr_b16 v[216:217], v17 offset:0
    v_mfma_f32_16x16x32_bf16 v[40:43], v[172:175], v[152:155], v[40:43]
    ds_read_b64_tr_b16 v[218:219], v17 offset:3584
    v_mfma_f32_16x16x32_bf16 v[56:59], v[176:179], v[152:155], v[56:59]
    v_mfma_f32_16x16x32_bf16 v[60:63], v[176:179], v[156:159], v[60:63]
    ds_read_b64_tr_b16 v[220:221], v17 offset:7168
    v_mfma_f32_16x16x32_bf16 v[64:67], v[176:179], v[160:163], v[64:67]
    ds_read_b64_tr_b16 v[222:223], v17 offset:10752
    v_mfma_f32_16x16x32_bf16 v[68:71], v[176:179], v[164:167], v[68:71]
    v_mfma_f32_16x16x32_bf16 v[84:87], v[180:183], v[164:167], v[84:87]
    ds_read_b64_tr_b16 v[224:225], v17 offset:32
    v_mfma_f32_16x16x32_bf16 v[80:83], v[180:183], v[160:163], v[80:83]
    ds_read_b64_tr_b16 v[226:227], v17 offset:3616
    v_mfma_f32_16x16x32_bf16 v[76:79], v[180:183], v[156:159], v[76:79]
    v_mfma_f32_16x16x32_bf16 v[72:75], v[180:183], v[152:155], v[72:75]
    ds_read_b64_tr_b16 v[228:229], v17 offset:7200
    v_mfma_f32_16x16x32_bf16 v[88:91], v[184:187], v[152:155], v[88:91]
    ds_read_b64_tr_b16 v[230:231], v17 offset:10784
    v_mfma_f32_16x16x32_bf16 v[92:95], v[184:187], v[156:159], v[92:95]
    v_mfma_f32_16x16x32_bf16 v[96:99], v[184:187], v[160:163], v[96:99]
    ds_read_b64_tr_b16 v[232:233], v17 offset:64
    v_mfma_f32_16x16x32_bf16 v[100:103], v[184:187], v[164:167], v[100:103]
    ds_read_b64_tr_b16 v[234:235], v17 offset:3648
    v_mfma_f32_16x16x32_bf16 v[116:119], v[188:191], v[164:167], v[116:119]
    v_mfma_f32_16x16x32_bf16 v[112:115], v[188:191], v[160:163], v[112:115]
    ds_read_b64_tr_b16 v[236:237], v17 offset:7232
    v_mfma_f32_16x16x32_bf16 v[108:111], v[188:191], v[156:159], v[108:111]
    ds_read_b64_tr_b16 v[238:239], v17 offset:10816
    v_mfma_f32_16x16x32_bf16 v[104:107], v[188:191], v[152:155], v[104:107]
    v_mfma_f32_16x16x32_bf16 v[120:123], v[192:195], v[152:155], v[120:123]
    ds_read_b64_tr_b16 v[240:241], v17 offset:96
    v_mfma_f32_16x16x32_bf16 v[124:127], v[192:195], v[156:159], v[124:127]
    ds_read_b64_tr_b16 v[242:243], v17 offset:3680
    v_mfma_f32_16x16x32_bf16 v[128:131], v[192:195], v[160:163], v[128:131]
    v_mfma_f32_16x16x32_bf16 v[132:135], v[192:195], v[164:167], v[132:135]
    ds_read_b64_tr_b16 v[244:245], v17 offset:7264
    v_mfma_f32_16x16x32_bf16 v[148:151], v[196:199], v[164:167], v[148:151]
    ds_read_b64_tr_b16 v[246:247], v17 offset:10848
    v_mfma_f32_16x16x32_bf16 v[144:147], v[196:199], v[160:163], v[144:147]
    v_mfma_f32_16x16x32_bf16 v[140:143], v[196:199], v[156:159], v[140:143]
    v_mfma_f32_16x16x32_bf16 v[136:139], v[196:199], v[152:155], v[136:139]
    s_add_u32 m0, s24, s30
    s_mov_b32 s24, s23
    s_add_u32 s23, s23, 30720
    s_cmp_eq_u32 s23, 153600
    s_cselect_b32 s23, 0, s23
    v_add_u32 v16, s23, v10
    v_add_u32 v17, s23, v11
    buffer_load_dwordx4 v6, s[8:11], s25 offen sc1 lds
    buffer_load_dwordx4 v6, s[8:11], s25 offen offset:1024 sc1 lds
    buffer_load_dwordx4 v6, s[8:11], s25 offen offset:2048 sc1 lds
    buffer_load_dwordx4 v6, s[8:11], s25 offen offset:3072 sc1 lds
    s_add_u32 s25, s25, 0x20000
    s_waitcnt vmcnt(12) lgkmcnt(0)
    s_barrier
    v_mfma_f32_16x16x32_bf16 v[24:27], v[216:219], v[200:203], v[24:27]
    ds_read_b128 v[152:155], v16 offset:0
    v_mfma_f32_16x16x32_bf16 v[28:31], v[216:219], v[204:207], v[28:31]
    ds_read_b128 v[156:159], v16 offset:1024
    v_mfma_f32_16x16x32_bf16 v[32:35], v[216:219], v[208:211], v[32:35]
    ds_read_b128 v[160:163], v16 offset:2048
    v_mfma_f32_16x16x32_bf16 v[36:39], v[216:219], v[212:215], v[36:39]
    ds_read_b128 v[164:167], v16 offset:3072
    v_mfma_f32_16x16x32_bf16 v[52:55], v[220:223], v[212:215], v[52:55]
    ds_read_b64_tr_b16 v[168:169], v17 offset:0
    v_mfma_f32_16x16x32_bf16 v[48:51], v[220:223], v[208:211], v[48:51]
    ds_read_b64_tr_b16 v[170:171], v17 offset:3584
    v_mfma_f32_16x16x32_bf16 v[44:47], v[220:223], v[204:207], v[44:47]
    ds_read_b64_tr_b16 v[172:173], v17 offset:7168
    v_mfma_f32_16x16x32_bf16 v[40:43], v[220:223], v[200:203], v[40:43]
    ds_read_b64_tr_b16 v[174:175], v17 offset:10752
    v_mfma_f32_16x16x32_bf16 v[56:59], v[224:227], v[200:203], v[56:59]
    ds_read_b64_tr_b16 v[176:177], v17 offset:32
    v_mfma_f32_16x16x32_bf16 v[60:63], v[224:227], v[204:207], v[60:63]
    ds_read_b64_tr_b16 v[178:179], v17 offset:3616
    v_mfma_f32_16x16x32_bf16 v[64:67], v[224:227], v[208:211], v[64:67]
    ds_read_b64_tr_b16 v[180:181], v17 offset:7200
    v_mfma_f32_16x16x32_bf16 v[68:71], v[224:227], v[212:215], v[68:71]
    ds_read_b64_tr_b16 v[182:183], v17 offset:10784
    v_mfma_f32_16x16x32_bf16 v[84:87], v[228:231], v[212:215], v[84:87]
    ds_read_b64_tr_b16 v[184:185], v17 offset:64
    v_mfma_f32_16x16x32_bf16 v[80:83], v[228:231], v[208:211], v[80:83]
    ds_read_b64_tr_b16 v[186:187], v17 offset:3648
    v_mfma_f32_16x16x32_bf16 v[76:79], v[228:231], v[204:207], v[76:79]
    ds_read_b64_tr_b16 v[188:189], v17 offset:7232
    v_mfma_f32_16x16x32_bf16 v[72:75], v[228:231], v[200:203], v[72:75]
    ds_read_b64_tr_b16 v[190:191], v17 offset:10816
    v_mfma_f32_16x16x32_bf16 v[88:91], v[232:235], v[200:203], v[88:91]
    ds_read_b64_tr_b16 v[192:193], v17 offset:96
    v_mfma_f32_16x16x32_bf16 v[92:95], v[232:235], v[204:207], v[92:95]
    ds_read_b64_tr_b16 v[194:195], v17 offset:3680
    v_mfma_f32_16x16x32_bf16 v[96:99], v[232:235], v[208:211], v[96:99]
    ds_read_b64_tr_b16 v[196:197], v17 offset:7264
    v_mfma_f32_16x16x32_bf16 v[100:103], v[232:235], v[212:215], v[100:103]
    ds_read_b64_tr_b16 v[198:199], v17 offset:10848
    v_mfma_f32_16x16x32_bf16 v[116:119], v[236:239], v[212:215], v[116:119]
    v_mfma_f32_16x16x32_bf16 v[112:115], v[236:239], v[208:211], v[112:115]
    v_mfma_f32_16x16x32_bf16 v[108:111], v[236:239], v[204:207], v[108:111]
    v_mfma_f32_16x16x32_bf16 v[104:107], v[236:239], v[200:203], v[104:107]
    v_mfma_f32_16x16x32_bf16 v[120:123], v[240:243], v[200:203], v[120:123]
    v_mfma_f32_16x16x32_bf16 v[124:127], v[240:243], v[204:207], v[124:127]
    v_mfma_f32_16x16x32_bf16 v[128:131], v[240:243], v[208:211], v[128:131]
    v_mfma_f32_16x16x32_bf16 v[132:135], v[240:243], v[212:215], v[132:135]
    v_mfma_f32_16x16x32_bf16 v[148:151], v[244:247], v[212:215], v[148:151]
    v_mfma_f32_16x16x32_bf16 v[144:147], v[244:247], v[208:211], v[144:147]
    v_mfma_f32_16x16x32_bf16 v[140:143], v[244:247], v[204:207], v[140:143]
    v_mfma_f32_16x16x32_bf16 v[136:139], v[244:247], v[200:203], v[136:139]
    s_getpc_b64 s[56:57]
    ct_20:
    s_add_u32 s56, s56, gu_epiA-ct_20
    s_addc_u32 s57, s57, 0
    s_and_b32 s56, s56, 0xffffff80
    s_mov_b32 s58, code_end-gu_epiA
    s_mov_b32 s59, 0x20000
    v_lshlrev_b32 v252, 7, v1
    s_lshl_b32 s28, s31, 13
    buffer_load_dword v251, v252, s[56:59], s28 offen
    s_mov_b32 s24, s23
    s_add_u32 s23, s23, 30720
    s_cmp_eq_u32 s23, 153600
    s_cselect_b32 s23, 0, s23
    v_add_u32 v16, s23, v10
    v_add_u32 v17, s23, v11
    s_waitcnt vmcnt(9) lgkmcnt(0)
    s_barrier
    v_mfma_f32_16x16x32_bf16 v[24:27], v[168:171], v[152:155], v[24:27]
    ds_read_b128 v[200:203], v16 offset:0
    v_mfma_f32_16x16x32_bf16 v[28:31], v[168:171], v[156:159], v[28:31]
    ds_read_b128 v[204:207], v16 offset:1024
    v_mfma_f32_16x16x32_bf16 v[32:35], v[168:171], v[160:163], v[32:35]
    ds_read_b128 v[208:211], v16 offset:2048
    v_mfma_f32_16x16x32_bf16 v[36:39], v[168:171], v[164:167], v[36:39]
    ds_read_b128 v[212:215], v16 offset:3072
    v_mfma_f32_16x16x32_bf16 v[52:55], v[172:175], v[164:167], v[52:55]
    ds_read_b64_tr_b16 v[216:217], v17 offset:0
    v_mfma_f32_16x16x32_bf16 v[48:51], v[172:175], v[160:163], v[48:51]
    ds_read_b64_tr_b16 v[218:219], v17 offset:3584
    v_mfma_f32_16x16x32_bf16 v[44:47], v[172:175], v[156:159], v[44:47]
    ds_read_b64_tr_b16 v[220:221], v17 offset:7168
    v_mfma_f32_16x16x32_bf16 v[40:43], v[172:175], v[152:155], v[40:43]
    ds_read_b64_tr_b16 v[222:223], v17 offset:10752
    v_mfma_f32_16x16x32_bf16 v[56:59], v[176:179], v[152:155], v[56:59]
    ds_read_b64_tr_b16 v[224:225], v17 offset:32
    v_mfma_f32_16x16x32_bf16 v[60:63], v[176:179], v[156:159], v[60:63]
    ds_read_b64_tr_b16 v[226:227], v17 offset:3616
    v_mfma_f32_16x16x32_bf16 v[64:67], v[176:179], v[160:163], v[64:67]
    ds_read_b64_tr_b16 v[228:229], v17 offset:7200
    v_mfma_f32_16x16x32_bf16 v[68:71], v[176:179], v[164:167], v[68:71]
    ds_read_b64_tr_b16 v[230:231], v17 offset:10784
    v_mfma_f32_16x16x32_bf16 v[84:87], v[180:183], v[164:167], v[84:87]
    ds_read_b64_tr_b16 v[232:233], v17 offset:64
    v_mfma_f32_16x16x32_bf16 v[80:83], v[180:183], v[160:163], v[80:83]
    ds_read_b64_tr_b16 v[234:235], v17 offset:3648
    v_mfma_f32_16x16x32_bf16 v[76:79], v[180:183], v[156:159], v[76:79]
    ds_read_b64_tr_b16 v[236:237], v17 offset:7232
    v_mfma_f32_16x16x32_bf16 v[72:75], v[180:183], v[152:155], v[72:75]
    ds_read_b64_tr_b16 v[238:239], v17 offset:10816
    v_mfma_f32_16x16x32_bf16 v[88:91], v[184:187], v[152:155], v[88:91]
    ds_read_b64_tr_b16 v[240:241], v17 offset:96
    v_mfma_f32_16x16x32_bf16 v[92:95], v[184:187], v[156:159], v[92:95]
    ds_read_b64_tr_b16 v[242:243], v17 offset:3680
    v_mfma_f32_16x16x32_bf16 v[96:99], v[184:187], v[160:163], v[96:99]
    ds_read_b64_tr_b16 v[244:245], v17 offset:7264
    v_mfma_f32_16x16x32_bf16 v[100:103], v[184:187], v[164:167], v[100:103]
    ds_read_b64_tr_b16 v[246:247], v17 offset:10848
    v_mfma_f32_16x16x32_bf16 v[116:119], v[188:191], v[164:167], v[116:119]
    v_mfma_f32_16x16x32_bf16 v[112:115], v[188:191], v[160:163], v[112:115]
    v_mfma_f32_16x16x32_bf16 v[108:111], v[188:191], v[156:159], v[108:111]
    v_mfma_f32_16x16x32_bf16 v[104:107], v[188:191], v[152:155], v[104:107]
    v_mfma_f32_16x16x32_bf16 v[120:123], v[192:195], v[152:155], v[120:123]
    v_mfma_f32_16x16x32_bf16 v[124:127], v[192:195], v[156:159], v[124:127]
    v_mfma_f32_16x16x32_bf16 v[128:131], v[192:195], v[160:163], v[128:131]
    v_mfma_f32_16x16x32_bf16 v[132:135], v[192:195], v[164:167], v[132:135]
    v_mfma_f32_16x16x32_bf16 v[148:151], v[196:199], v[164:167], v[148:151]
    v_mfma_f32_16x16x32_bf16 v[144:147], v[196:199], v[160:163], v[144:147]
    v_mfma_f32_16x16x32_bf16 v[140:143], v[196:199], v[156:159], v[140:143]
    v_mfma_f32_16x16x32_bf16 v[136:139], v[196:199], v[152:155], v[136:139]
    s_mov_b32 s24, s23
    s_add_u32 s23, s23, 30720
    s_cmp_eq_u32 s23, 153600
    s_cselect_b32 s23, 0, s23
    v_add_u32 v16, s23, v10
    v_add_u32 v17, s23, v11
    s_waitcnt vmcnt(5) lgkmcnt(0)
    s_barrier
    v_mfma_f32_16x16x32_bf16 v[24:27], v[216:219], v[200:203], v[24:27]
    ds_read_b128 v[152:155], v16 offset:0
    v_mfma_f32_16x16x32_bf16 v[28:31], v[216:219], v[204:207], v[28:31]
    ds_read_b128 v[156:159], v16 offset:1024
    v_mfma_f32_16x16x32_bf16 v[32:35], v[216:219], v[208:211], v[32:35]
    ds_read_b128 v[160:163], v16 offset:2048
    v_mfma_f32_16x16x32_bf16 v[36:39], v[216:219], v[212:215], v[36:39]
    ds_read_b128 v[164:167], v16 offset:3072
    v_mfma_f32_16x16x32_bf16 v[52:55], v[220:223], v[212:215], v[52:55]
    ds_read_b64_tr_b16 v[168:169], v17 offset:0
    v_mfma_f32_16x16x32_bf16 v[48:51], v[220:223], v[208:211], v[48:51]
    ds_read_b64_tr_b16 v[170:171], v17 offset:3584
    v_mfma_f32_16x16x32_bf16 v[44:47], v[220:223], v[204:207], v[44:47]
    ds_read_b64_tr_b16 v[172:173], v17 offset:7168
    v_mfma_f32_16x16x32_bf16 v[40:43], v[220:223], v[200:203], v[40:43]
    ds_read_b64_tr_b16 v[174:175], v17 offset:10752
    v_mfma_f32_16x16x32_bf16 v[56:59], v[224:227], v[200:203], v[56:59]
    ds_read_b64_tr_b16 v[176:177], v17 offset:32
    v_mfma_f32_16x16x32_bf16 v[60:63], v[224:227], v[204:207], v[60:63]
    ds_read_b64_tr_b16 v[178:179], v17 offset:3616
    v_mfma_f32_16x16x32_bf16 v[64:67], v[224:227], v[208:211], v[64:67]
    ds_read_b64_tr_b16 v[180:181], v17 offset:7200
    v_mfma_f32_16x16x32_bf16 v[68:71], v[224:227], v[212:215], v[68:71]
    ds_read_b64_tr_b16 v[182:183], v17 offset:10784
    v_mfma_f32_16x16x32_bf16 v[84:87], v[228:231], v[212:215], v[84:87]
    ds_read_b64_tr_b16 v[184:185], v17 offset:64
    v_mfma_f32_16x16x32_bf16 v[80:83], v[228:231], v[208:211], v[80:83]
    ds_read_b64_tr_b16 v[186:187], v17 offset:3648
    v_mfma_f32_16x16x32_bf16 v[76:79], v[228:231], v[204:207], v[76:79]
    ds_read_b64_tr_b16 v[188:189], v17 offset:7232
    v_mfma_f32_16x16x32_bf16 v[72:75], v[228:231], v[200:203], v[72:75]
    ds_read_b64_tr_b16 v[190:191], v17 offset:10816
    v_mfma_f32_16x16x32_bf16 v[88:91], v[232:235], v[200:203], v[88:91]
    ds_read_b64_tr_b16 v[192:193], v17 offset:96
    v_mfma_f32_16x16x32_bf16 v[92:95], v[232:235], v[204:207], v[92:95]
    ds_read_b64_tr_b16 v[194:195], v17 offset:3680
    v_mfma_f32_16x16x32_bf16 v[96:99], v[232:235], v[208:211], v[96:99]
    ds_read_b64_tr_b16 v[196:197], v17 offset:7264
    v_mfma_f32_16x16x32_bf16 v[100:103], v[232:235], v[212:215], v[100:103]
    ds_read_b64_tr_b16 v[198:199], v17 offset:10848
    v_mfma_f32_16x16x32_bf16 v[116:119], v[236:239], v[212:215], v[116:119]
    v_mfma_f32_16x16x32_bf16 v[112:115], v[236:239], v[208:211], v[112:115]
    v_mfma_f32_16x16x32_bf16 v[108:111], v[236:239], v[204:207], v[108:111]
    v_mfma_f32_16x16x32_bf16 v[104:107], v[236:239], v[200:203], v[104:107]
    v_mfma_f32_16x16x32_bf16 v[120:123], v[240:243], v[200:203], v[120:123]
    v_mfma_f32_16x16x32_bf16 v[124:127], v[240:243], v[204:207], v[124:127]
    v_mfma_f32_16x16x32_bf16 v[128:131], v[240:243], v[208:211], v[128:131]
    v_mfma_f32_16x16x32_bf16 v[132:135], v[240:243], v[212:215], v[132:135]
    v_mfma_f32_16x16x32_bf16 v[148:151], v[244:247], v[212:215], v[148:151]
    v_mfma_f32_16x16x32_bf16 v[144:147], v[244:247], v[208:211], v[144:147]
    v_mfma_f32_16x16x32_bf16 v[140:143], v[244:247], v[204:207], v[140:143]
    v_mfma_f32_16x16x32_bf16 v[136:139], v[244:247], v[200:203], v[136:139]
    s_mov_b32 s24, s23
    s_add_u32 s23, s23, 30720
    s_cmp_eq_u32 s23, 153600
    s_cselect_b32 s23, 0, s23
    v_add_u32 v16, s23, v10
    v_add_u32 v17, s23, v11
    s_waitcnt vmcnt(1) lgkmcnt(0)
    s_barrier
    v_mfma_f32_16x16x32_bf16 v[24:27], v[168:171], v[152:155], v[24:27]
    ds_read_b128 v[200:203], v16 offset:0
    v_mfma_f32_16x16x32_bf16 v[28:31], v[168:171], v[156:159], v[28:31]
    ds_read_b128 v[204:207], v16 offset:1024
    v_mfma_f32_16x16x32_bf16 v[32:35], v[168:171], v[160:163], v[32:35]
    ds_read_b128 v[208:211], v16 offset:2048
    v_mfma_f32_16x16x32_bf16 v[36:39], v[168:171], v[164:167], v[36:39]
    ds_read_b128 v[212:215], v16 offset:3072
    v_mfma_f32_16x16x32_bf16 v[52:55], v[172:175], v[164:167], v[52:55]
    ds_read_b64_tr_b16 v[216:217], v17 offset:0
    v_mfma_f32_16x16x32_bf16 v[48:51], v[172:175], v[160:163], v[48:51]
    ds_read_b64_tr_b16 v[218:219], v17 offset:3584
    v_mfma_f32_16x16x32_bf16 v[44:47], v[172:175], v[156:159], v[44:47]
    ds_read_b64_tr_b16 v[220:221], v17 offset:7168
    v_mfma_f32_16x16x32_bf16 v[40:43], v[172:175], v[152:155], v[40:43]
    ds_read_b64_tr_b16 v[222:223], v17 offset:10752
    v_mfma_f32_16x16x32_bf16 v[56:59], v[176:179], v[152:155], v[56:59]
    ds_read_b64_tr_b16 v[224:225], v17 offset:32
    v_mfma_f32_16x16x32_bf16 v[60:63], v[176:179], v[156:159], v[60:63]
    ds_read_b64_tr_b16 v[226:227], v17 offset:3616
    v_mfma_f32_16x16x32_bf16 v[64:67], v[176:179], v[160:163], v[64:67]
    ds_read_b64_tr_b16 v[228:229], v17 offset:7200
    v_mfma_f32_16x16x32_bf16 v[68:71], v[176:179], v[164:167], v[68:71]
    ds_read_b64_tr_b16 v[230:231], v17 offset:10784
    v_mfma_f32_16x16x32_bf16 v[84:87], v[180:183], v[164:167], v[84:87]
    ds_read_b64_tr_b16 v[232:233], v17 offset:64
    v_mfma_f32_16x16x32_bf16 v[80:83], v[180:183], v[160:163], v[80:83]
    ds_read_b64_tr_b16 v[234:235], v17 offset:3648
    v_mfma_f32_16x16x32_bf16 v[76:79], v[180:183], v[156:159], v[76:79]
    ds_read_b64_tr_b16 v[236:237], v17 offset:7232
    v_mfma_f32_16x16x32_bf16 v[72:75], v[180:183], v[152:155], v[72:75]
    ds_read_b64_tr_b16 v[238:239], v17 offset:10816
    v_mfma_f32_16x16x32_bf16 v[88:91], v[184:187], v[152:155], v[88:91]
    ds_read_b64_tr_b16 v[240:241], v17 offset:96
    v_mfma_f32_16x16x32_bf16 v[92:95], v[184:187], v[156:159], v[92:95]
    ds_read_b64_tr_b16 v[242:243], v17 offset:3680
    v_mfma_f32_16x16x32_bf16 v[96:99], v[184:187], v[160:163], v[96:99]
    ds_read_b64_tr_b16 v[244:245], v17 offset:7264
    v_mfma_f32_16x16x32_bf16 v[100:103], v[184:187], v[164:167], v[100:103]
    ds_read_b64_tr_b16 v[246:247], v17 offset:10848
    v_mfma_f32_16x16x32_bf16 v[116:119], v[188:191], v[164:167], v[116:119]
    v_mfma_f32_16x16x32_bf16 v[112:115], v[188:191], v[160:163], v[112:115]
    v_mfma_f32_16x16x32_bf16 v[108:111], v[188:191], v[156:159], v[108:111]
    v_mfma_f32_16x16x32_bf16 v[104:107], v[188:191], v[152:155], v[104:107]
    v_mfma_f32_16x16x32_bf16 v[120:123], v[192:195], v[152:155], v[120:123]
    v_mfma_f32_16x16x32_bf16 v[124:127], v[192:195], v[156:159], v[124:127]
    v_mfma_f32_16x16x32_bf16 v[128:131], v[192:195], v[160:163], v[128:131]
    v_mfma_f32_16x16x32_bf16 v[132:135], v[192:195], v[164:167], v[132:135]
    v_mfma_f32_16x16x32_bf16 v[148:151], v[196:199], v[164:167], v[148:151]
    v_mfma_f32_16x16x32_bf16 v[144:147], v[196:199], v[160:163], v[144:147]
    v_mfma_f32_16x16x32_bf16 v[140:143], v[196:199], v[156:159], v[140:143]
    v_mfma_f32_16x16x32_bf16 v[136:139], v[196:199], v[152:155], v[136:139]
    s_mov_b32 s24, s23
    s_add_u32 s23, s23, 30720
    s_cmp_eq_u32 s23, 153600
    s_cselect_b32 s23, 0, s23
    v_add_u32 v16, s23, v10
    v_add_u32 v17, s23, v11
    s_waitcnt lgkmcnt(0)
    v_mfma_f32_16x16x32_bf16 v[24:27], v[216:219], v[200:203], v[24:27]
    v_mfma_f32_16x16x32_bf16 v[28:31], v[216:219], v[204:207], v[28:31]
    v_mfma_f32_16x16x32_bf16 v[32:35], v[216:219], v[208:211], v[32:35]
    v_mfma_f32_16x16x32_bf16 v[36:39], v[216:219], v[212:215], v[36:39]
    v_mfma_f32_16x16x32_bf16 v[52:55], v[220:223], v[212:215], v[52:55]
    v_mfma_f32_16x16x32_bf16 v[48:51], v[220:223], v[208:211], v[48:51]
    v_mfma_f32_16x16x32_bf16 v[44:47], v[220:223], v[204:207], v[44:47]
    v_mfma_f32_16x16x32_bf16 v[40:43], v[220:223], v[200:203], v[40:43]
    v_mfma_f32_16x16x32_bf16 v[56:59], v[224:227], v[200:203], v[56:59]
    v_mfma_f32_16x16x32_bf16 v[60:63], v[224:227], v[204:207], v[60:63]
    v_mfma_f32_16x16x32_bf16 v[64:67], v[224:227], v[208:211], v[64:67]
    v_mfma_f32_16x16x32_bf16 v[68:71], v[224:227], v[212:215], v[68:71]
    v_mfma_f32_16x16x32_bf16 v[84:87], v[228:231], v[212:215], v[84:87]
    v_mfma_f32_16x16x32_bf16 v[80:83], v[228:231], v[208:211], v[80:83]
    v_mfma_f32_16x16x32_bf16 v[76:79], v[228:231], v[204:207], v[76:79]
    v_mfma_f32_16x16x32_bf16 v[72:75], v[228:231], v[200:203], v[72:75]
    v_mfma_f32_16x16x32_bf16 v[88:91], v[232:235], v[200:203], v[88:91]
    v_mfma_f32_16x16x32_bf16 v[92:95], v[232:235], v[204:207], v[92:95]
    v_mfma_f32_16x16x32_bf16 v[96:99], v[232:235], v[208:211], v[96:99]
    v_mfma_f32_16x16x32_bf16 v[100:103], v[232:235], v[212:215], v[100:103]
    v_mfma_f32_16x16x32_bf16 v[116:119], v[236:239], v[212:215], v[116:119]
    v_mfma_f32_16x16x32_bf16 v[112:115], v[236:239], v[208:211], v[112:115]
    v_mfma_f32_16x16x32_bf16 v[108:111], v[236:239], v[204:207], v[108:111]
    v_mfma_f32_16x16x32_bf16 v[104:107], v[236:239], v[200:203], v[104:107]
    v_mfma_f32_16x16x32_bf16 v[120:123], v[240:243], v[200:203], v[120:123]
    v_mfma_f32_16x16x32_bf16 v[124:127], v[240:243], v[204:207], v[124:127]
    v_mfma_f32_16x16x32_bf16 v[128:131], v[240:243], v[208:211], v[128:131]
    v_mfma_f32_16x16x32_bf16 v[132:135], v[240:243], v[212:215], v[132:135]
    v_mfma_f32_16x16x32_bf16 v[148:151], v[244:247], v[212:215], v[148:151]
    v_mfma_f32_16x16x32_bf16 v[144:147], v[244:247], v[208:211], v[144:147]
    v_mfma_f32_16x16x32_bf16 v[140:143], v[244:247], v[204:207], v[140:143]
    v_mfma_f32_16x16x32_bf16 v[136:139], v[244:247], v[200:203], v[136:139]
    s_nop 7
gu_epiA:
    s_load_dwordx2 s[44:45], s[0:1], 56
    s_load_dwordx2 s[46:47], s[0:1], 64
    s_lshl_b32 s28, s31, 10
    s_add_u32 s28, s28, 153600
    v_lshlrev_b32 v14, 4, v5
    v_add_u32 v14, s28, v14
    ds_read_b128 v[232:235], v14 offset:0
    ds_read_b128 v[236:239], v14 offset:256
    ds_read_b128 v[240:243], v14 offset:512
    ds_read_b128 v[244:247], v14 offset:768
    s_lshl_b32 s28, s31, 9
    s_add_u32 s28, s28, 158720
    v_lshlrev_b32 v14, 3, v5
    v_add_u32 v14, s28, v14
    ds_read_b64 v[184:185], v14 offset:0
    ds_read_b64 v[186:187], v14 offset:128
    ds_read_b64 v[188:189], v14 offset:256
    ds_read_b64 v[190:191], v14 offset:384
    v_lshlrev_b32 v9, 4, v2
    s_lshl_b32 s28, s37, 6
    s_add_u32 s28, s28, 157696
    v_add_u32 v14, s28, v9
    s_lshl_b32 s28, s39, 6
    s_add_u32 s28, s28, 157696
    v_add_u32 v15, s28, v9
    ds_read_b128 v[200:203], v14 offset:0
    ds_read_b128 v[204:207], v14 offset:448
    ds_read_b128 v[208:211], v14 offset:64
    ds_read_b128 v[212:215], v14 offset:512
    ds_read_b128 v[216:219], v14 offset:128
    ds_read_b128 v[220:223], v14 offset:576
    ds_read_b128 v[224:227], v14 offset:192
    ds_read_b128 v[228:231], v14 offset:640
    s_mul_i32 s28, s22, 7
    s_add_u32 s29, s28, s37
    s_lshr_b32 s29, s29, 1
    s_lshl_b32 s29, s29, 17
    s_lshl_b32 s33, s21, 4
    s_lshl_b32 s36, s31, 2
    s_add_u32 s33, s33, s36
    s_lshl_b32 s33, s33, 10
    s_add_u32 s56, s29, s33
    s_add_u32 s57, s56, 0x20000
    s_add_u32 s29, s28, s39
    s_and_b32 s36, s29, 1
    s_lshl_b32 s36, s36, 3
    s_lshr_b32 s29, s29, 1
    s_lshl_b32 s29, s29, 17
    s_add_u32 s58, s29, s33
    s_add_u32 s58, s58, s36
    s_waitcnt lgkmcnt(0)
    s_barrier
    v_pk_fma_f32 v[24:25], v[200:201], v[232:233], v[24:25]
    v_pk_fma_f32 v[26:27], v[202:203], v[232:233], v[26:27]
    v_pk_fma_f32 v[40:41], v[204:205], v[232:233], v[40:41]
    v_pk_fma_f32 v[42:43], v[206:207], v[232:233], v[42:43]
    v_pk_fma_f32 v[56:57], v[208:209], v[232:233], v[56:57]
    v_pk_fma_f32 v[58:59], v[210:211], v[232:233], v[58:59]
    v_pk_fma_f32 v[72:73], v[212:213], v[232:233], v[72:73]
    v_pk_fma_f32 v[74:75], v[214:215], v[232:233], v[74:75]
    v_pk_mul_f32 v[24:25], v[24:25], v[234:235]
    v_pk_mul_f32 v[26:27], v[26:27], v[234:235]
    v_pk_mul_f32 v[56:57], v[56:57], v[234:235]
    v_pk_mul_f32 v[58:59], v[58:59], v[234:235]
    v_exp_f32 v24, v24
    v_exp_f32 v25, v25
    v_exp_f32 v26, v26
    v_exp_f32 v27, v27
    v_exp_f32 v56, v56
    v_exp_f32 v57, v57
    v_exp_f32 v58, v58
    v_exp_f32 v59, v59
    v_pk_fma_f32 v[24:25], v[24:25], v[184:185], v[184:185]
    v_pk_fma_f32 v[26:27], v[26:27], v[184:185], v[184:185]
    v_pk_fma_f32 v[56:57], v[56:57], v[184:185], v[184:185]
    v_pk_fma_f32 v[58:59], v[58:59], v[184:185], v[184:185]
    v_rcp_f32 v24, v24
    v_rcp_f32 v25, v25
    v_rcp_f32 v26, v26
    v_rcp_f32 v27, v27
    v_rcp_f32 v56, v56
    v_rcp_f32 v57, v57
    v_rcp_f32 v58, v58
    v_rcp_f32 v59, v59
    v_pk_mul_f32 v[40:41], v[40:41], v[24:25]
    v_pk_mul_f32 v[42:43], v[42:43], v[26:27]
    v_pk_mul_f32 v[72:73], v[72:73], v[56:57]
    v_pk_mul_f32 v[74:75], v[74:75], v[58:59]
    v_cvt_pk_bf16_f32 v152, v40, v41
    v_cvt_pk_bf16_f32 v153, v42, v43
    v_cvt_pk_bf16_f32 v154, v72, v73
    v_cvt_pk_bf16_f32 v155, v74, v75
    buffer_store_dwordx4 v[152:155], v6, s[52:55], s56 offen offset:0 sc1
    v_pk_fma_f32 v[28:29], v[200:201], v[236:237], v[28:29]
    v_pk_fma_f32 v[30:31], v[202:203], v[236:237], v[30:31]
    v_pk_fma_f32 v[44:45], v[204:205], v[236:237], v[44:45]
    v_pk_fma_f32 v[46:47], v[206:207], v[236:237], v[46:47]
    v_pk_fma_f32 v[60:61], v[208:209], v[236:237], v[60:61]
    v_pk_fma_f32 v[62:63], v[210:211], v[236:237], v[62:63]
    v_pk_fma_f32 v[76:77], v[212:213], v[236:237], v[76:77]
    v_pk_fma_f32 v[78:79], v[214:215], v[236:237], v[78:79]
    v_pk_mul_f32 v[28:29], v[28:29], v[238:239]
    v_pk_mul_f32 v[30:31], v[30:31], v[238:239]
    v_pk_mul_f32 v[60:61], v[60:61], v[238:239]
    v_pk_mul_f32 v[62:63], v[62:63], v[238:239]
    v_exp_f32 v28, v28
    v_exp_f32 v29, v29
    v_exp_f32 v30, v30
    v_exp_f32 v31, v31
    v_exp_f32 v60, v60
    v_exp_f32 v61, v61
    v_exp_f32 v62, v62
    v_exp_f32 v63, v63
    v_pk_fma_f32 v[28:29], v[28:29], v[186:187], v[186:187]
    v_pk_fma_f32 v[30:31], v[30:31], v[186:187], v[186:187]
    v_pk_fma_f32 v[60:61], v[60:61], v[186:187], v[186:187]
    v_pk_fma_f32 v[62:63], v[62:63], v[186:187], v[186:187]
    v_rcp_f32 v28, v28
    v_rcp_f32 v29, v29
    v_rcp_f32 v30, v30
    v_rcp_f32 v31, v31
    v_rcp_f32 v60, v60
    v_rcp_f32 v61, v61
    v_rcp_f32 v62, v62
    v_rcp_f32 v63, v63
    v_pk_mul_f32 v[44:45], v[44:45], v[28:29]
    v_pk_mul_f32 v[46:47], v[46:47], v[30:31]
    v_pk_mul_f32 v[76:77], v[76:77], v[60:61]
    v_pk_mul_f32 v[78:79], v[78:79], v[62:63]
    v_cvt_pk_bf16_f32 v156, v44, v45
    v_cvt_pk_bf16_f32 v157, v46, v47
    v_cvt_pk_bf16_f32 v158, v76, v77
    v_cvt_pk_bf16_f32 v159, v78, v79
    buffer_store_dwordx4 v[156:159], v6, s[52:55], s56 offen offset:1024 sc1
    v_pk_fma_f32 v[32:33], v[200:201], v[240:241], v[32:33]
    v_pk_fma_f32 v[34:35], v[202:203], v[240:241], v[34:35]
    v_pk_fma_f32 v[48:49], v[204:205], v[240:241], v[48:49]
    v_pk_fma_f32 v[50:51], v[206:207], v[240:241], v[50:51]
    v_pk_fma_f32 v[64:65], v[208:209], v[240:241], v[64:65]
    v_pk_fma_f32 v[66:67], v[210:211], v[240:241], v[66:67]
    v_pk_fma_f32 v[80:81], v[212:213], v[240:241], v[80:81]
    v_pk_fma_f32 v[82:83], v[214:215], v[240:241], v[82:83]
    v_pk_mul_f32 v[32:33], v[32:33], v[242:243]
    v_pk_mul_f32 v[34:35], v[34:35], v[242:243]
    v_pk_mul_f32 v[64:65], v[64:65], v[242:243]
    v_pk_mul_f32 v[66:67], v[66:67], v[242:243]
    v_exp_f32 v32, v32
    v_exp_f32 v33, v33
    v_exp_f32 v34, v34
    v_exp_f32 v35, v35
    v_exp_f32 v64, v64
    v_exp_f32 v65, v65
    v_exp_f32 v66, v66
    v_exp_f32 v67, v67
    v_pk_fma_f32 v[32:33], v[32:33], v[188:189], v[188:189]
    v_pk_fma_f32 v[34:35], v[34:35], v[188:189], v[188:189]
    v_pk_fma_f32 v[64:65], v[64:65], v[188:189], v[188:189]
    v_pk_fma_f32 v[66:67], v[66:67], v[188:189], v[188:189]
    v_rcp_f32 v32, v32
    v_rcp_f32 v33, v33
    v_rcp_f32 v34, v34
    v_rcp_f32 v35, v35
    v_rcp_f32 v64, v64
    v_rcp_f32 v65, v65
    v_rcp_f32 v66, v66
    v_rcp_f32 v67, v67
    v_pk_mul_f32 v[48:49], v[48:49], v[32:33]
    v_pk_mul_f32 v[50:51], v[50:51], v[34:35]
    v_pk_mul_f32 v[80:81], v[80:81], v[64:65]
    v_pk_mul_f32 v[82:83], v[82:83], v[66:67]
    v_cvt_pk_bf16_f32 v160, v48, v49
    v_cvt_pk_bf16_f32 v161, v50, v51
    v_cvt_pk_bf16_f32 v162, v80, v81
    v_cvt_pk_bf16_f32 v163, v82, v83
    buffer_store_dwordx4 v[160:163], v6, s[52:55], s56 offen offset:2048 sc1
    v_pk_fma_f32 v[36:37], v[200:201], v[244:245], v[36:37]
    v_pk_fma_f32 v[38:39], v[202:203], v[244:245], v[38:39]
    v_pk_fma_f32 v[52:53], v[204:205], v[244:245], v[52:53]
    v_pk_fma_f32 v[54:55], v[206:207], v[244:245], v[54:55]
    v_pk_fma_f32 v[68:69], v[208:209], v[244:245], v[68:69]
    v_pk_fma_f32 v[70:71], v[210:211], v[244:245], v[70:71]
    v_pk_fma_f32 v[84:85], v[212:213], v[244:245], v[84:85]
    v_pk_fma_f32 v[86:87], v[214:215], v[244:245], v[86:87]
    v_pk_mul_f32 v[36:37], v[36:37], v[246:247]
    v_pk_mul_f32 v[38:39], v[38:39], v[246:247]
    v_pk_mul_f32 v[68:69], v[68:69], v[246:247]
    v_pk_mul_f32 v[70:71], v[70:71], v[246:247]
    v_exp_f32 v36, v36
    v_exp_f32 v37, v37
    v_exp_f32 v38, v38
    v_exp_f32 v39, v39
    v_exp_f32 v68, v68
    v_exp_f32 v69, v69
    v_exp_f32 v70, v70
    v_exp_f32 v71, v71
    v_pk_fma_f32 v[36:37], v[36:37], v[190:191], v[190:191]
    v_pk_fma_f32 v[38:39], v[38:39], v[190:191], v[190:191]
    v_pk_fma_f32 v[68:69], v[68:69], v[190:191], v[190:191]
    v_pk_fma_f32 v[70:71], v[70:71], v[190:191], v[190:191]
    v_rcp_f32 v36, v36
    v_rcp_f32 v37, v37
    v_rcp_f32 v38, v38
    v_rcp_f32 v39, v39
    v_rcp_f32 v68, v68
    v_rcp_f32 v69, v69
    v_rcp_f32 v70, v70
    v_rcp_f32 v71, v71
    v_pk_mul_f32 v[52:53], v[52:53], v[36:37]
    v_pk_mul_f32 v[54:55], v[54:55], v[38:39]
    v_pk_mul_f32 v[84:85], v[84:85], v[68:69]
    v_pk_mul_f32 v[86:87], v[86:87], v[70:71]
    v_cvt_pk_bf16_f32 v164, v52, v53
    v_cvt_pk_bf16_f32 v165, v54, v55
    v_cvt_pk_bf16_f32 v166, v84, v85
    v_cvt_pk_bf16_f32 v167, v86, v87
    buffer_store_dwordx4 v[164:167], v6, s[52:55], s56 offen offset:3072 sc1
    v_pk_fma_f32 v[88:89], v[216:217], v[232:233], v[88:89]
    v_pk_fma_f32 v[90:91], v[218:219], v[232:233], v[90:91]
    v_pk_fma_f32 v[104:105], v[220:221], v[232:233], v[104:105]
    v_pk_fma_f32 v[106:107], v[222:223], v[232:233], v[106:107]
    v_pk_fma_f32 v[120:121], v[224:225], v[232:233], v[120:121]
    v_pk_fma_f32 v[122:123], v[226:227], v[232:233], v[122:123]
    v_pk_fma_f32 v[136:137], v[228:229], v[232:233], v[136:137]
    v_pk_fma_f32 v[138:139], v[230:231], v[232:233], v[138:139]
    v_pk_mul_f32 v[88:89], v[88:89], v[234:235]
    v_pk_mul_f32 v[90:91], v[90:91], v[234:235]
    v_pk_mul_f32 v[120:121], v[120:121], v[234:235]
    v_pk_mul_f32 v[122:123], v[122:123], v[234:235]
    v_exp_f32 v88, v88
    v_exp_f32 v89, v89
    v_exp_f32 v90, v90
    v_exp_f32 v91, v91
    v_exp_f32 v120, v120
    v_exp_f32 v121, v121
    v_exp_f32 v122, v122
    v_exp_f32 v123, v123
    v_pk_fma_f32 v[88:89], v[88:89], v[184:185], v[184:185]
    v_pk_fma_f32 v[90:91], v[90:91], v[184:185], v[184:185]
    v_pk_fma_f32 v[120:121], v[120:121], v[184:185], v[184:185]
    v_pk_fma_f32 v[122:123], v[122:123], v[184:185], v[184:185]
    v_rcp_f32 v88, v88
    v_rcp_f32 v89, v89
    v_rcp_f32 v90, v90
    v_rcp_f32 v91, v91
    v_rcp_f32 v120, v120
    v_rcp_f32 v121, v121
    v_rcp_f32 v122, v122
    v_rcp_f32 v123, v123
    v_pk_mul_f32 v[104:105], v[104:105], v[88:89]
    v_pk_mul_f32 v[106:107], v[106:107], v[90:91]
    v_pk_mul_f32 v[136:137], v[136:137], v[120:121]
    v_pk_mul_f32 v[138:139], v[138:139], v[122:123]
    v_cvt_pk_bf16_f32 v168, v104, v105
    v_cvt_pk_bf16_f32 v169, v106, v107
    v_cvt_pk_bf16_f32 v170, v136, v137
    v_cvt_pk_bf16_f32 v171, v138, v139
    buffer_store_dwordx4 v[168:171], v6, s[52:55], s57 offen offset:0 sc1
    v_pk_fma_f32 v[92:93], v[216:217], v[236:237], v[92:93]
    v_pk_fma_f32 v[94:95], v[218:219], v[236:237], v[94:95]
    v_pk_fma_f32 v[108:109], v[220:221], v[236:237], v[108:109]
    v_pk_fma_f32 v[110:111], v[222:223], v[236:237], v[110:111]
    v_pk_fma_f32 v[124:125], v[224:225], v[236:237], v[124:125]
    v_pk_fma_f32 v[126:127], v[226:227], v[236:237], v[126:127]
    v_pk_fma_f32 v[140:141], v[228:229], v[236:237], v[140:141]
    v_pk_fma_f32 v[142:143], v[230:231], v[236:237], v[142:143]
    v_pk_mul_f32 v[92:93], v[92:93], v[238:239]
    v_pk_mul_f32 v[94:95], v[94:95], v[238:239]
    v_pk_mul_f32 v[124:125], v[124:125], v[238:239]
    v_pk_mul_f32 v[126:127], v[126:127], v[238:239]
    v_exp_f32 v92, v92
    v_exp_f32 v93, v93
    v_exp_f32 v94, v94
    v_exp_f32 v95, v95
    v_exp_f32 v124, v124
    v_exp_f32 v125, v125
    v_exp_f32 v126, v126
    v_exp_f32 v127, v127
    v_pk_fma_f32 v[92:93], v[92:93], v[186:187], v[186:187]
    v_pk_fma_f32 v[94:95], v[94:95], v[186:187], v[186:187]
    v_pk_fma_f32 v[124:125], v[124:125], v[186:187], v[186:187]
    v_pk_fma_f32 v[126:127], v[126:127], v[186:187], v[186:187]
    v_rcp_f32 v92, v92
    v_rcp_f32 v93, v93
    v_rcp_f32 v94, v94
    v_rcp_f32 v95, v95
    v_rcp_f32 v124, v124
    v_rcp_f32 v125, v125
    v_rcp_f32 v126, v126
    v_rcp_f32 v127, v127
    v_pk_mul_f32 v[108:109], v[108:109], v[92:93]
    v_pk_mul_f32 v[110:111], v[110:111], v[94:95]
    v_pk_mul_f32 v[140:141], v[140:141], v[124:125]
    v_pk_mul_f32 v[142:143], v[142:143], v[126:127]
    v_cvt_pk_bf16_f32 v172, v108, v109
    v_cvt_pk_bf16_f32 v173, v110, v111
    v_cvt_pk_bf16_f32 v174, v140, v141
    v_cvt_pk_bf16_f32 v175, v142, v143
    buffer_store_dwordx4 v[172:175], v6, s[52:55], s57 offen offset:1024 sc1
    v_pk_fma_f32 v[96:97], v[216:217], v[240:241], v[96:97]
    v_pk_fma_f32 v[98:99], v[218:219], v[240:241], v[98:99]
    v_pk_fma_f32 v[112:113], v[220:221], v[240:241], v[112:113]
    v_pk_fma_f32 v[114:115], v[222:223], v[240:241], v[114:115]
    v_pk_fma_f32 v[128:129], v[224:225], v[240:241], v[128:129]
    v_pk_fma_f32 v[130:131], v[226:227], v[240:241], v[130:131]
    v_pk_fma_f32 v[144:145], v[228:229], v[240:241], v[144:145]
    v_pk_fma_f32 v[146:147], v[230:231], v[240:241], v[146:147]
    v_pk_mul_f32 v[96:97], v[96:97], v[242:243]
    v_pk_mul_f32 v[98:99], v[98:99], v[242:243]
    v_pk_mul_f32 v[128:129], v[128:129], v[242:243]
    v_pk_mul_f32 v[130:131], v[130:131], v[242:243]
    v_exp_f32 v96, v96
    v_exp_f32 v97, v97
    v_exp_f32 v98, v98
    v_exp_f32 v99, v99
    v_exp_f32 v128, v128
    v_exp_f32 v129, v129
    v_exp_f32 v130, v130
    v_exp_f32 v131, v131
    v_pk_fma_f32 v[96:97], v[96:97], v[188:189], v[188:189]
    v_pk_fma_f32 v[98:99], v[98:99], v[188:189], v[188:189]
    v_pk_fma_f32 v[128:129], v[128:129], v[188:189], v[188:189]
    v_pk_fma_f32 v[130:131], v[130:131], v[188:189], v[188:189]
    v_rcp_f32 v96, v96
    v_rcp_f32 v97, v97
    v_rcp_f32 v98, v98
    v_rcp_f32 v99, v99
    v_rcp_f32 v128, v128
    v_rcp_f32 v129, v129
    v_rcp_f32 v130, v130
    v_rcp_f32 v131, v131
    v_pk_mul_f32 v[112:113], v[112:113], v[96:97]
    v_pk_mul_f32 v[114:115], v[114:115], v[98:99]
    v_pk_mul_f32 v[144:145], v[144:145], v[128:129]
    v_pk_mul_f32 v[146:147], v[146:147], v[130:131]
    v_cvt_pk_bf16_f32 v176, v112, v113
    v_cvt_pk_bf16_f32 v177, v114, v115
    v_cvt_pk_bf16_f32 v178, v144, v145
    v_cvt_pk_bf16_f32 v179, v146, v147
    buffer_store_dwordx4 v[176:179], v6, s[52:55], s57 offen offset:2048 sc1
    v_pk_fma_f32 v[100:101], v[216:217], v[244:245], v[100:101]
    v_pk_fma_f32 v[102:103], v[218:219], v[244:245], v[102:103]
    v_pk_fma_f32 v[116:117], v[220:221], v[244:245], v[116:117]
    v_pk_fma_f32 v[118:119], v[222:223], v[244:245], v[118:119]
    v_pk_fma_f32 v[132:133], v[224:225], v[244:245], v[132:133]
    v_pk_fma_f32 v[134:135], v[226:227], v[244:245], v[134:135]
    v_pk_fma_f32 v[148:149], v[228:229], v[244:245], v[148:149]
    v_pk_fma_f32 v[150:151], v[230:231], v[244:245], v[150:151]
    v_pk_mul_f32 v[100:101], v[100:101], v[246:247]
    v_pk_mul_f32 v[102:103], v[102:103], v[246:247]
    v_pk_mul_f32 v[132:133], v[132:133], v[246:247]
    v_pk_mul_f32 v[134:135], v[134:135], v[246:247]
    v_exp_f32 v100, v100
    v_exp_f32 v101, v101
    v_exp_f32 v102, v102
    v_exp_f32 v103, v103
    v_exp_f32 v132, v132
    v_exp_f32 v133, v133
    v_exp_f32 v134, v134
    v_exp_f32 v135, v135
    v_pk_fma_f32 v[100:101], v[100:101], v[190:191], v[190:191]
    v_pk_fma_f32 v[102:103], v[102:103], v[190:191], v[190:191]
    v_pk_fma_f32 v[132:133], v[132:133], v[190:191], v[190:191]
    v_pk_fma_f32 v[134:135], v[134:135], v[190:191], v[190:191]
    v_rcp_f32 v100, v100
    v_rcp_f32 v101, v101
    v_rcp_f32 v102, v102
    v_rcp_f32 v103, v103
    v_rcp_f32 v132, v132
    v_rcp_f32 v133, v133
    v_rcp_f32 v134, v134
    v_rcp_f32 v135, v135
    v_pk_mul_f32 v[116:117], v[116:117], v[100:101]
    v_pk_mul_f32 v[118:119], v[118:119], v[102:103]
    v_pk_mul_f32 v[148:149], v[148:149], v[132:133]
    v_pk_mul_f32 v[150:151], v[150:151], v[134:135]
    v_cvt_pk_bf16_f32 v180, v116, v117
    v_cvt_pk_bf16_f32 v181, v118, v119
    v_cvt_pk_bf16_f32 v182, v148, v149
    v_cvt_pk_bf16_f32 v183, v150, v151
    buffer_store_dwordx4 v[180:183], v6, s[52:55], s57 offen offset:3072 sc1
    s_branch gu_end
gu_B:
    s_barrier
    s_barrier
    s_barrier
    s_barrier
    s_mov_b32 s23, 0
    v_add_u32 v16, s23, v10
    v_add_u32 v17, s23, v11
    v_add_u32 v18, s23, v12
    s_waitcnt vmcnt(16)
    s_barrier
    ds_read_b128 v[120:123], v16 offset:0
    ds_read_b128 v[124:127], v16 offset:1024
    ds_read_b128 v[128:131], v16 offset:2048
    ds_read_b128 v[132:135], v16 offset:3072
    ds_read_b64_tr_b16 v[136:137], v17 offset:0
    ds_read_b64_tr_b16 v[138:139], v17 offset:3584
    ds_read_b64_tr_b16 v[140:141], v17 offset:7168
    ds_read_b64_tr_b16 v[142:143], v17 offset:10752
    ds_read_b64_tr_b16 v[144:145], v17 offset:32
    ds_read_b64_tr_b16 v[146:147], v17 offset:3616
    ds_read_b64_tr_b16 v[148:149], v17 offset:7200
    ds_read_b64_tr_b16 v[150:151], v17 offset:10784
    ds_read_b64_tr_b16 v[152:153], v18 offset:0
    ds_read_b64_tr_b16 v[154:155], v18 offset:3584
    ds_read_b64_tr_b16 v[156:157], v18 offset:7168
    ds_read_b64_tr_b16 v[158:159], v18 offset:10752
    s_mov_b32 s24, s23
    s_add_u32 s23, s23, 30720
    s_cmp_eq_u32 s23, 153600
    s_cselect_b32 s23, 0, s23
    v_add_u32 v16, s23, v10
    v_add_u32 v17, s23, v11
    v_add_u32 v18, s23, v12
    s_mov_b32 s27, 13
.p2align 6
gu_loopB:
    s_waitcnt vmcnt(12) lgkmcnt(0)
    s_barrier
    s_add_u32 m0, s24, s30
    s_mov_b64 exec, s[34:35]
    buffer_load_dwordx4 v7, s[12:15], s25 offen lds
    buffer_load_dwordx4 v8, s[12:15], s25 offen offset:896 lds
    s_add_u32 m0, m0, 7168
    s_nop 0
    buffer_load_dwordx4 v7, s[16:19], s25 offen lds
    buffer_load_dwordx4 v8, s[16:19], s25 offen offset:896 lds
    s_mov_b64 exec, -1
    s_add_u32 s25, s25, 229376
    v_mfma_f32_16x16x32_bf16 v[24:27], v[136:139], v[120:123], v[24:27]
    ds_read_b128 v[160:163], v16 offset:0
    v_mfma_f32_16x16x32_bf16 v[28:31], v[136:139], v[124:127], v[28:31]
    ds_read_b128 v[164:167], v16 offset:1024
    v_mfma_f32_16x16x32_bf16 v[32:35], v[136:139], v[128:131], v[32:35]
    ds_read_b128 v[168:171], v16 offset:2048
    v_mfma_f32_16x16x32_bf16 v[36:39], v[136:139], v[132:135], v[36:39]
    ds_read_b128 v[172:175], v16 offset:3072
    v_mfma_f32_16x16x32_bf16 v[52:55], v[140:143], v[132:135], v[52:55]
    ds_read_b64_tr_b16 v[176:177], v17 offset:0
    v_mfma_f32_16x16x32_bf16 v[48:51], v[140:143], v[128:131], v[48:51]
    ds_read_b64_tr_b16 v[178:179], v17 offset:3584
    v_mfma_f32_16x16x32_bf16 v[44:47], v[140:143], v[124:127], v[44:47]
    ds_read_b64_tr_b16 v[180:181], v17 offset:7168
    v_mfma_f32_16x16x32_bf16 v[40:43], v[140:143], v[120:123], v[40:43]
    ds_read_b64_tr_b16 v[182:183], v17 offset:10752
    v_mfma_f32_16x16x32_bf16 v[56:59], v[144:147], v[120:123], v[56:59]
    ds_read_b64_tr_b16 v[184:185], v17 offset:32
    v_mfma_f32_16x16x32_bf16 v[60:63], v[144:147], v[124:127], v[60:63]
    ds_read_b64_tr_b16 v[186:187], v17 offset:3616
    v_mfma_f32_16x16x32_bf16 v[64:67], v[144:147], v[128:131], v[64:67]
    ds_read_b64_tr_b16 v[188:189], v17 offset:7200
    v_mfma_f32_16x16x32_bf16 v[68:71], v[144:147], v[132:135], v[68:71]
    ds_read_b64_tr_b16 v[190:191], v17 offset:10784
    v_mfma_f32_16x16x32_bf16 v[84:87], v[148:151], v[132:135], v[84:87]
    ds_read_b64_tr_b16 v[192:193], v18 offset:0
    v_mfma_f32_16x16x32_bf16 v[80:83], v[148:151], v[128:131], v[80:83]
    ds_read_b64_tr_b16 v[194:195], v18 offset:3584
    v_mfma_f32_16x16x32_bf16 v[76:79], v[148:151], v[124:127], v[76:79]
    ds_read_b64_tr_b16 v[196:197], v18 offset:7168
    v_mfma_f32_16x16x32_bf16 v[72:75], v[148:151], v[120:123], v[72:75]
    ds_read_b64_tr_b16 v[198:199], v18 offset:10752
    v_mfma_f32_16x16x32_bf16 v[88:91], v[152:155], v[120:123], v[88:91]
    s_mov_b32 s24, s23
    v_mfma_f32_16x16x32_bf16 v[92:95], v[152:155], v[124:127], v[92:95]
    s_add_u32 s23, s23, 30720
    v_mfma_f32_16x16x32_bf16 v[96:99], v[152:155], v[128:131], v[96:99]
    s_cmp_eq_u32 s23, 153600
    s_cselect_b32 s23, 0, s23
    v_mfma_f32_16x16x32_bf16 v[100:103], v[152:155], v[132:135], v[100:103]
    v_add_u32 v16, s23, v10
    v_mfma_f32_16x16x32_bf16 v[116:119], v[156:159], v[132:135], v[116:119]
    v_add_u32 v17, s23, v11
    v_mfma_f32_16x16x32_bf16 v[112:115], v[156:159], v[128:131], v[112:115]
    v_add_u32 v18, s23, v12
    v_mfma_f32_16x16x32_bf16 v[108:111], v[156:159], v[124:127], v[108:111]
    v_mfma_f32_16x16x32_bf16 v[104:107], v[156:159], v[120:123], v[104:107]
    s_waitcnt vmcnt(12) lgkmcnt(0)
    s_barrier
    s_add_u32 m0, s24, s30
    s_mov_b64 exec, s[34:35]
    buffer_load_dwordx4 v7, s[12:15], s25 offen lds
    buffer_load_dwordx4 v8, s[12:15], s25 offen offset:896 lds
    s_add_u32 m0, m0, 7168
    s_nop 0
    buffer_load_dwordx4 v7, s[16:19], s25 offen lds
    buffer_load_dwordx4 v8, s[16:19], s25 offen offset:896 lds
    s_mov_b64 exec, -1
    s_add_u32 s25, s25, 229376
    v_mfma_f32_16x16x32_bf16 v[24:27], v[176:179], v[160:163], v[24:27]
    ds_read_b128 v[120:123], v16 offset:0
    v_mfma_f32_16x16x32_bf16 v[28:31], v[176:179], v[164:167], v[28:31]
    ds_read_b128 v[124:127], v16 offset:1024
    v_mfma_f32_16x16x32_bf16 v[32:35], v[176:179], v[168:171], v[32:35]
    ds_read_b128 v[128:131], v16 offset:2048
    v_mfma_f32_16x16x32_bf16 v[36:39], v[176:179], v[172:175], v[36:39]
    ds_read_b128 v[132:135], v16 offset:3072
    v_mfma_f32_16x16x32_bf16 v[52:55], v[180:183], v[172:175], v[52:55]
    ds_read_b64_tr_b16 v[136:137], v17 offset:0
    v_mfma_f32_16x16x32_bf16 v[48:51], v[180:183], v[168:171], v[48:51]
    ds_read_b64_tr_b16 v[138:139], v17 offset:3584
    v_mfma_f32_16x16x32_bf16 v[44:47], v[180:183], v[164:167], v[44:47]
    ds_read_b64_tr_b16 v[140:141], v17 offset:7168
    v_mfma_f32_16x16x32_bf16 v[40:43], v[180:183], v[160:163], v[40:43]
    ds_read_b64_tr_b16 v[142:143], v17 offset:10752
    v_mfma_f32_16x16x32_bf16 v[56:59], v[184:187], v[160:163], v[56:59]
    ds_read_b64_tr_b16 v[144:145], v17 offset:32
    v_mfma_f32_16x16x32_bf16 v[60:63], v[184:187], v[164:167], v[60:63]
    ds_read_b64_tr_b16 v[146:147], v17 offset:3616
    v_mfma_f32_16x16x32_bf16 v[64:67], v[184:187], v[168:171], v[64:67]
    ds_read_b64_tr_b16 v[148:149], v17 offset:7200
    v_mfma_f32_16x16x32_bf16 v[68:71], v[184:187], v[172:175], v[68:71]
    ds_read_b64_tr_b16 v[150:151], v17 offset:10784
    v_mfma_f32_16x16x32_bf16 v[84:87], v[188:191], v[172:175], v[84:87]
    ds_read_b64_tr_b16 v[152:153], v18 offset:0
    v_mfma_f32_16x16x32_bf16 v[80:83], v[188:191], v[168:171], v[80:83]
    ds_read_b64_tr_b16 v[154:155], v18 offset:3584
    v_mfma_f32_16x16x32_bf16 v[76:79], v[188:191], v[164:167], v[76:79]
    ds_read_b64_tr_b16 v[156:157], v18 offset:7168
    v_mfma_f32_16x16x32_bf16 v[72:75], v[188:191], v[160:163], v[72:75]
    ds_read_b64_tr_b16 v[158:159], v18 offset:10752
    v_mfma_f32_16x16x32_bf16 v[88:91], v[192:195], v[160:163], v[88:91]
    s_mov_b32 s24, s23
    v_mfma_f32_16x16x32_bf16 v[92:95], v[192:195], v[164:167], v[92:95]
    s_add_u32 s23, s23, 30720
    v_mfma_f32_16x16x32_bf16 v[96:99], v[192:195], v[168:171], v[96:99]
    s_cmp_eq_u32 s23, 153600
    s_cselect_b32 s23, 0, s23
    v_mfma_f32_16x16x32_bf16 v[100:103], v[192:195], v[172:175], v[100:103]
    v_add_u32 v16, s23, v10
    v_mfma_f32_16x16x32_bf16 v[116:119], v[196:199], v[172:175], v[116:119]
    v_add_u32 v17, s23, v11
    v_mfma_f32_16x16x32_bf16 v[112:115], v[196:199], v[168:171], v[112:115]
    v_add_u32 v18, s23, v12
    v_mfma_f32_16x16x32_bf16 v[108:111], v[196:199], v[164:167], v[108:111]
    s_sub_u32 s27, s27, 1
    s_cmp_lg_u32 s27, 0
    v_mfma_f32_16x16x32_bf16 v[104:107], v[196:199], v[160:163], v[104:107]
    s_cbranch_scc1 gu_loopB
    s_waitcnt vmcnt(12) lgkmcnt(0)
    s_barrier
    s_add_u32 m0, s24, s30
    s_mov_b64 exec, s[34:35]
    buffer_load_dwordx4 v7, s[12:15], s25 offen lds
    buffer_load_dwordx4 v8, s[12:15], s25 offen offset:896 lds
    s_add_u32 m0, m0, 7168
    s_nop 0
    buffer_load_dwordx4 v7, s[16:19], s25 offen lds
    buffer_load_dwordx4 v8, s[16:19], s25 offen offset:896 lds
    s_mov_b64 exec, -1
    s_add_u32 s25, s25, 229376
    v_mfma_f32_16x16x32_bf16 v[24:27], v[136:139], v[120:123], v[24:27]
    ds_read_b128 v[160:163], v16 offset:0
    v_mfma_f32_16x16x32_bf16 v[28:31], v[136:139], v[124:127], v[28:31]
    ds_read_b128 v[164:167], v16 offset:1024
    v_mfma_f32_16x16x32_bf16 v[32:35], v[136:139], v[128:131], v[32:35]
    ds_read_b128 v[168:171], v16 offset:2048
    v_mfma_f32_16x16x32_bf16 v[36:39], v[136:139], v[132:135], v[36:39]
    ds_read_b128 v[172:175], v16 offset:3072
    v_mfma_f32_16x16x32_bf16 v[52:55], v[140:143], v[132:135], v[52:55]
    ds_read_b64_tr_b16 v[176:177], v17 offset:0
    v_mfma_f32_16x16x32_bf16 v[48:51], v[140:143], v[128:131], v[48:51]
    ds_read_b64_tr_b16 v[178:179], v17 offset:3584
    v_mfma_f32_16x16x32_bf16 v[44:47], v[140:143], v[124:127], v[44:47]
    ds_read_b64_tr_b16 v[180:181], v17 offset:7168
    v_mfma_f32_16x16x32_bf16 v[40:43], v[140:143], v[120:123], v[40:43]
    ds_read_b64_tr_b16 v[182:183], v17 offset:10752
    v_mfma_f32_16x16x32_bf16 v[56:59], v[144:147], v[120:123], v[56:59]
    ds_read_b64_tr_b16 v[184:185], v17 offset:32
    v_mfma_f32_16x16x32_bf16 v[60:63], v[144:147], v[124:127], v[60:63]
    ds_read_b64_tr_b16 v[186:187], v17 offset:3616
    v_mfma_f32_16x16x32_bf16 v[64:67], v[144:147], v[128:131], v[64:67]
    ds_read_b64_tr_b16 v[188:189], v17 offset:7200
    v_mfma_f32_16x16x32_bf16 v[68:71], v[144:147], v[132:135], v[68:71]
    ds_read_b64_tr_b16 v[190:191], v17 offset:10784
    v_mfma_f32_16x16x32_bf16 v[84:87], v[148:151], v[132:135], v[84:87]
    ds_read_b64_tr_b16 v[192:193], v18 offset:0
    v_mfma_f32_16x16x32_bf16 v[80:83], v[148:151], v[128:131], v[80:83]
    ds_read_b64_tr_b16 v[194:195], v18 offset:3584
    v_mfma_f32_16x16x32_bf16 v[76:79], v[148:151], v[124:127], v[76:79]
    ds_read_b64_tr_b16 v[196:197], v18 offset:7168
    v_mfma_f32_16x16x32_bf16 v[72:75], v[148:151], v[120:123], v[72:75]
    ds_read_b64_tr_b16 v[198:199], v18 offset:10752
    v_mfma_f32_16x16x32_bf16 v[88:91], v[152:155], v[120:123], v[88:91]
    s_mov_b32 s24, s23
    v_mfma_f32_16x16x32_bf16 v[92:95], v[152:155], v[124:127], v[92:95]
    s_add_u32 s23, s23, 30720
    v_mfma_f32_16x16x32_bf16 v[96:99], v[152:155], v[128:131], v[96:99]
    s_cmp_eq_u32 s23, 153600
    s_cselect_b32 s23, 0, s23
    v_mfma_f32_16x16x32_bf16 v[100:103], v[152:155], v[132:135], v[100:103]
    v_add_u32 v16, s23, v10
    v_mfma_f32_16x16x32_bf16 v[116:119], v[156:159], v[132:135], v[116:119]
    v_add_u32 v17, s23, v11
    v_mfma_f32_16x16x32_bf16 v[112:115], v[156:159], v[128:131], v[112:115]
    v_add_u32 v18, s23, v12
    v_mfma_f32_16x16x32_bf16 v[108:111], v[156:159], v[124:127], v[108:111]
    v_mfma_f32_16x16x32_bf16 v[104:107], v[156:159], v[120:123], v[104:107]
    s_waitcnt vmcnt(12) lgkmcnt(0)
    s_barrier
    buffer_load_dwordx2 v[200:201], v14, s[44:47], s32 offen sc1
    s_add_u32 s32, s32, 16384
    buffer_load_dwordx2 v[202:203], v14, s[44:47], s32 offen sc1
    s_add_u32 s32, s32, 16384
    buffer_load_dwordx2 v[204:205], v14, s[44:47], s32 offen sc1
    s_add_u32 s32, s32, 16384
    buffer_load_dwordx2 v[206:207], v14, s[44:47], s32 offen sc1
    s_add_u32 s32, s32, 16384
    buffer_load_dwordx2 v[208:209], v14, s[44:47], s32 offen sc1
    s_add_u32 s32, s32, 16384
    buffer_load_dwordx2 v[210:211], v14, s[44:47], s32 offen sc1
    s_add_u32 s32, s32, 16384
    buffer_load_dwordx2 v[212:213], v14, s[44:47], s32 offen sc1
    s_add_u32 s32, s32, 16384
    buffer_load_dwordx2 v[214:215], v14, s[44:47], s32 offen sc1
    s_add_u32 s32, s32, 16384
    buffer_load_dwordx2 v[216:217], v14, s[44:47], s32 offen sc1
    s_add_u32 s32, s32, 16384
    buffer_load_dwordx2 v[218:219], v14, s[44:47], s32 offen sc1
    s_add_u32 s32, s32, 16384
    buffer_load_dwordx2 v[220:221], v14, s[44:47], s32 offen sc1
    s_add_u32 s32, s32, 16384
    buffer_load_dwordx2 v[222:223], v14, s[44:47], s32 offen sc1
    s_add_u32 s32, s32, 16384
    buffer_load_dwordx2 v[224:225], v14, s[44:47], s32 offen sc1
    s_add_u32 s32, s32, 16384
    buffer_load_dwordx2 v[226:227], v14, s[44:47], s32 offen sc1
    s_add_u32 s32, s32, 16384
    buffer_load_dwordx2 v[228:229], v14, s[44:47], s32 offen sc1
    s_add_u32 s32, s32, 16384
    buffer_load_dwordx2 v[230:231], v14, s[44:47], s32 offen sc1
    s_add_u32 s32, s32, 16384
    buffer_load_dword v232, v15, s[48:51], s33 offen sc1
    s_add_u32 s33, s33, 28672
    buffer_load_dword v233, v15, s[48:51], s33 offen sc1
    s_add_u32 s33, s33, 28672
    buffer_load_dword v234, v15, s[48:51], s33 offen sc1
    s_add_u32 s33, s33, 28672
    buffer_load_dword v235, v15, s[48:51], s33 offen sc1
    s_add_u32 s33, s33, 28672
    v_mfma_f32_16x16x32_bf16 v[24:27], v[176:179], v[160:163], v[24:27]
    ds_read_b128 v[120:123], v16 offset:0
    v_mfma_f32_16x16x32_bf16 v[28:31], v[176:179], v[164:167], v[28:31]
    ds_read_b128 v[124:127], v16 offset:1024
    v_mfma_f32_16x16x32_bf16 v[32:35], v[176:179], v[168:171], v[32:35]
    ds_read_b128 v[128:131], v16 offset:2048
    v_mfma_f32_16x16x32_bf16 v[36:39], v[176:179], v[172:175], v[36:39]
    ds_read_b128 v[132:135], v16 offset:3072
    v_mfma_f32_16x16x32_bf16 v[52:55], v[180:183], v[172:175], v[52:55]
    ds_read_b64_tr_b16 v[136:137], v17 offset:0
    v_mfma_f32_16x16x32_bf16 v[48:51], v[180:183], v[168:171], v[48:51]
    ds_read_b64_tr_b16 v[138:139], v17 offset:3584
    v_mfma_f32_16x16x32_bf16 v[44:47], v[180:183], v[164:167], v[44:47]
    ds_read_b64_tr_b16 v[140:141], v17 offset:7168
    v_mfma_f32_16x16x32_bf16 v[40:43], v[180:183], v[160:163], v[40:43]
    ds_read_b64_tr_b16 v[142:143], v17 offset:10752
    v_mfma_f32_16x16x32_bf16 v[56:59], v[184:187], v[160:163], v[56:59]
    ds_read_b64_tr_b16 v[144:145], v17 offset:32
    v_mfma_f32_16x16x32_bf16 v[60:63], v[184:187], v[164:167], v[60:63]
    ds_read_b64_tr_b16 v[146:147], v17 offset:3616
    v_mfma_f32_16x16x32_bf16 v[64:67], v[184:187], v[168:171], v[64:67]
    ds_read_b64_tr_b16 v[148:149], v17 offset:7200
    v_mfma_f32_16x16x32_bf16 v[68:71], v[184:187], v[172:175], v[68:71]
    ds_read_b64_tr_b16 v[150:151], v17 offset:10784
    v_mfma_f32_16x16x32_bf16 v[84:87], v[188:191], v[172:175], v[84:87]
    ds_read_b64_tr_b16 v[152:153], v18 offset:0
    v_mfma_f32_16x16x32_bf16 v[80:83], v[188:191], v[168:171], v[80:83]
    ds_read_b64_tr_b16 v[154:155], v18 offset:3584
    v_mfma_f32_16x16x32_bf16 v[76:79], v[188:191], v[164:167], v[76:79]
    ds_read_b64_tr_b16 v[156:157], v18 offset:7168
    v_mfma_f32_16x16x32_bf16 v[72:75], v[188:191], v[160:163], v[72:75]
    ds_read_b64_tr_b16 v[158:159], v18 offset:10752
    v_mfma_f32_16x16x32_bf16 v[88:91], v[192:195], v[160:163], v[88:91]
    s_mov_b32 s24, s23
    v_mfma_f32_16x16x32_bf16 v[92:95], v[192:195], v[164:167], v[92:95]
    s_add_u32 s23, s23, 30720
    v_mfma_f32_16x16x32_bf16 v[96:99], v[192:195], v[168:171], v[96:99]
    s_cmp_eq_u32 s23, 153600
    s_cselect_b32 s23, 0, s23
    v_mfma_f32_16x16x32_bf16 v[100:103], v[192:195], v[172:175], v[100:103]
    v_add_u32 v16, s23, v10
    v_mfma_f32_16x16x32_bf16 v[116:119], v[196:199], v[172:175], v[116:119]
    v_add_u32 v17, s23, v11
    v_mfma_f32_16x16x32_bf16 v[112:115], v[196:199], v[168:171], v[112:115]
    v_add_u32 v18, s23, v12
    v_mfma_f32_16x16x32_bf16 v[108:111], v[196:199], v[164:167], v[108:111]
    v_mfma_f32_16x16x32_bf16 v[104:107], v[196:199], v[160:163], v[104:107]
    s_waitcnt vmcnt(28) lgkmcnt(0)
    s_barrier
    v_mfma_f32_16x16x32_bf16 v[24:27], v[136:139], v[120:123], v[24:27]
    ds_read_b128 v[160:163], v16 offset:0
    v_mfma_f32_16x16x32_bf16 v[28:31], v[136:139], v[124:127], v[28:31]
    ds_read_b128 v[164:167], v16 offset:1024
    v_mfma_f32_16x16x32_bf16 v[32:35], v[136:139], v[128:131], v[32:35]
    ds_read_b128 v[168:171], v16 offset:2048
    v_mfma_f32_16x16x32_bf16 v[36:39], v[136:139], v[132:135], v[36:39]
    ds_read_b128 v[172:175], v16 offset:3072
    v_mfma_f32_16x16x32_bf16 v[52:55], v[140:143], v[132:135], v[52:55]
    ds_read_b64_tr_b16 v[176:177], v17 offset:0
    v_mfma_f32_16x16x32_bf16 v[48:51], v[140:143], v[128:131], v[48:51]
    ds_read_b64_tr_b16 v[178:179], v17 offset:3584
    v_mfma_f32_16x16x32_bf16 v[44:47], v[140:143], v[124:127], v[44:47]
    ds_read_b64_tr_b16 v[180:181], v17 offset:7168
    v_mfma_f32_16x16x32_bf16 v[40:43], v[140:143], v[120:123], v[40:43]
    ds_read_b64_tr_b16 v[182:183], v17 offset:10752
    v_mfma_f32_16x16x32_bf16 v[56:59], v[144:147], v[120:123], v[56:59]
    ds_read_b64_tr_b16 v[184:185], v17 offset:32
    v_mfma_f32_16x16x32_bf16 v[60:63], v[144:147], v[124:127], v[60:63]
    ds_read_b64_tr_b16 v[186:187], v17 offset:3616
    v_mfma_f32_16x16x32_bf16 v[64:67], v[144:147], v[128:131], v[64:67]
    ds_read_b64_tr_b16 v[188:189], v17 offset:7200
    v_mfma_f32_16x16x32_bf16 v[68:71], v[144:147], v[132:135], v[68:71]
    ds_read_b64_tr_b16 v[190:191], v17 offset:10784
    v_mfma_f32_16x16x32_bf16 v[84:87], v[148:151], v[132:135], v[84:87]
    ds_read_b64_tr_b16 v[192:193], v18 offset:0
    v_mfma_f32_16x16x32_bf16 v[80:83], v[148:151], v[128:131], v[80:83]
    ds_read_b64_tr_b16 v[194:195], v18 offset:3584
    v_mfma_f32_16x16x32_bf16 v[76:79], v[148:151], v[124:127], v[76:79]
    ds_read_b64_tr_b16 v[196:197], v18 offset:7168
    v_mfma_f32_16x16x32_bf16 v[72:75], v[148:151], v[120:123], v[72:75]
    ds_read_b64_tr_b16 v[198:199], v18 offset:10752
    v_mfma_f32_16x16x32_bf16 v[88:91], v[152:155], v[120:123], v[88:91]
    s_mov_b32 s24, s23
    v_mfma_f32_16x16x32_bf16 v[92:95], v[152:155], v[124:127], v[92:95]
    s_add_u32 s23, s23, 30720
    v_mfma_f32_16x16x32_bf16 v[96:99], v[152:155], v[128:131], v[96:99]
    s_cmp_eq_u32 s23, 153600
    s_cselect_b32 s23, 0, s23
    v_mfma_f32_16x16x32_bf16 v[100:103], v[152:155], v[132:135], v[100:103]
    v_add_u32 v16, s23, v10
    v_mfma_f32_16x16x32_bf16 v[116:119], v[156:159], v[132:135], v[116:119]
    v_add_u32 v17, s23, v11
    v_mfma_f32_16x16x32_bf16 v[112:115], v[156:159], v[128:131], v[112:115]
    v_add_u32 v18, s23, v12
    v_mfma_f32_16x16x32_bf16 v[108:111], v[156:159], v[124:127], v[108:111]
    v_mfma_f32_16x16x32_bf16 v[104:107], v[156:159], v[120:123], v[104:107]
    s_waitcnt vmcnt(24) lgkmcnt(0)
    s_barrier
    s_waitcnt vmcnt(0)
    v_add_f32 v200, v200, v202
    v_add_f32 v201, v201, v203
    v_add_f32 v216, v216, v218
    v_add_f32 v217, v217, v219
    v_add_f32 v200, v200, v204
    v_add_f32 v201, v201, v205
    v_add_f32 v216, v216, v220
    v_add_f32 v217, v217, v221
    v_add_f32 v200, v200, v206
    v_add_f32 v201, v201, v207
    v_add_f32 v216, v216, v222
    v_add_f32 v217, v217, v223
    v_add_f32 v200, v200, v208
    v_add_f32 v201, v201, v209
    v_add_f32 v216, v216, v224
    v_add_f32 v217, v217, v225
    v_add_f32 v200, v200, v210
    v_add_f32 v201, v201, v211
    v_add_f32 v216, v216, v226
    v_add_f32 v217, v217, v227
    v_add_f32 v200, v200, v212
    v_add_f32 v201, v201, v213
    v_add_f32 v216, v216, v228
    v_add_f32 v217, v217, v229
    v_add_f32 v200, v200, v214
    v_add_f32 v201, v201, v215
    v_add_f32 v216, v216, v230
    v_add_f32 v217, v217, v231
    v_add_f32 v200, v200, v216
    v_add_f32 v201, v201, v217
    v_add_f32 v232, v232, v233
    v_add_f32 v234, v234, v235
    v_add_f32 v232, v232, v234
    v_mul_f32 v200, 0xba800000, v200
    v_mul_f32 v201, 0x3a800000, v201
    v_fma_f32 v201, -v200, v200, v201
    v_max_f32 v201, 0, v201
    v_add_f32 v201, 0x3727c5ac, v201
    v_rsq_f32 v202, v201
    v_sqrt_f32 v204, v201
    v_mov_b32 v201, v200
    v_mul_f32 v202, 0xbfb8aa3b, v202
    v_mov_b32 v205, v204
    v_mov_b32 v203, v202
    v_lshlrev_b32 v14, 4, v13
    v_add_u32 v14, 153600, v14
    ds_write_b128 v14, v[200:203]
    v_lshlrev_b32 v14, 3, v13
    v_add_u32 v14, 158720, v14
    ds_write_b64 v14, v[204:205]
    v_lshlrev_b32 v15, 2, v13
    v_add_u32 v15, 157696, v15
    ds_write_b32 v15, v232
    v_mfma_f32_16x16x32_bf16 v[24:27], v[176:179], v[160:163], v[24:27]
    ds_read_b128 v[120:123], v16 offset:0
    v_mfma_f32_16x16x32_bf16 v[28:31], v[176:179], v[164:167], v[28:31]
    ds_read_b128 v[124:127], v16 offset:1024
    v_mfma_f32_16x16x32_bf16 v[32:35], v[176:179], v[168:171], v[32:35]
    ds_read_b128 v[128:131], v16 offset:2048
    v_mfma_f32_16x16x32_bf16 v[36:39], v[176:179], v[172:175], v[36:39]
    ds_read_b128 v[132:135], v16 offset:3072
    v_mfma_f32_16x16x32_bf16 v[52:55], v[180:183], v[172:175], v[52:55]
    ds_read_b64_tr_b16 v[136:137], v17 offset:0
    v_mfma_f32_16x16x32_bf16 v[48:51], v[180:183], v[168:171], v[48:51]
    ds_read_b64_tr_b16 v[138:139], v17 offset:3584
    v_mfma_f32_16x16x32_bf16 v[44:47], v[180:183], v[164:167], v[44:47]
    ds_read_b64_tr_b16 v[140:141], v17 offset:7168
    v_mfma_f32_16x16x32_bf16 v[40:43], v[180:183], v[160:163], v[40:43]
    ds_read_b64_tr_b16 v[142:143], v17 offset:10752
    v_mfma_f32_16x16x32_bf16 v[56:59], v[184:187], v[160:163], v[56:59]
    ds_read_b64_tr_b16 v[144:145], v17 offset:32
    v_mfma_f32_16x16x32_bf16 v[60:63], v[184:187], v[164:167], v[60:63]
    ds_read_b64_tr_b16 v[146:147], v17 offset:3616
    v_mfma_f32_16x16x32_bf16 v[64:67], v[184:187], v[168:171], v[64:67]
    ds_read_b64_tr_b16 v[148:149], v17 offset:7200
    v_mfma_f32_16x16x32_bf16 v[68:71], v[184:187], v[172:175], v[68:71]
    ds_read_b64_tr_b16 v[150:151], v17 offset:10784
    v_mfma_f32_16x16x32_bf16 v[84:87], v[188:191], v[172:175], v[84:87]
    ds_read_b64_tr_b16 v[152:153], v18 offset:0
    v_mfma_f32_16x16x32_bf16 v[80:83], v[188:191], v[168:171], v[80:83]
    ds_read_b64_tr_b16 v[154:155], v18 offset:3584
    v_mfma_f32_16x16x32_bf16 v[76:79], v[188:191], v[164:167], v[76:79]
    ds_read_b64_tr_b16 v[156:157], v18 offset:7168
    v_mfma_f32_16x16x32_bf16 v[72:75], v[188:191], v[160:163], v[72:75]
    ds_read_b64_tr_b16 v[158:159], v18 offset:10752
    v_mfma_f32_16x16x32_bf16 v[88:91], v[192:195], v[160:163], v[88:91]
    s_mov_b32 s24, s23
    v_mfma_f32_16x16x32_bf16 v[92:95], v[192:195], v[164:167], v[92:95]
    s_add_u32 s23, s23, 30720
    v_mfma_f32_16x16x32_bf16 v[96:99], v[192:195], v[168:171], v[96:99]
    s_cmp_eq_u32 s23, 153600
    s_cselect_b32 s23, 0, s23
    v_mfma_f32_16x16x32_bf16 v[100:103], v[192:195], v[172:175], v[100:103]
    v_add_u32 v16, s23, v10
    v_mfma_f32_16x16x32_bf16 v[116:119], v[196:199], v[172:175], v[116:119]
    v_add_u32 v17, s23, v11
    v_mfma_f32_16x16x32_bf16 v[112:115], v[196:199], v[168:171], v[112:115]
    v_add_u32 v18, s23, v12
    v_mfma_f32_16x16x32_bf16 v[108:111], v[196:199], v[164:167], v[108:111]
    v_mfma_f32_16x16x32_bf16 v[104:107], v[196:199], v[160:163], v[104:107]
    s_waitcnt vmcnt(0) lgkmcnt(0)
    s_barrier
    v_mfma_f32_16x16x32_bf16 v[24:27], v[136:139], v[120:123], v[24:27]
    ds_read_b128 v[160:163], v16 offset:0
    v_mfma_f32_16x16x32_bf16 v[28:31], v[136:139], v[124:127], v[28:31]
    ds_read_b128 v[164:167], v16 offset:1024
    v_mfma_f32_16x16x32_bf16 v[32:35], v[136:139], v[128:131], v[32:35]
    ds_read_b128 v[168:171], v16 offset:2048
    v_mfma_f32_16x16x32_bf16 v[36:39], v[136:139], v[132:135], v[36:39]
    ds_read_b128 v[172:175], v16 offset:3072
    v_mfma_f32_16x16x32_bf16 v[52:55], v[140:143], v[132:135], v[52:55]
    ds_read_b64_tr_b16 v[176:177], v17 offset:0
    v_mfma_f32_16x16x32_bf16 v[48:51], v[140:143], v[128:131], v[48:51]
    ds_read_b64_tr_b16 v[178:179], v17 offset:3584
    v_mfma_f32_16x16x32_bf16 v[44:47], v[140:143], v[124:127], v[44:47]
    ds_read_b64_tr_b16 v[180:181], v17 offset:7168
    v_mfma_f32_16x16x32_bf16 v[40:43], v[140:143], v[120:123], v[40:43]
    ds_read_b64_tr_b16 v[182:183], v17 offset:10752
    v_mfma_f32_16x16x32_bf16 v[56:59], v[144:147], v[120:123], v[56:59]
    ds_read_b64_tr_b16 v[184:185], v17 offset:32
    v_mfma_f32_16x16x32_bf16 v[60:63], v[144:147], v[124:127], v[60:63]
    ds_read_b64_tr_b16 v[186:187], v17 offset:3616
    v_mfma_f32_16x16x32_bf16 v[64:67], v[144:147], v[128:131], v[64:67]
    ds_read_b64_tr_b16 v[188:189], v17 offset:7200
    v_mfma_f32_16x16x32_bf16 v[68:71], v[144:147], v[132:135], v[68:71]
    ds_read_b64_tr_b16 v[190:191], v17 offset:10784
    v_mfma_f32_16x16x32_bf16 v[84:87], v[148:151], v[132:135], v[84:87]
    ds_read_b64_tr_b16 v[192:193], v18 offset:0
    v_mfma_f32_16x16x32_bf16 v[80:83], v[148:151], v[128:131], v[80:83]
    ds_read_b64_tr_b16 v[194:195], v18 offset:3584
    v_mfma_f32_16x16x32_bf16 v[76:79], v[148:151], v[124:127], v[76:79]
    ds_read_b64_tr_b16 v[196:197], v18 offset:7168
    v_mfma_f32_16x16x32_bf16 v[72:75], v[148:151], v[120:123], v[72:75]
    ds_read_b64_tr_b16 v[198:199], v18 offset:10752
    v_mfma_f32_16x16x32_bf16 v[88:91], v[152:155], v[120:123], v[88:91]
    s_mov_b32 s24, s23
    v_mfma_f32_16x16x32_bf16 v[92:95], v[152:155], v[124:127], v[92:95]
    s_add_u32 s23, s23, 30720
    v_mfma_f32_16x16x32_bf16 v[96:99], v[152:155], v[128:131], v[96:99]
    s_cmp_eq_u32 s23, 153600
    s_cselect_b32 s23, 0, s23
    v_mfma_f32_16x16x32_bf16 v[100:103], v[152:155], v[132:135], v[100:103]
    v_add_u32 v16, s23, v10
    v_mfma_f32_16x16x32_bf16 v[116:119], v[156:159], v[132:135], v[116:119]
    v_add_u32 v17, s23, v11
    v_mfma_f32_16x16x32_bf16 v[112:115], v[156:159], v[128:131], v[112:115]
    v_add_u32 v18, s23, v12
    v_mfma_f32_16x16x32_bf16 v[108:111], v[156:159], v[124:127], v[108:111]
    v_mfma_f32_16x16x32_bf16 v[104:107], v[156:159], v[120:123], v[104:107]
    s_waitcnt lgkmcnt(0)
    v_mfma_f32_16x16x32_bf16 v[24:27], v[176:179], v[160:163], v[24:27]
    v_mfma_f32_16x16x32_bf16 v[28:31], v[176:179], v[164:167], v[28:31]
    v_mfma_f32_16x16x32_bf16 v[32:35], v[176:179], v[168:171], v[32:35]
    v_mfma_f32_16x16x32_bf16 v[36:39], v[176:179], v[172:175], v[36:39]
    v_mfma_f32_16x16x32_bf16 v[52:55], v[180:183], v[172:175], v[52:55]
    v_mfma_f32_16x16x32_bf16 v[48:51], v[180:183], v[168:171], v[48:51]
    v_mfma_f32_16x16x32_bf16 v[44:47], v[180:183], v[164:167], v[44:47]
    v_mfma_f32_16x16x32_bf16 v[40:43], v[180:183], v[160:163], v[40:43]
    v_mfma_f32_16x16x32_bf16 v[56:59], v[184:187], v[160:163], v[56:59]
    v_mfma_f32_16x16x32_bf16 v[60:63], v[184:187], v[164:167], v[60:63]
    v_mfma_f32_16x16x32_bf16 v[64:67], v[184:187], v[168:171], v[64:67]
    v_mfma_f32_16x16x32_bf16 v[68:71], v[184:187], v[172:175], v[68:71]
    v_mfma_f32_16x16x32_bf16 v[84:87], v[188:191], v[172:175], v[84:87]
    v_mfma_f32_16x16x32_bf16 v[80:83], v[188:191], v[168:171], v[80:83]
    v_mfma_f32_16x16x32_bf16 v[76:79], v[188:191], v[164:167], v[76:79]
    v_mfma_f32_16x16x32_bf16 v[72:75], v[188:191], v[160:163], v[72:75]
    v_mfma_f32_16x16x32_bf16 v[88:91], v[192:195], v[160:163], v[88:91]
    v_mfma_f32_16x16x32_bf16 v[92:95], v[192:195], v[164:167], v[92:95]
    v_mfma_f32_16x16x32_bf16 v[96:99], v[192:195], v[168:171], v[96:99]
    v_mfma_f32_16x16x32_bf16 v[100:103], v[192:195], v[172:175], v[100:103]
    v_mfma_f32_16x16x32_bf16 v[116:119], v[196:199], v[172:175], v[116:119]
    v_mfma_f32_16x16x32_bf16 v[112:115], v[196:199], v[168:171], v[112:115]
    v_mfma_f32_16x16x32_bf16 v[108:111], v[196:199], v[164:167], v[108:111]
    v_mfma_f32_16x16x32_bf16 v[104:107], v[196:199], v[160:163], v[104:107]
    s_nop 7
gu_epiB:
    s_barrier
    s_load_dwordx2 s[44:45], s[0:1], 56
    s_load_dwordx2 s[46:47], s[0:1], 64
    s_lshl_b32 s28, s31, 10
    s_add_u32 s28, s28, 153600
    v_lshlrev_b32 v14, 4, v5
    v_add_u32 v14, s28, v14
    ds_read_b128 v[232:235], v14 offset:0
    ds_read_b128 v[236:239], v14 offset:256
    ds_read_b128 v[240:243], v14 offset:512
    ds_read_b128 v[244:247], v14 offset:768
    s_lshl_b32 s28, s31, 9
    s_add_u32 s28, s28, 158720
    v_lshlrev_b32 v14, 3, v5
    v_add_u32 v14, s28, v14
    ds_read_b64 v[184:185], v14 offset:0
    ds_read_b64 v[186:187], v14 offset:128
    ds_read_b64 v[188:189], v14 offset:256
    ds_read_b64 v[190:191], v14 offset:384
    v_lshlrev_b32 v9, 4, v2
    s_lshl_b32 s28, s37, 6
    s_add_u32 s28, s28, 157696
    v_add_u32 v14, s28, v9
    s_lshl_b32 s28, s39, 6
    s_add_u32 s28, s28, 157696
    v_add_u32 v15, s28, v9
    ds_read_b128 v[200:203], v14 offset:0
    ds_read_b128 v[204:207], v14 offset:448
    ds_read_b128 v[208:211], v14 offset:64
    ds_read_b128 v[212:215], v14 offset:512
    ds_read_b128 v[216:219], v15 offset:0
    ds_read_b128 v[220:223], v15 offset:448
    s_mul_i32 s28, s22, 7
    s_add_u32 s29, s28, s37
    s_lshr_b32 s29, s29, 1
    s_lshl_b32 s29, s29, 17
    s_lshl_b32 s33, s21, 4
    s_lshl_b32 s36, s31, 2
    s_add_u32 s33, s33, s36
    s_lshl_b32 s33, s33, 10
    s_add_u32 s56, s29, s33
    s_add_u32 s57, s56, 0x20000
    s_add_u32 s29, s28, s39
    s_and_b32 s36, s29, 1
    s_lshl_b32 s36, s36, 3
    s_lshr_b32 s29, s29, 1
    s_lshl_b32 s29, s29, 17
    s_add_u32 s58, s29, s33
    s_add_u32 s58, s58, s36
    s_waitcnt lgkmcnt(0)
    v_pk_fma_f32 v[24:25], v[200:201], v[232:233], v[24:25]
    v_pk_fma_f32 v[26:27], v[202:203], v[232:233], v[26:27]
    v_pk_fma_f32 v[40:41], v[204:205], v[232:233], v[40:41]
    v_pk_fma_f32 v[42:43], v[206:207], v[232:233], v[42:43]
    v_pk_fma_f32 v[56:57], v[208:209], v[232:233], v[56:57]
    v_pk_fma_f32 v[58:59], v[210:211], v[232:233], v[58:59]
    v_pk_fma_f32 v[72:73], v[212:213], v[232:233], v[72:73]
    v_pk_fma_f32 v[74:75], v[214:215], v[232:233], v[74:75]
    v_pk_mul_f32 v[24:25], v[24:25], v[234:235]
    v_pk_mul_f32 v[26:27], v[26:27], v[234:235]
    v_pk_mul_f32 v[56:57], v[56:57], v[234:235]
    v_pk_mul_f32 v[58:59], v[58:59], v[234:235]
    v_exp_f32 v24, v24
    v_exp_f32 v25, v25
    v_exp_f32 v26, v26
    v_exp_f32 v27, v27
    v_exp_f32 v56, v56
    v_exp_f32 v57, v57
    v_exp_f32 v58, v58
    v_exp_f32 v59, v59
    v_pk_fma_f32 v[24:25], v[24:25], v[184:185], v[184:185]
    v_pk_fma_f32 v[26:27], v[26:27], v[184:185], v[184:185]
    v_pk_fma_f32 v[56:57], v[56:57], v[184:185], v[184:185]
    v_pk_fma_f32 v[58:59], v[58:59], v[184:185], v[184:185]
    v_rcp_f32 v24, v24
    v_rcp_f32 v25, v25
    v_rcp_f32 v26, v26
    v_rcp_f32 v27, v27
    v_rcp_f32 v56, v56
    v_rcp_f32 v57, v57
    v_rcp_f32 v58, v58
    v_rcp_f32 v59, v59
    v_pk_mul_f32 v[40:41], v[40:41], v[24:25]
    v_pk_mul_f32 v[42:43], v[42:43], v[26:27]
    v_pk_mul_f32 v[72:73], v[72:73], v[56:57]
    v_pk_mul_f32 v[74:75], v[74:75], v[58:59]
    v_cvt_pk_bf16_f32 v120, v40, v41
    v_cvt_pk_bf16_f32 v121, v42, v43
    v_cvt_pk_bf16_f32 v122, v72, v73
    v_cvt_pk_bf16_f32 v123, v74, v75
    buffer_store_dwordx4 v[120:123], v6, s[52:55], s56 offen offset:0 sc1
    v_pk_fma_f32 v[28:29], v[200:201], v[236:237], v[28:29]
    v_pk_fma_f32 v[30:31], v[202:203], v[236:237], v[30:31]
    v_pk_fma_f32 v[44:45], v[204:205], v[236:237], v[44:45]
    v_pk_fma_f32 v[46:47], v[206:207], v[236:237], v[46:47]
    v_pk_fma_f32 v[60:61], v[208:209], v[236:237], v[60:61]
    v_pk_fma_f32 v[62:63], v[210:211], v[236:237], v[62:63]
    v_pk_fma_f32 v[76:77], v[212:213], v[236:237], v[76:77]
    v_pk_fma_f32 v[78:79], v[214:215], v[236:237], v[78:79]
    v_pk_mul_f32 v[28:29], v[28:29], v[238:239]
    v_pk_mul_f32 v[30:31], v[30:31], v[238:239]
    v_pk_mul_f32 v[60:61], v[60:61], v[238:239]
    v_pk_mul_f32 v[62:63], v[62:63], v[238:239]
    v_exp_f32 v28, v28
    v_exp_f32 v29, v29
    v_exp_f32 v30, v30
    v_exp_f32 v31, v31
    v_exp_f32 v60, v60
    v_exp_f32 v61, v61
    v_exp_f32 v62, v62
    v_exp_f32 v63, v63
    v_pk_fma_f32 v[28:29], v[28:29], v[186:187], v[186:187]
    v_pk_fma_f32 v[30:31], v[30:31], v[186:187], v[186:187]
    v_pk_fma_f32 v[60:61], v[60:61], v[186:187], v[186:187]
    v_pk_fma_f32 v[62:63], v[62:63], v[186:187], v[186:187]
    v_rcp_f32 v28, v28
    v_rcp_f32 v29, v29
    v_rcp_f32 v30, v30
    v_rcp_f32 v31, v31
    v_rcp_f32 v60, v60
    v_rcp_f32 v61, v61
    v_rcp_f32 v62, v62
    v_rcp_f32 v63, v63
    v_pk_mul_f32 v[44:45], v[44:45], v[28:29]
    v_pk_mul_f32 v[46:47], v[46:47], v[30:31]
    v_pk_mul_f32 v[76:77], v[76:77], v[60:61]
    v_pk_mul_f32 v[78:79], v[78:79], v[62:63]
    v_cvt_pk_bf16_f32 v124, v44, v45
    v_cvt_pk_bf16_f32 v125, v46, v47
    v_cvt_pk_bf16_f32 v126, v76, v77
    v_cvt_pk_bf16_f32 v127, v78, v79
    buffer_store_dwordx4 v[124:127], v6, s[52:55], s56 offen offset:1024 sc1
    v_pk_fma_f32 v[32:33], v[200:201], v[240:241], v[32:33]
    v_pk_fma_f32 v[34:35], v[202:203], v[240:241], v[34:35]
    v_pk_fma_f32 v[48:49], v[204:205], v[240:241], v[48:49]
    v_pk_fma_f32 v[50:51], v[206:207], v[240:241], v[50:51]
    v_pk_fma_f32 v[64:65], v[208:209], v[240:241], v[64:65]
    v_pk_fma_f32 v[66:67], v[210:211], v[240:241], v[66:67]
    v_pk_fma_f32 v[80:81], v[212:213], v[240:241], v[80:81]
    v_pk_fma_f32 v[82:83], v[214:215], v[240:241], v[82:83]
    v_pk_mul_f32 v[32:33], v[32:33], v[242:243]
    v_pk_mul_f32 v[34:35], v[34:35], v[242:243]
    v_pk_mul_f32 v[64:65], v[64:65], v[242:243]
    v_pk_mul_f32 v[66:67], v[66:67], v[242:243]
    v_exp_f32 v32, v32
    v_exp_f32 v33, v33
    v_exp_f32 v34, v34
    v_exp_f32 v35, v35
    v_exp_f32 v64, v64
    v_exp_f32 v65, v65
    v_exp_f32 v66, v66
    v_exp_f32 v67, v67
    v_pk_fma_f32 v[32:33], v[32:33], v[188:189], v[188:189]
    v_pk_fma_f32 v[34:35], v[34:35], v[188:189], v[188:189]
    v_pk_fma_f32 v[64:65], v[64:65], v[188:189], v[188:189]
    v_pk_fma_f32 v[66:67], v[66:67], v[188:189], v[188:189]
    v_rcp_f32 v32, v32
    v_rcp_f32 v33, v33
    v_rcp_f32 v34, v34
    v_rcp_f32 v35, v35
    v_rcp_f32 v64, v64
    v_rcp_f32 v65, v65
    v_rcp_f32 v66, v66
    v_rcp_f32 v67, v67
    v_pk_mul_f32 v[48:49], v[48:49], v[32:33]
    v_pk_mul_f32 v[50:51], v[50:51], v[34:35]
    v_pk_mul_f32 v[80:81], v[80:81], v[64:65]
    v_pk_mul_f32 v[82:83], v[82:83], v[66:67]
    v_cvt_pk_bf16_f32 v128, v48, v49
    v_cvt_pk_bf16_f32 v129, v50, v51
    v_cvt_pk_bf16_f32 v130, v80, v81
    v_cvt_pk_bf16_f32 v131, v82, v83
    buffer_store_dwordx4 v[128:131], v6, s[52:55], s56 offen offset:2048 sc1
    v_pk_fma_f32 v[36:37], v[200:201], v[244:245], v[36:37]
    v_pk_fma_f32 v[38:39], v[202:203], v[244:245], v[38:39]
    v_pk_fma_f32 v[52:53], v[204:205], v[244:245], v[52:53]
    v_pk_fma_f32 v[54:55], v[206:207], v[244:245], v[54:55]
    v_pk_fma_f32 v[68:69], v[208:209], v[244:245], v[68:69]
    v_pk_fma_f32 v[70:71], v[210:211], v[244:245], v[70:71]
    v_pk_fma_f32 v[84:85], v[212:213], v[244:245], v[84:85]
    v_pk_fma_f32 v[86:87], v[214:215], v[244:245], v[86:87]
    v_pk_mul_f32 v[36:37], v[36:37], v[246:247]
    v_pk_mul_f32 v[38:39], v[38:39], v[246:247]
    v_pk_mul_f32 v[68:69], v[68:69], v[246:247]
    v_pk_mul_f32 v[70:71], v[70:71], v[246:247]
    v_exp_f32 v36, v36
    v_exp_f32 v37, v37
    v_exp_f32 v38, v38
    v_exp_f32 v39, v39
    v_exp_f32 v68, v68
    v_exp_f32 v69, v69
    v_exp_f32 v70, v70
    v_exp_f32 v71, v71
    v_pk_fma_f32 v[36:37], v[36:37], v[190:191], v[190:191]
    v_pk_fma_f32 v[38:39], v[38:39], v[190:191], v[190:191]
    v_pk_fma_f32 v[68:69], v[68:69], v[190:191], v[190:191]
    v_pk_fma_f32 v[70:71], v[70:71], v[190:191], v[190:191]
    v_rcp_f32 v36, v36
    v_rcp_f32 v37, v37
    v_rcp_f32 v38, v38
    v_rcp_f32 v39, v39
    v_rcp_f32 v68, v68
    v_rcp_f32 v69, v69
    v_rcp_f32 v70, v70
    v_rcp_f32 v71, v71
    v_pk_mul_f32 v[52:53], v[52:53], v[36:37]
    v_pk_mul_f32 v[54:55], v[54:55], v[38:39]
    v_pk_mul_f32 v[84:85], v[84:85], v[68:69]
    v_pk_mul_f32 v[86:87], v[86:87], v[70:71]
    v_cvt_pk_bf16_f32 v132, v52, v53
    v_cvt_pk_bf16_f32 v133, v54, v55
    v_cvt_pk_bf16_f32 v134, v84, v85
    v_cvt_pk_bf16_f32 v135, v86, v87
    buffer_store_dwordx4 v[132:135], v6, s[52:55], s56 offen offset:3072 sc1
    v_pk_fma_f32 v[88:89], v[216:217], v[232:233], v[88:89]
    v_pk_fma_f32 v[90:91], v[218:219], v[232:233], v[90:91]
    v_pk_fma_f32 v[104:105], v[220:221], v[232:233], v[104:105]
    v_pk_fma_f32 v[106:107], v[222:223], v[232:233], v[106:107]
    v_pk_mul_f32 v[88:89], v[88:89], v[234:235]
    v_pk_mul_f32 v[90:91], v[90:91], v[234:235]
    v_exp_f32 v88, v88
    v_exp_f32 v89, v89
    v_exp_f32 v90, v90
    v_exp_f32 v91, v91
    s_nop 0
    v_pk_fma_f32 v[88:89], v[88:89], v[184:185], v[184:185]
    v_pk_fma_f32 v[90:91], v[90:91], v[184:185], v[184:185]
    v_rcp_f32 v88, v88
    v_rcp_f32 v89, v89
    v_rcp_f32 v90, v90
    v_rcp_f32 v91, v91
    s_nop 0
    v_pk_mul_f32 v[104:105], v[104:105], v[88:89]
    v_pk_mul_f32 v[106:107], v[106:107], v[90:91]
    v_cvt_pk_bf16_f32 v136, v104, v105
    v_cvt_pk_bf16_f32 v137, v106, v107
    buffer_store_dwordx2 v[136:137], v6, s[52:55], s58 offen offset:0 sc1
    v_pk_fma_f32 v[92:93], v[216:217], v[236:237], v[92:93]
    v_pk_fma_f32 v[94:95], v[218:219], v[236:237], v[94:95]
    v_pk_fma_f32 v[108:109], v[220:221], v[236:237], v[108:109]
    v_pk_fma_f32 v[110:111], v[222:223], v[236:237], v[110:111]
    v_pk_mul_f32 v[92:93], v[92:93], v[238:239]
    v_pk_mul_f32 v[94:95], v[94:95], v[238:239]
    v_exp_f32 v92, v92
    v_exp_f32 v93, v93
    v_exp_f32 v94, v94
    v_exp_f32 v95, v95
    s_nop 0
    v_pk_fma_f32 v[92:93], v[92:93], v[186:187], v[186:187]
    v_pk_fma_f32 v[94:95], v[94:95], v[186:187], v[186:187]
    v_rcp_f32 v92, v92
    v_rcp_f32 v93, v93
    v_rcp_f32 v94, v94
    v_rcp_f32 v95, v95
    s_nop 0
    v_pk_mul_f32 v[108:109], v[108:109], v[92:93]
    v_pk_mul_f32 v[110:111], v[110:111], v[94:95]
    v_cvt_pk_bf16_f32 v140, v108, v109
    v_cvt_pk_bf16_f32 v141, v110, v111
    buffer_store_dwordx2 v[140:141], v6, s[52:55], s58 offen offset:1024 sc1
    v_pk_fma_f32 v[96:97], v[216:217], v[240:241], v[96:97]
    v_pk_fma_f32 v[98:99], v[218:219], v[240:241], v[98:99]
    v_pk_fma_f32 v[112:113], v[220:221], v[240:241], v[112:113]
    v_pk_fma_f32 v[114:115], v[222:223], v[240:241], v[114:115]
    v_pk_mul_f32 v[96:97], v[96:97], v[242:243]
    v_pk_mul_f32 v[98:99], v[98:99], v[242:243]
    v_exp_f32 v96, v96
    v_exp_f32 v97, v97
    v_exp_f32 v98, v98
    v_exp_f32 v99, v99
    s_nop 0
    v_pk_fma_f32 v[96:97], v[96:97], v[188:189], v[188:189]
    v_pk_fma_f32 v[98:99], v[98:99], v[188:189], v[188:189]
    v_rcp_f32 v96, v96
    v_rcp_f32 v97, v97
    v_rcp_f32 v98, v98
    v_rcp_f32 v99, v99
    s_nop 0
    v_pk_mul_f32 v[112:113], v[112:113], v[96:97]
    v_pk_mul_f32 v[114:115], v[114:115], v[98:99]
    v_cvt_pk_bf16_f32 v144, v112, v113
    v_cvt_pk_bf16_f32 v145, v114, v115
    buffer_store_dwordx2 v[144:145], v6, s[52:55], s58 offen offset:2048 sc1
    v_pk_fma_f32 v[100:101], v[216:217], v[244:245], v[100:101]
    v_pk_fma_f32 v[102:103], v[218:219], v[244:245], v[102:103]
    v_pk_fma_f32 v[116:117], v[220:221], v[244:245], v[116:117]
    v_pk_fma_f32 v[118:119], v[222:223], v[244:245], v[118:119]
    v_pk_mul_f32 v[100:101], v[100:101], v[246:247]
    v_pk_mul_f32 v[102:103], v[102:103], v[246:247]
    v_exp_f32 v100, v100
    v_exp_f32 v101, v101
    v_exp_f32 v102, v102
    v_exp_f32 v103, v103
    s_nop 0
    v_pk_fma_f32 v[100:101], v[100:101], v[190:191], v[190:191]
    v_pk_fma_f32 v[102:103], v[102:103], v[190:191], v[190:191]
    v_rcp_f32 v100, v100
    v_rcp_f32 v101, v101
    v_rcp_f32 v102, v102
    v_rcp_f32 v103, v103
    s_nop 0
    v_pk_mul_f32 v[116:117], v[116:117], v[100:101]
    v_pk_mul_f32 v[118:119], v[118:119], v[102:103]
    v_cvt_pk_bf16_f32 v148, v116, v117
    v_cvt_pk_bf16_f32 v149, v118, v119
    buffer_store_dwordx2 v[148:149], v6, s[52:55], s58 offen offset:3072 sc1
gu_end:
    s_lshl_b32 s3, s21, 8
    s_lshl_b32 s28, s22, 3
    s_add_u32 s3, s3, s28
    s_add_u32 s3, s3, 16384
    v_mov_b32 v250, s3
    s_waitcnt vmcnt(0)
    s_add_u32 s56, s6, 0x1a00000
    s_addc_u32 s57, s7, 0
    s_mov_b32 s58, 0x6000
    s_mov_b32 s59, 0x20000
    s_barrier
    s_cmp_lg_u32 s20, 0
    s_cbranch_scc1 pub_skip_21
    s_mov_b64 exec, 1
    buffer_store_dwordx2 v[248:249], v250, s[56:59], 0 offen sc1
    s_mov_b64 exec, -1
pub_skip_21:
    s_and_b32 s21, s2, 3
    s_lshl_b32 s21, s21, 2
    s_bfe_u32 s28, s2, 0x20003
    s_add_u32 s21, s21, s28
    s_lshr_b32 s22, s2, 5
    s_bfe_u32 s26, s2, 0x10002
    s_and_b32 s32, s20, 1
    s_lshr_b32 s33, s20, 1
    s_add_u32 s12, s6, 0x4000000
    s_addc_u32 s13, s7, 0
    s_mov_b32 s14, 0x700000
    s_mov_b32 s15, 0x20000
    s_mov_b32 s8, s6
    s_mov_b32 s9, s7
    s_mov_b32 s10, 0xe00000
    s_mov_b32 s11, 0x20000
    s_mov_b32 s52, s46
    s_mov_b32 s53, s47
    s_mov_b32 s54, 0x100
    s_mov_b32 s55, 0x20000
    v_mov_b32 v20, 0
    buffer_load_dwordx2 v[248:249], v20, s[52:55], 0 offen sc1
    s_cmp_lt_u32 s20, 4
    s_cbranch_scc1 d2_A0
    s_lshl_b32 s28, s22, 1
    s_lshr_b32 s29, s31, 1
    s_add_u32 s28, s28, s29
    s_mul_i32 s28, s28, 458752
    s_mul_i32 s29, s26, 229376
    s_add_u32 s28, s28, s29
    s_and_b32 s29, s31, 1
    s_lshl_b32 s29, s29, 12
    s_add_u32 s25, s28, s29
    s_lshl_b32 s30, s31, 12
    s_add_u32 s30, s30, 16384
    s_mov_b32 s24, 0
    s_add_u32 m0, s24, s30
    s_nop 0
    buffer_load_dwordx4 v6, s[12:15], s25 offen sc1 lds
    buffer_load_dwordx4 v6, s[12:15], s25 offen offset:1024 sc1 lds
    buffer_load_dwordx4 v6, s[12:15], s25 offen offset:2048 sc1 lds
    buffer_load_dwordx4 v6, s[12:15], s25 offen offset:3072 sc1 lds
    s_add_u32 s25, s25, 0x2000
    s_mov_b32 s24, 32768
    s_add_u32 m0, s24, s30
    s_nop 0
    buffer_load_dwordx4 v6, s[12:15], s25 offen sc1 lds
    buffer_load_dwordx4 v6, s[12:15], s25 offen offset:1024 sc1 lds
    buffer_load_dwordx4 v6, s[12:15], s25 offen offset:2048 sc1 lds
    buffer_load_dwordx4 v6, s[12:15], s25 offen offset:3072 sc1 lds
    s_add_u32 s25, s25, 0x2000
    s_mov_b32 s24, 65536
    s_add_u32 m0, s24, s30
    s_nop 0
    buffer_load_dwordx4 v6, s[12:15], s25 offen sc1 lds
    buffer_load_dwordx4 v6, s[12:15], s25 offen offset:1024 sc1 lds
    buffer_load_dwordx4 v6, s[12:15], s25 offen offset:2048 sc1 lds
    buffer_load_dwordx4 v6, s[12:15], s25 offen offset:3072 sc1 lds
    s_add_u32 s25, s25, 0x2000
    s_mov_b32 s24, 98304
    s_add_u32 m0, s24, s30
    s_nop 0
    buffer_load_dwordx4 v6, s[12:15], s25 offen sc1 lds
    buffer_load_dwordx4 v6, s[12:15], s25 offen offset:1024 sc1 lds
    buffer_load_dwordx4 v6, s[12:15], s25 offen offset:2048 sc1 lds
    buffer_load_dwordx4 v6, s[12:15], s25 offen offset:3072 sc1 lds
    s_add_u32 s25, s25, 0x2000
    s_mov_b32 s24, 131072
    s_add_u32 m0, s24, s30
    s_nop 0
    buffer_load_dwordx4 v6, s[12:15], s25 offen sc1 lds
    buffer_load_dwordx4 v6, s[12:15], s25 offen offset:1024 sc1 lds
    buffer_load_dwordx4 v6, s[12:15], s25 offen offset:2048 sc1 lds
    buffer_load_dwordx4 v6, s[12:15], s25 offen offset:3072 sc1 lds
    s_add_u32 s25, s25, 0x2000
    s_branch d2_C0
d2_A0:
    s_mul_i32 s28, s26, 56
    s_lshr_b32 s29, s31, 1
    s_add_u32 s28, s28, s29
    s_lshl_b32 s28, s28, 7
    s_lshl_b32 s29, s21, 3
    s_add_u32 s28, s28, s29
    s_and_b32 s29, s31, 1
    s_lshl_b32 s29, s29, 2
    s_add_u32 s28, s28, s29
    s_lshl_b32 s25, s28, 10
    s_lshl_b32 s30, s31, 12
d2_C0:
    s_lshl_b32 s34, s22, 2
    s_add_u32 s34, s34, s33
    s_lshl_b32 s34, s34, 7
    s_lshl_b32 s35, s21, 3
    s_lshl_b32 s36, s32, 2
    s_add_u32 s35, s35, s36
    s_lshl_b32 s36, s26, 1
    s_add_u32 s35, s35, s36
    s_add_u32 s34, s34, s35
    s_lshl_b32 s34, s34, 10
    s_lshl_b32 s35, s35, 15
    s_lshl_b32 s36, s22, 8
    s_add_u32 s35, s35, s36
    s_lshl_b32 s36, s33, 6
    s_add_u32 s35, s35, s36
    s_add_u32 s36, s35, 32768
    s_add_u32 s16, s6, 0x1400000
    s_addc_u32 s17, s7, 0
    s_mov_b32 s18, 0x400000
    s_mov_b32 s19, 0x20000
    s_mov_b32 s48, s44
    s_mov_b32 s49, s45
    s_mov_b32 s50, 0x400000
    s_mov_b32 s51, 0x20000
    v_lshlrev_b32 v9, 11, v5
    v_and_b32 v15, 1, v2
    v_lshl_add_u32 v9, v15, 5, v9
    v_lshrrev_b32 v15, 1, v2
    v_lshl_add_u32 v9, v15, 4, v9
    s_lshl_b32 s28, s32, 12
    s_lshl_b32 s29, s26, 11
    s_add_u32 s3, s28, s29
    v_add_u32 v10, s3, v6
    s_xor_b32 s3, s3, 2048
    v_add_u32 v15, s3, v6
    v_lshl_add_u32 v11, v2, 2, v3
    v_lshlrev_b32 v11, 7, v11
    v_lshl_add_u32 v11, v4, 3, v11
    s_lshr_b32 s28, s33, 1
    s_lshl_b32 s28, s28, 13
    s_add_u32 s28, s28, 16384
    v_add_u32 v11, s28, v11
    v_bfe_u32 v12, v1, 3, 2
    s_and_b32 s29, s33, 1
    s_lshl_b32 s29, s29, 1
    v_xor_b32 v13, s29, v12
    v_lshl_add_u32 v13, v13, 5, v11
    v_xor_b32 v14, 32, v13
    v_mov_b32 v48, 0
    v_mov_b32 v49, 0
    v_mov_b32 v50, 0
    v_mov_b32 v51, 0
    v_mov_b32 v52, 0
    v_mov_b32 v53, 0
    v_mov_b32 v54, 0
    v_mov_b32 v55, 0
    v_mov_b32 v56, 0
    v_mov_b32 v57, 0
    v_mov_b32 v58, 0
    v_mov_b32 v59, 0
    v_mov_b32 v60, 0
    v_mov_b32 v61, 0
    v_mov_b32 v62, 0
    v_mov_b32 v63, 0
    s_lshr_b32 s40, s21, 1
    s_lshl_b32 s41, s26, 7
    s_cmp_lg_u32 s20, 0
    s_cbranch_scc1 wf_skip_22
    s_add_u32 s56, s6, 0x1a00000
    s_addc_u32 s57, s7, 0
    s_mov_b32 s58, 0x6000
    s_mov_b32 s59, 0x20000
    s_lshl_b32 s3, s40, 8
    s_add_u32 s3, s3, 16384
    v_and_b32 v22, 31, v0
    v_lshlrev_b32 v22, 3, v22
    v_lshlrev_b32 v23, 3, v0
    s_mov_b32 s28, 262144
    buffer_load_dwordx2 v[252:253], v22, s[56:59], s3 offen sc1
wf_loop_23:
    s_waitcnt vmcnt(0)
    v_cmp_ne_u64 vcc, s[62:63], v[252:253]
    s_nop 1
    s_cmp_eq_u64 vcc, 0
    s_cbranch_scc1 wf_skip_22
    s_sleep 1
    buffer_load_dwordx2 v[252:253], v22, s[56:59], s3 offen sc1
    s_sub_u32 s28, s28, 1
    s_cmp_lg_u32 s28, 0
    s_cbranch_scc1 wf_loop_23
wf_skip_22:
    s_barrier
    buffer_load_dwordx4 v[240:243], v6, s[16:19], s34 offen offset:0 sc1
    buffer_load_dwordx4 v[244:247], v6, s[16:19], s34 offen offset:1024 sc1
    s_cmp_ge_u32 s20, 4
    s_cbranch_scc1 d2_B
    s_mov_b32 s24, 0
    s_add_u32 m0, s24, s30
    s_nop 0
    buffer_load_dwordx4 v6, s[8:11], s25 offen sc1 lds
    buffer_load_dwordx4 v6, s[8:11], s25 offen offset:1024 sc1 lds
    buffer_load_dwordx4 v6, s[8:11], s25 offen offset:2048 sc1 lds
    buffer_load_dwordx4 v6, s[8:11], s25 offen offset:3072 sc1 lds
    s_add_u32 s25, s25, 0x40000
    s_barrier
    s_mov_b32 s24, 32768
    s_add_u32 m0, s24, s30
    s_nop 0
    buffer_load_dwordx4 v6, s[8:11], s25 offen sc1 lds
    buffer_load_dwordx4 v6, s[8:11], s25 offen offset:1024 sc1 lds
    buffer_load_dwordx4 v6, s[8:11], s25 offen offset:2048 sc1 lds
    buffer_load_dwordx4 v6, s[8:11], s25 offen offset:3072 sc1 lds
    s_add_u32 s25, s25, 0x40000
    s_barrier
    s_mov_b32 s24, 65536
    s_add_u32 m0, s24, s30
    s_nop 0
    buffer_load_dwordx4 v6, s[8:11], s25 offen sc1 lds
    buffer_load_dwordx4 v6, s[8:11], s25 offen offset:1024 sc1 lds
    buffer_load_dwordx4 v6, s[8:11], s25 offen offset:2048 sc1 lds
    buffer_load_dwordx4 v6, s[8:11], s25 offen offset:3072 sc1 lds
    s_add_u32 s25, s25, 0x40000
    s_barrier
    s_mov_b32 s24, 98304
    s_add_u32 m0, s24, s30
    s_nop 0
    buffer_load_dwordx4 v6, s[8:11], s25 offen sc1 lds
    buffer_load_dwordx4 v6, s[8:11], s25 offen offset:1024 sc1 lds
    buffer_load_dwordx4 v6, s[8:11], s25 offen offset:2048 sc1 lds
    buffer_load_dwordx4 v6, s[8:11], s25 offen offset:3072 sc1 lds
    s_add_u32 s25, s25, 0x40000
    s_barrier
    s_mov_b32 s24, 131072
    s_add_u32 m0, s24, s30
    s_nop 0
    buffer_load_dwordx4 v6, s[8:11], s25 offen sc1 lds
    buffer_load_dwordx4 v6, s[8:11], s25 offen offset:1024 sc1 lds
    buffer_load_dwordx4 v6, s[8:11], s25 offen offset:2048 sc1 lds
    buffer_load_dwordx4 v6, s[8:11], s25 offen offset:3072 sc1 lds
    s_add_u32 s25, s25, 0x40000
    s_waitcnt vmcnt(20)
    v_lshlrev_b32 v32, 16, v240
    v_and_b32 v33, 0xffff0000, v240
    v_lshlrev_b32 v34, 16, v241
    v_and_b32 v35, 0xffff0000, v241
    v_lshlrev_b32 v36, 16, v242
    v_and_b32 v37, 0xffff0000, v242
    v_lshlrev_b32 v38, 16, v243
    v_and_b32 v39, 0xffff0000, v243
    v_lshlrev_b32 v40, 16, v244
    v_and_b32 v41, 0xffff0000, v244
    v_lshlrev_b32 v42, 16, v245
    v_and_b32 v43, 0xffff0000, v245
    v_lshlrev_b32 v44, 16, v246
    v_and_b32 v45, 0xffff0000, v246
    v_lshlrev_b32 v46, 16, v247
    v_and_b32 v47, 0xffff0000, v247
    s_add_u32 s52, s6, 0x1000000
    s_addc_u32 s53, s7, 0
    s_mov_b32 s54, 0x900000
    s_mov_b32 s55, 0x20000
    s_and_b32 s28, s21, 1
    s_lshl_b32 s28, s28, 4
    s_lshl_b32 s29, s26, 3
    s_add_u32 s28, s28, s29
    s_add_u32 s28, s28, s22
    s_lshr_b32 s29, s21, 1
    s_lshl_b32 s40, s28, 17
    s_lshl_b32 s3, s29, 14
    s_add_u32 s40, s40, s3
    s_lshl_b32 s3, s20, 11
    s_add_u32 s40, s40, s3
    s_xor_b32 s41, s40, 0x100000
    s_lshr_b32 s42, s28, 1
    s_lshl_b32 s42, s42, 14
    s_lshl_b32 s3, s29, 11
    s_add_u32 s42, s42, s3
    s_and_b32 s3, s28, 1
    s_lshl_b32 s3, s3, 10
    s_add_u32 s42, s42, s3
    s_lshl_b32 s3, s20, 7
    s_add_u32 s42, s42, s3
    s_xor_b32 s43, s42, 0x10000
    s_add_u32 s42, s42, 8388608
    s_add_u32 s43, s43, 8388608
    v_mov_b32 v20, 0
    s_mov_b32 s23, 0
    v_add_u32 v16, s23, v10
    v_add_u32 v17, s23, v13
    v_add_u32 v18, s23, v14
    v_add_u32 v19, s23, v15
    s_waitcnt vmcnt(16)
    s_barrier
    ds_read_b64_tr_b16 v[96:97], v17 offset:0
    ds_read_b64_tr_b16 v[98:99], v17 offset:2048
    ds_read_b64_tr_b16 v[100:101], v18 offset:0
    ds_read_b64_tr_b16 v[102:103], v18 offset:2048
    ds_read_b128 v[64:67], v16 offset:0
    ds_read_b128 v[68:71], v16 offset:1024
    ds_read_b128 v[72:75], v19 offset:0
    ds_read_b128 v[76:79], v19 offset:1024
    ds_read_b64_tr_b16 v[104:105], v17 offset:4096
    ds_read_b64_tr_b16 v[106:107], v17 offset:6144
    ds_read_b64_tr_b16 v[108:109], v18 offset:4096
    ds_read_b64_tr_b16 v[110:111], v18 offset:6144
    ds_read_b128 v[80:83], v16 offset:8192
    ds_read_b128 v[84:87], v16 offset:9216
    ds_read_b128 v[88:91], v19 offset:8192
    ds_read_b128 v[92:95], v19 offset:9216
    s_mov_b32 s24, s23
    s_add_u32 s23, s23, 32768
    s_cmp_eq_u32 s23, 163840
    s_cselect_b32 s23, 0, s23
    v_add_u32 v16, s23, v10
    v_add_u32 v17, s23, v13
    v_add_u32 v18, s23, v14
    v_add_u32 v19, s23, v15
    s_mov_b32 s27, 11
.p2align 6
d2_loopA:
    s_waitcnt vmcnt(12) lgkmcnt(0)
    s_barrier
    v_mfma_f32_16x16x32_bf16 v[48:51], v[96:99], v[72:75], v[48:51]
    ds_read_b64_tr_b16 v[144:145], v17 offset:0
    ds_read_b64_tr_b16 v[146:147], v17 offset:2048
    v_mfma_f32_16x16x32_bf16 v[56:59], v[96:99], v[76:79], v[56:59]
    ds_read_b64_tr_b16 v[148:149], v18 offset:0
    v_mfma_f32_16x16x32_bf16 v[52:55], v[100:103], v[72:75], v[52:55]
    ds_read_b64_tr_b16 v[150:151], v18 offset:2048
    v_mfma_f32_16x16x32_bf16 v[60:63], v[100:103], v[76:79], v[60:63]
    ds_read_b128 v[112:115], v16 offset:0
    v_mfma_f32_16x16x32_bf16 v[48:51], v[104:107], v[88:91], v[48:51]
    ds_read_b128 v[116:119], v16 offset:1024
    v_mfma_f32_16x16x32_bf16 v[56:59], v[104:107], v[92:95], v[56:59]
    ds_read_b128 v[120:123], v19 offset:0
    v_mfma_f32_16x16x32_bf16 v[52:55], v[108:111], v[88:91], v[52:55]
    ds_read_b128 v[124:127], v19 offset:1024
    v_mfma_f32_16x16x32_bf16 v[60:63], v[108:111], v[92:95], v[60:63]
    ds_read_b64_tr_b16 v[152:153], v17 offset:4096
    ds_read_b64_tr_b16 v[154:155], v17 offset:6144
    v_mfma_f32_16x16x32_bf16 v[32:35], v[96:99], v[64:67], v[32:35]
    ds_read_b64_tr_b16 v[156:157], v18 offset:4096
    v_mfma_f32_16x16x32_bf16 v[40:43], v[96:99], v[68:71], v[40:43]
    ds_read_b64_tr_b16 v[158:159], v18 offset:6144
    v_mfma_f32_16x16x32_bf16 v[36:39], v[100:103], v[64:67], v[36:39]
    ds_read_b128 v[128:131], v16 offset:8192
    v_mfma_f32_16x16x32_bf16 v[44:47], v[100:103], v[68:71], v[44:47]
    ds_read_b128 v[132:135], v16 offset:9216
    v_mfma_f32_16x16x32_bf16 v[32:35], v[104:107], v[80:83], v[32:35]
    ds_read_b128 v[136:139], v19 offset:8192
    v_mfma_f32_16x16x32_bf16 v[40:43], v[104:107], v[84:87], v[40:43]
    ds_read_b128 v[140:143], v19 offset:9216
    v_mfma_f32_16x16x32_bf16 v[36:39], v[108:111], v[80:83], v[36:39]
    v_mfma_f32_16x16x32_bf16 v[44:47], v[108:111], v[84:87], v[44:47]
    s_add_u32 m0, s24, s30
    s_mov_b32 s24, s23
    s_add_u32 s23, s23, 32768
    s_cmp_eq_u32 s23, 163840
    s_cselect_b32 s23, 0, s23
    v_add_u32 v16, s23, v10
    v_add_u32 v17, s23, v13
    v_add_u32 v18, s23, v14
    v_add_u32 v19, s23, v15
    buffer_load_dwordx4 v6, s[8:11], s25 offen sc1 lds
    buffer_load_dwordx4 v6, s[8:11], s25 offen offset:1024 sc1 lds
    buffer_load_dwordx4 v6, s[8:11], s25 offen offset:2048 sc1 lds
    buffer_load_dwordx4 v6, s[8:11], s25 offen offset:3072 sc1 lds
    s_add_u32 s25, s25, 0x40000
    s_waitcnt vmcnt(12) lgkmcnt(0)
    s_barrier
    v_mfma_f32_16x16x32_bf16 v[48:51], v[144:147], v[120:123], v[48:51]
    ds_read_b64_tr_b16 v[96:97], v17 offset:0
    ds_read_b64_tr_b16 v[98:99], v17 offset:2048
    v_mfma_f32_16x16x32_bf16 v[56:59], v[144:147], v[124:127], v[56:59]
    ds_read_b64_tr_b16 v[100:101], v18 offset:0
    v_mfma_f32_16x16x32_bf16 v[52:55], v[148:151], v[120:123], v[52:55]
    ds_read_b64_tr_b16 v[102:103], v18 offset:2048
    v_mfma_f32_16x16x32_bf16 v[60:63], v[148:151], v[124:127], v[60:63]
    ds_read_b128 v[64:67], v16 offset:0
    v_mfma_f32_16x16x32_bf16 v[48:51], v[152:155], v[136:139], v[48:51]
    ds_read_b128 v[68:71], v16 offset:1024
    v_mfma_f32_16x16x32_bf16 v[56:59], v[152:155], v[140:143], v[56:59]
    ds_read_b128 v[72:75], v19 offset:0
    v_mfma_f32_16x16x32_bf16 v[52:55], v[156:159], v[136:139], v[52:55]
    ds_read_b128 v[76:79], v19 offset:1024
    v_mfma_f32_16x16x32_bf16 v[60:63], v[156:159], v[140:143], v[60:63]
    ds_read_b64_tr_b16 v[104:105], v17 offset:4096
    ds_read_b64_tr_b16 v[106:107], v17 offset:6144
    v_mfma_f32_16x16x32_bf16 v[32:35], v[144:147], v[112:115], v[32:35]
    ds_read_b64_tr_b16 v[108:109], v18 offset:4096
    v_mfma_f32_16x16x32_bf16 v[40:43], v[144:147], v[116:119], v[40:43]
    ds_read_b64_tr_b16 v[110:111], v18 offset:6144
    v_mfma_f32_16x16x32_bf16 v[36:39], v[148:151], v[112:115], v[36:39]
    ds_read_b128 v[80:83], v16 offset:8192
    v_mfma_f32_16x16x32_bf16 v[44:47], v[148:151], v[116:119], v[44:47]
    ds_read_b128 v[84:87], v16 offset:9216
    v_mfma_f32_16x16x32_bf16 v[32:35], v[152:155], v[128:131], v[32:35]
    ds_read_b128 v[88:91], v19 offset:8192
    v_mfma_f32_16x16x32_bf16 v[40:43], v[152:155], v[132:135], v[40:43]
    ds_read_b128 v[92:95], v19 offset:9216
    v_mfma_f32_16x16x32_bf16 v[36:39], v[156:159], v[128:131], v[36:39]
    v_mfma_f32_16x16x32_bf16 v[44:47], v[156:159], v[132:135], v[44:47]
    s_add_u32 m0, s24, s30
    s_mov_b32 s24, s23
    s_add_u32 s23, s23, 32768
    s_cmp_eq_u32 s23, 163840
    s_cselect_b32 s23, 0, s23
    v_add_u32 v16, s23, v10
    v_add_u32 v17, s23, v13
    v_add_u32 v18, s23, v14
    v_add_u32 v19, s23, v15
    buffer_load_dwordx4 v6, s[8:11], s25 offen sc1 lds
    buffer_load_dwordx4 v6, s[8:11], s25 offen offset:1024 sc1 lds
    buffer_load_dwordx4 v6, s[8:11], s25 offen offset:2048 sc1 lds
    buffer_load_dwordx4 v6, s[8:11], s25 offen offset:3072 sc1 lds
    s_add_u32 s25, s25, 0x40000
    s_sub_u32 s27, s27, 1
    s_cmp_lg_u32 s27, 0
    s_cbranch_scc1 d2_loopA
    s_waitcnt vmcnt(12) lgkmcnt(0)
    s_barrier
    v_mfma_f32_16x16x32_bf16 v[48:51], v[96:99], v[72:75], v[48:51]
    ds_read_b64_tr_b16 v[144:145], v17 offset:0
    ds_read_b64_tr_b16 v[146:147], v17 offset:2048
    v_mfma_f32_16x16x32_bf16 v[56:59], v[96:99], v[76:79], v[56:59]
    ds_read_b64_tr_b16 v[148:149], v18 offset:0
    v_mfma_f32_16x16x32_bf16 v[52:55], v[100:103], v[72:75], v[52:55]
    ds_read_b64_tr_b16 v[150:151], v18 offset:2048
    v_mfma_f32_16x16x32_bf16 v[60:63], v[100:103], v[76:79], v[60:63]
    ds_read_b128 v[112:115], v16 offset:0
    v_mfma_f32_16x16x32_bf16 v[48:51], v[104:107], v[88:91], v[48:51]
    ds_read_b128 v[116:119], v16 offset:1024
    v_mfma_f32_16x16x32_bf16 v[56:59], v[104:107], v[92:95], v[56:59]
    ds_read_b128 v[120:123], v19 offset:0
    v_mfma_f32_16x16x32_bf16 v[52:55], v[108:111], v[88:91], v[52:55]
    ds_read_b128 v[124:127], v19 offset:1024
    v_mfma_f32_16x16x32_bf16 v[60:63], v[108:111], v[92:95], v[60:63]
    ds_read_b64_tr_b16 v[152:153], v17 offset:4096
    ds_read_b64_tr_b16 v[154:155], v17 offset:6144
    v_mfma_f32_16x16x32_bf16 v[32:35], v[96:99], v[64:67], v[32:35]
    ds_read_b64_tr_b16 v[156:157], v18 offset:4096
    v_mfma_f32_16x16x32_bf16 v[40:43], v[96:99], v[68:71], v[40:43]
    ds_read_b64_tr_b16 v[158:159], v18 offset:6144
    v_mfma_f32_16x16x32_bf16 v[36:39], v[100:103], v[64:67], v[36:39]
    ds_read_b128 v[128:131], v16 offset:8192
    v_mfma_f32_16x16x32_bf16 v[44:47], v[100:103], v[68:71], v[44:47]
    ds_read_b128 v[132:135], v16 offset:9216
    v_mfma_f32_16x16x32_bf16 v[32:35], v[104:107], v[80:83], v[32:35]
    ds_read_b128 v[136:139], v19 offset:8192
    v_mfma_f32_16x16x32_bf16 v[40:43], v[104:107], v[84:87], v[40:43]
    ds_read_b128 v[140:143], v19 offset:9216
    v_mfma_f32_16x16x32_bf16 v[36:39], v[108:111], v[80:83], v[36:39]
    v_mfma_f32_16x16x32_bf16 v[44:47], v[108:111], v[84:87], v[44:47]
    s_add_u32 m0, s24, s30
    s_mov_b32 s24, s23
    s_add_u32 s23, s23, 32768
    s_cmp_eq_u32 s23, 163840
    s_cselect_b32 s23, 0, s23
    v_add_u32 v16, s23, v10
    v_add_u32 v17, s23, v13
    v_add_u32 v18, s23, v14
    v_add_u32 v19, s23, v15
    buffer_load_dwordx4 v6, s[8:11], s25 offen sc1 lds
    buffer_load_dwordx4 v6, s[8:11], s25 offen offset:1024 sc1 lds
    buffer_load_dwordx4 v6, s[8:11], s25 offen offset:2048 sc1 lds
    buffer_load_dwordx4 v6, s[8:11], s25 offen offset:3072 sc1 lds
    s_add_u32 s25, s25, 0x40000
    s_waitcnt vmcnt(12) lgkmcnt(0)
    s_barrier
    v_mfma_f32_16x16x32_bf16 v[48:51], v[144:147], v[120:123], v[48:51]
    ds_read_b64_tr_b16 v[96:97], v17 offset:0
    ds_read_b64_tr_b16 v[98:99], v17 offset:2048
    v_mfma_f32_16x16x32_bf16 v[56:59], v[144:147], v[124:127], v[56:59]
    ds_read_b64_tr_b16 v[100:101], v18 offset:0
    ds_read_b64_tr_b16 v[102:103], v18 offset:2048
    v_mfma_f32_16x16x32_bf16 v[52:55], v[148:151], v[120:123], v[52:55]
    ds_read_b128 v[64:67], v16 offset:0
    v_mfma_f32_16x16x32_bf16 v[60:63], v[148:151], v[124:127], v[60:63]
    ds_read_b128 v[68:71], v16 offset:1024
    ds_read_b128 v[72:75], v19 offset:0
    v_mfma_f32_16x16x32_bf16 v[48:51], v[152:155], v[136:139], v[48:51]
    ds_read_b128 v[76:79], v19 offset:1024
    v_mfma_f32_16x16x32_bf16 v[56:59], v[152:155], v[140:143], v[56:59]
    ds_read_b64_tr_b16 v[104:105], v17 offset:4096
    ds_read_b64_tr_b16 v[106:107], v17 offset:6144
    v_mfma_f32_16x16x32_bf16 v[52:55], v[156:159], v[136:139], v[52:55]
    ds_read_b64_tr_b16 v[108:109], v18 offset:4096
    ds_read_b64_tr_b16 v[110:111], v18 offset:6144
    v_mfma_f32_16x16x32_bf16 v[60:63], v[156:159], v[140:143], v[60:63]
    ds_read_b128 v[80:83], v16 offset:8192
    v_mfma_f32_16x16x32_bf16 v[32:35], v[144:147], v[112:115], v[32:35]
    ds_read_b128 v[84:87], v16 offset:9216
    ds_read_b128 v[88:91], v19 offset:8192
    v_mfma_f32_16x16x32_bf16 v[40:43], v[144:147], v[116:119], v[40:43]
    ds_read_b128 v[92:95], v19 offset:9216
    v_mfma_f32_16x16x32_bf16 v[36:39], v[148:151], v[112:115], v[36:39]
    v_mfma_f32_16x16x32_bf16 v[44:47], v[148:151], v[116:119], v[44:47]
    v_mfma_f32_16x16x32_bf16 v[32:35], v[152:155], v[128:131], v[32:35]
    v_mfma_f32_16x16x32_bf16 v[40:43], v[152:155], v[132:135], v[40:43]
    v_mfma_f32_16x16x32_bf16 v[36:39], v[156:159], v[128:131], v[36:39]
    v_mfma_f32_16x16x32_bf16 v[44:47], v[156:159], v[132:135], v[44:47]
    s_getpc_b64 s[56:57]
    ct_25:
    s_add_u32 s56, s56, d2_epi-ct_25
    s_addc_u32 s57, s57, 0
    s_and_b32 s56, s56, 0xffffff80
    s_mov_b32 s58, code_end-d2_epi
    s_mov_b32 s59, 0x20000
    v_lshlrev_b32 v252, 7, v1
    s_lshl_b32 s28, s31, 13
    buffer_load_dword v251, v252, s[56:59], s28 offen
    s_mov_b32 s24, s23
    s_add_u32 s23, s23, 32768
    s_cmp_eq_u32 s23, 163840
    s_cselect_b32 s23, 0, s23
    v_add_u32 v16, s23, v10
    v_add_u32 v17, s23, v13
    v_add_u32 v18, s23, v14
    v_add_u32 v19, s23, v15
    s_waitcnt vmcnt(9) lgkmcnt(0)
    s_barrier
    v_mfma_f32_16x16x32_bf16 v[48:51], v[96:99], v[72:75], v[48:51]
    ds_read_b64_tr_b16 v[144:145], v17 offset:0
    ds_read_b64_tr_b16 v[146:147], v17 offset:2048
    v_mfma_f32_16x16x32_bf16 v[56:59], v[96:99], v[76:79], v[56:59]
    ds_read_b64_tr_b16 v[148:149], v18 offset:0
    ds_read_b64_tr_b16 v[150:151], v18 offset:2048
    v_mfma_f32_16x16x32_bf16 v[52:55], v[100:103], v[72:75], v[52:55]
    ds_read_b128 v[112:115], v16 offset:0
    v_mfma_f32_16x16x32_bf16 v[60:63], v[100:103], v[76:79], v[60:63]
    ds_read_b128 v[116:119], v16 offset:1024
    ds_read_b128 v[120:123], v19 offset:0
    v_mfma_f32_16x16x32_bf16 v[48:51], v[104:107], v[88:91], v[48:51]
    ds_read_b128 v[124:127], v19 offset:1024
    v_mfma_f32_16x16x32_bf16 v[56:59], v[104:107], v[92:95], v[56:59]
    ds_read_b64_tr_b16 v[152:153], v17 offset:4096
    ds_read_b64_tr_b16 v[154:155], v17 offset:6144
    v_mfma_f32_16x16x32_bf16 v[52:55], v[108:111], v[88:91], v[52:55]
    ds_read_b64_tr_b16 v[156:157], v18 offset:4096
    ds_read_b64_tr_b16 v[158:159], v18 offset:6144
    v_mfma_f32_16x16x32_bf16 v[60:63], v[108:111], v[92:95], v[60:63]
    ds_read_b128 v[128:131], v16 offset:8192
    v_mfma_f32_16x16x32_bf16 v[32:35], v[96:99], v[64:67], v[32:35]
    ds_read_b128 v[132:135], v16 offset:9216
    ds_read_b128 v[136:139], v19 offset:8192
    v_mfma_f32_16x16x32_bf16 v[40:43], v[96:99], v[68:71], v[40:43]
    ds_read_b128 v[140:143], v19 offset:9216
    v_mfma_f32_16x16x32_bf16 v[36:39], v[100:103], v[64:67], v[36:39]
    v_mfma_f32_16x16x32_bf16 v[44:47], v[100:103], v[68:71], v[44:47]
    v_mfma_f32_16x16x32_bf16 v[32:35], v[104:107], v[80:83], v[32:35]
    v_mfma_f32_16x16x32_bf16 v[40:43], v[104:107], v[84:87], v[40:43]
    v_mfma_f32_16x16x32_bf16 v[36:39], v[108:111], v[80:83], v[36:39]
    v_mfma_f32_16x16x32_bf16 v[44:47], v[108:111], v[84:87], v[44:47]
    s_mov_b32 s24, s23
    s_add_u32 s23, s23, 32768
    s_cmp_eq_u32 s23, 163840
    s_cselect_b32 s23, 0, s23
    v_add_u32 v16, s23, v10
    v_add_u32 v17, s23, v13
    v_add_u32 v18, s23, v14
    v_add_u32 v19, s23, v15
    s_waitcnt vmcnt(5) lgkmcnt(0)
    s_barrier
    v_mfma_f32_16x16x32_bf16 v[48:51], v[144:147], v[120:123], v[48:51]
    ds_read_b64_tr_b16 v[96:97], v17 offset:0
    ds_read_b64_tr_b16 v[98:99], v17 offset:2048
    v_mfma_f32_16x16x32_bf16 v[56:59], v[144:147], v[124:127], v[56:59]
    ds_read_b64_tr_b16 v[100:101], v18 offset:0
    ds_read_b64_tr_b16 v[102:103], v18 offset:2048
    v_mfma_f32_16x16x32_bf16 v[52:55], v[148:151], v[120:123], v[52:55]
    ds_read_b128 v[64:67], v16 offset:0
    v_mfma_f32_16x16x32_bf16 v[60:63], v[148:151], v[124:127], v[60:63]
    ds_read_b128 v[68:71], v16 offset:1024
    ds_read_b128 v[72:75], v19 offset:0
    v_mfma_f32_16x16x32_bf16 v[48:51], v[152:155], v[136:139], v[48:51]
    ds_read_b128 v[76:79], v19 offset:1024
    v_mfma_f32_16x16x32_bf16 v[56:59], v[152:155], v[140:143], v[56:59]
    ds_read_b64_tr_b16 v[104:105], v17 offset:4096
    ds_read_b64_tr_b16 v[106:107], v17 offset:6144
    v_mfma_f32_16x16x32_bf16 v[52:55], v[156:159], v[136:139], v[52:55]
    ds_read_b64_tr_b16 v[108:109], v18 offset:4096
    ds_read_b64_tr_b16 v[110:111], v18 offset:6144
    v_mfma_f32_16x16x32_bf16 v[60:63], v[156:159], v[140:143], v[60:63]
    ds_read_b128 v[80:83], v16 offset:8192
    v_mfma_f32_16x16x32_bf16 v[32:35], v[144:147], v[112:115], v[32:35]
    ds_read_b128 v[84:87], v16 offset:9216
    ds_read_b128 v[88:91], v19 offset:8192
    v_mfma_f32_16x16x32_bf16 v[40:43], v[144:147], v[116:119], v[40:43]
    ds_read_b128 v[92:95], v19 offset:9216
    v_mfma_f32_16x16x32_bf16 v[36:39], v[148:151], v[112:115], v[36:39]
    v_mfma_f32_16x16x32_bf16 v[44:47], v[148:151], v[116:119], v[44:47]
    v_mfma_f32_16x16x32_bf16 v[32:35], v[152:155], v[128:131], v[32:35]
    v_mfma_f32_16x16x32_bf16 v[40:43], v[152:155], v[132:135], v[40:43]
    v_mfma_f32_16x16x32_bf16 v[36:39], v[156:159], v[128:131], v[36:39]
    v_mfma_f32_16x16x32_bf16 v[44:47], v[156:159], v[132:135], v[44:47]
    s_mov_b32 s24, s23
    s_add_u32 s23, s23, 32768
    s_cmp_eq_u32 s23, 163840
    s_cselect_b32 s23, 0, s23
    v_add_u32 v16, s23, v10
    v_add_u32 v17, s23, v13
    v_add_u32 v18, s23, v14
    v_add_u32 v19, s23, v15
    s_waitcnt vmcnt(1) lgkmcnt(0)
    s_barrier
    v_mfma_f32_16x16x32_bf16 v[48:51], v[96:99], v[72:75], v[48:51]
    ds_read_b64_tr_b16 v[144:145], v17 offset:0
    ds_read_b64_tr_b16 v[146:147], v17 offset:2048
    v_mfma_f32_16x16x32_bf16 v[56:59], v[96:99], v[76:79], v[56:59]
    ds_read_b64_tr_b16 v[148:149], v18 offset:0
    ds_read_b64_tr_b16 v[150:151], v18 offset:2048
    v_mfma_f32_16x16x32_bf16 v[52:55], v[100:103], v[72:75], v[52:55]
    ds_read_b128 v[112:115], v16 offset:0
    v_mfma_f32_16x16x32_bf16 v[60:63], v[100:103], v[76:79], v[60:63]
    ds_read_b128 v[116:119], v16 offset:1024
    ds_read_b128 v[120:123], v19 offset:0
    v_mfma_f32_16x16x32_bf16 v[48:51], v[104:107], v[88:91], v[48:51]
    ds_read_b128 v[124:127], v19 offset:1024
    v_mfma_f32_16x16x32_bf16 v[56:59], v[104:107], v[92:95], v[56:59]
    ds_read_b64_tr_b16 v[152:153], v17 offset:4096
    ds_read_b64_tr_b16 v[154:155], v17 offset:6144
    v_mfma_f32_16x16x32_bf16 v[52:55], v[108:111], v[88:91], v[52:55]
    ds_read_b64_tr_b16 v[156:157], v18 offset:4096
    ds_read_b64_tr_b16 v[158:159], v18 offset:6144
    v_mfma_f32_16x16x32_bf16 v[60:63], v[108:111], v[92:95], v[60:63]
    ds_read_b128 v[128:131], v16 offset:8192
    v_mfma_f32_16x16x32_bf16 v[32:35], v[96:99], v[64:67], v[32:35]
    ds_read_b128 v[132:135], v16 offset:9216
    ds_read_b128 v[136:139], v19 offset:8192
    v_mfma_f32_16x16x32_bf16 v[40:43], v[96:99], v[68:71], v[40:43]
    ds_read_b128 v[140:143], v19 offset:9216
    v_mfma_f32_16x16x32_bf16 v[36:39], v[100:103], v[64:67], v[36:39]
    v_mfma_f32_16x16x32_bf16 v[44:47], v[100:103], v[68:71], v[44:47]
    v_mfma_f32_16x16x32_bf16 v[32:35], v[104:107], v[80:83], v[32:35]
    v_mfma_f32_16x16x32_bf16 v[40:43], v[104:107], v[84:87], v[40:43]
    v_mfma_f32_16x16x32_bf16 v[36:39], v[108:111], v[80:83], v[36:39]
    v_mfma_f32_16x16x32_bf16 v[44:47], v[108:111], v[84:87], v[44:47]
    s_mov_b32 s24, s23
    s_add_u32 s23, s23, 32768
    s_cmp_eq_u32 s23, 163840
    s_cselect_b32 s23, 0, s23
    v_add_u32 v16, s23, v10
    v_add_u32 v17, s23, v13
    v_add_u32 v18, s23, v14
    v_add_u32 v19, s23, v15
    s_waitcnt lgkmcnt(0)
    v_mfma_f32_16x16x32_bf16 v[48:51], v[144:147], v[120:123], v[48:51]
    v_mfma_f32_16x16x32_bf16 v[56:59], v[144:147], v[124:127], v[56:59]
    v_mfma_f32_16x16x32_bf16 v[52:55], v[148:151], v[120:123], v[52:55]
    v_mfma_f32_16x16x32_bf16 v[60:63], v[148:151], v[124:127], v[60:63]
    v_mfma_f32_16x16x32_bf16 v[48:51], v[152:155], v[136:139], v[48:51]
    v_mfma_f32_16x16x32_bf16 v[56:59], v[152:155], v[140:143], v[56:59]
    v_mfma_f32_16x16x32_bf16 v[52:55], v[156:159], v[136:139], v[52:55]
    v_mfma_f32_16x16x32_bf16 v[60:63], v[156:159], v[140:143], v[60:63]
    v_mfma_f32_16x16x32_bf16 v[32:35], v[144:147], v[112:115], v[32:35]
    v_mfma_f32_16x16x32_bf16 v[40:43], v[144:147], v[116:119], v[40:43]
    v_mfma_f32_16x16x32_bf16 v[36:39], v[148:151], v[112:115], v[36:39]
    v_mfma_f32_16x16x32_bf16 v[44:47], v[148:151], v[116:119], v[44:47]
    s_nop 4
    v_cvt_pk_bf16_f32 v160, v48, v49
    v_cvt_pk_bf16_f32 v161, v50, v51
    v_mfma_f32_16x16x32_bf16 v[32:35], v[152:155], v[128:131], v[32:35]
    v_cvt_pk_bf16_f32 v162, v52, v53
    v_cvt_pk_bf16_f32 v163, v54, v55
    v_mfma_f32_16x16x32_bf16 v[40:43], v[152:155], v[132:135], v[40:43]
    buffer_store_dwordx4 v[160:163], v6, s[52:55], s40 offen offset:0 sc1
    v_cvt_pk_bf16_f32 v164, v56, v57
    v_mfma_f32_16x16x32_bf16 v[36:39], v[156:159], v[128:131], v[36:39]
    v_cvt_pk_bf16_f32 v165, v58, v59
    v_cvt_pk_bf16_f32 v166, v60, v61
    v_mfma_f32_16x16x32_bf16 v[44:47], v[156:159], v[132:135], v[44:47]
    v_cvt_pk_bf16_f32 v167, v62, v63
    buffer_store_dwordx4 v[164:167], v6, s[52:55], s40 offen offset:1024 sc1
    s_nop 7
    s_branch d2_epi
d2_B:
    s_barrier
    s_barrier
    s_barrier
    s_barrier
    s_waitcnt vmcnt(0)
    v_lshlrev_b32 v32, 16, v240
    v_and_b32 v33, 0xffff0000, v240
    v_lshlrev_b32 v34, 16, v241
    v_and_b32 v35, 0xffff0000, v241
    v_lshlrev_b32 v36, 16, v242
    v_and_b32 v37, 0xffff0000, v242
    v_lshlrev_b32 v38, 16, v243
    v_and_b32 v39, 0xffff0000, v243
    v_lshlrev_b32 v40, 16, v244
    v_and_b32 v41, 0xffff0000, v244
    v_lshlrev_b32 v42, 16, v245
    v_and_b32 v43, 0xffff0000, v245
    v_lshlrev_b32 v44, 16, v246
    v_and_b32 v45, 0xffff0000, v246
    v_lshlrev_b32 v46, 16, v247
    v_and_b32 v47, 0xffff0000, v247
    s_add_u32 s52, s6, 0x1000000
    s_addc_u32 s53, s7, 0
    s_mov_b32 s54, 0x900000
    s_mov_b32 s55, 0x20000
    s_and_b32 s28, s21, 1
    s_lshl_b32 s28, s28, 4
    s_lshl_b32 s29, s26, 3
    s_add_u32 s28, s28, s29
    s_add_u32 s28, s28, s22
    s_lshr_b32 s29, s21, 1
    s_lshl_b32 s40, s28, 17
    s_lshl_b32 s3, s29, 14
    s_add_u32 s40, s40, s3
    s_lshl_b32 s3, s20, 11
    s_add_u32 s40, s40, s3
    s_xor_b32 s41, s40, 0x100000
    s_lshr_b32 s42, s28, 1
    s_lshl_b32 s42, s42, 14
    s_lshl_b32 s3, s29, 11
    s_add_u32 s42, s42, s3
    s_and_b32 s3, s28, 1
    s_lshl_b32 s3, s3, 10
    s_add_u32 s42, s42, s3
    s_lshl_b32 s3, s20, 7
    s_add_u32 s42, s42, s3
    s_xor_b32 s43, s42, 0x10000
    s_add_u32 s42, s42, 8388608
    s_add_u32 s43, s43, 8388608
    v_mov_b32 v20, 0
    s_mov_b32 s23, 0
    v_add_u32 v16, s23, v10
    v_add_u32 v17, s23, v13
    v_add_u32 v18, s23, v14
    v_add_u32 v19, s23, v15
    s_waitcnt vmcnt(16)
    s_barrier
    ds_read_b64_tr_b16 v[96:97], v17 offset:0
    ds_read_b64_tr_b16 v[98:99], v17 offset:2048
    ds_read_b64_tr_b16 v[100:101], v18 offset:0
    ds_read_b64_tr_b16 v[102:103], v18 offset:2048
    ds_read_b128 v[64:67], v16 offset:0
    ds_read_b128 v[68:71], v16 offset:1024
    ds_read_b128 v[72:75], v19 offset:0
    ds_read_b128 v[76:79], v19 offset:1024
    ds_read_b64_tr_b16 v[104:105], v17 offset:4096
    ds_read_b64_tr_b16 v[106:107], v17 offset:6144
    ds_read_b64_tr_b16 v[108:109], v18 offset:4096
    ds_read_b64_tr_b16 v[110:111], v18 offset:6144
    ds_read_b128 v[80:83], v16 offset:8192
    ds_read_b128 v[84:87], v16 offset:9216
    ds_read_b128 v[88:91], v19 offset:8192
    ds_read_b128 v[92:95], v19 offset:9216
    s_mov_b32 s24, s23
    s_add_u32 s23, s23, 32768
    s_cmp_eq_u32 s23, 163840
    s_cselect_b32 s23, 0, s23
    v_add_u32 v16, s23, v10
    v_add_u32 v17, s23, v13
    v_add_u32 v18, s23, v14
    v_add_u32 v19, s23, v15
    s_mov_b32 s27, 11
.p2align 6
d2_loopB:
    s_waitcnt vmcnt(12) lgkmcnt(0)
    s_barrier
    s_add_u32 m0, s24, s30
    s_nop 0
    buffer_load_dwordx4 v6, s[12:15], s25 offen sc1 lds
    buffer_load_dwordx4 v6, s[12:15], s25 offen offset:1024 sc1 lds
    buffer_load_dwordx4 v6, s[12:15], s25 offen offset:2048 sc1 lds
    buffer_load_dwordx4 v6, s[12:15], s25 offen offset:3072 sc1 lds
    s_add_u32 s25, s25, 0x2000
    v_mfma_f32_16x16x32_bf16 v[48:51], v[96:99], v[72:75], v[48:51]
    ds_read_b64_tr_b16 v[144:145], v17 offset:0
    ds_read_b64_tr_b16 v[146:147], v17 offset:2048
    v_mfma_f32_16x16x32_bf16 v[56:59], v[96:99], v[76:79], v[56:59]
    ds_read_b64_tr_b16 v[148:149], v18 offset:0
    ds_read_b64_tr_b16 v[150:151], v18 offset:2048
    v_mfma_f32_16x16x32_bf16 v[52:55], v[100:103], v[72:75], v[52:55]
    ds_read_b128 v[112:115], v16 offset:0
    v_mfma_f32_16x16x32_bf16 v[60:63], v[100:103], v[76:79], v[60:63]
    ds_read_b128 v[116:119], v16 offset:1024
    ds_read_b128 v[120:123], v19 offset:0
    v_mfma_f32_16x16x32_bf16 v[48:51], v[104:107], v[88:91], v[48:51]
    ds_read_b128 v[124:127], v19 offset:1024
    v_mfma_f32_16x16x32_bf16 v[56:59], v[104:107], v[92:95], v[56:59]
    ds_read_b64_tr_b16 v[152:153], v17 offset:4096
    ds_read_b64_tr_b16 v[154:155], v17 offset:6144
    v_mfma_f32_16x16x32_bf16 v[52:55], v[108:111], v[88:91], v[52:55]
    ds_read_b64_tr_b16 v[156:157], v18 offset:4096
    ds_read_b64_tr_b16 v[158:159], v18 offset:6144
    v_mfma_f32_16x16x32_bf16 v[60:63], v[108:111], v[92:95], v[60:63]
    ds_read_b128 v[128:131], v16 offset:8192
    v_mfma_f32_16x16x32_bf16 v[32:35], v[96:99], v[64:67], v[32:35]
    ds_read_b128 v[132:135], v16 offset:9216
    ds_read_b128 v[136:139], v19 offset:8192
    v_mfma_f32_16x16x32_bf16 v[40:43], v[96:99], v[68:71], v[40:43]
    ds_read_b128 v[140:143], v19 offset:9216
    v_mfma_f32_16x16x32_bf16 v[36:39], v[100:103], v[64:67], v[36:39]
    s_mov_b32 s24, s23
    s_add_u32 s23, s23, 32768
    v_mfma_f32_16x16x32_bf16 v[44:47], v[100:103], v[68:71], v[44:47]
    s_cmp_eq_u32 s23, 163840
    s_cselect_b32 s23, 0, s23
    v_mfma_f32_16x16x32_bf16 v[32:35], v[104:107], v[80:83], v[32:35]
    v_add_u32 v16, s23, v10
    v_add_u32 v17, s23, v13
    v_mfma_f32_16x16x32_bf16 v[40:43], v[104:107], v[84:87], v[40:43]
    v_add_u32 v18, s23, v14
    v_mfma_f32_16x16x32_bf16 v[36:39], v[108:111], v[80:83], v[36:39]
    v_add_u32 v19, s23, v15
    v_mfma_f32_16x16x32_bf16 v[44:47], v[108:111], v[84:87], v[44:47]
    s_waitcnt vmcnt(12) lgkmcnt(0)
    s_barrier
    s_add_u32 m0, s24, s30
    s_nop 0
    buffer_load_dwordx4 v6, s[12:15], s25 offen sc1 lds
    buffer_load_dwordx4 v6, s[12:15], s25 offen offset:1024 sc1 lds
    buffer_load_dwordx4 v6, s[12:15], s25 offen offset:2048 sc1 lds
    buffer_load_dwordx4 v6, s[12:15], s25 offen offset:3072 sc1 lds
    s_add_u32 s25, s25, 0x2000
    v_mfma_f32_16x16x32_bf16 v[48:51], v[144:147], v[120:123], v[48:51]
    ds_read_b64_tr_b16 v[96:97], v17 offset:0
    ds_read_b64_tr_b16 v[98:99], v17 offset:2048
    v_mfma_f32_16x16x32_bf16 v[56:59], v[144:147], v[124:127], v[56:59]
    ds_read_b64_tr_b16 v[100:101], v18 offset:0
    ds_read_b64_tr_b16 v[102:103], v18 offset:2048
    v_mfma_f32_16x16x32_bf16 v[52:55], v[148:151], v[120:123], v[52:55]
    ds_read_b128 v[64:67], v16 offset:0
    v_mfma_f32_16x16x32_bf16 v[60:63], v[148:151], v[124:127], v[60:63]
    ds_read_b128 v[68:71], v16 offset:1024
    ds_read_b128 v[72:75], v19 offset:0
    v_mfma_f32_16x16x32_bf16 v[48:51], v[152:155], v[136:139], v[48:51]
    ds_read_b128 v[76:79], v19 offset:1024
    v_mfma_f32_16x16x32_bf16 v[56:59], v[152:155], v[140:143], v[56:59]
    ds_read_b64_tr_b16 v[104:105], v17 offset:4096
    ds_read_b64_tr_b16 v[106:107], v17 offset:6144
    v_mfma_f32_16x16x32_bf16 v[52:55], v[156:159], v[136:139], v[52:55]
    ds_read_b64_tr_b16 v[108:109], v18 offset:4096
    ds_read_b64_tr_b16 v[110:111], v18 offset:6144
    v_mfma_f32_16x16x32_bf16 v[60:63], v[156:159], v[140:143], v[60:63]
    ds_read_b128 v[80:83], v16 offset:8192
    v_mfma_f32_16x16x32_bf16 v[32:35], v[144:147], v[112:115], v[32:35]
    ds_read_b128 v[84:87], v16 offset:9216
    ds_read_b128 v[88:91], v19 offset:8192
    v_mfma_f32_16x16x32_bf16 v[40:43], v[144:147], v[116:119], v[40:43]
    ds_read_b128 v[92:95], v19 offset:9216
    v_mfma_f32_16x16x32_bf16 v[36:39], v[148:151], v[112:115], v[36:39]
    s_mov_b32 s24, s23
    s_add_u32 s23, s23, 32768
    v_mfma_f32_16x16x32_bf16 v[44:47], v[148:151], v[116:119], v[44:47]
    s_cmp_eq_u32 s23, 163840
    s_cselect_b32 s23, 0, s23
    v_add_u32 v16, s23, v10
    v_mfma_f32_16x16x32_bf16 v[32:35], v[152:155], v[128:131], v[32:35]
    v_add_u32 v17, s23, v13
    v_mfma_f32_16x16x32_bf16 v[40:43], v[152:155], v[132:135], v[40:43]
    v_add_u32 v18, s23, v14
    v_add_u32 v19, s23, v15
    v_mfma_f32_16x16x32_bf16 v[36:39], v[156:159], v[128:131], v[36:39]
    s_sub_u32 s27, s27, 1
    s_cmp_lg_u32 s27, 0
    v_mfma_f32_16x16x32_bf16 v[44:47], v[156:159], v[132:135], v[44:47]
    s_cbranch_scc1 d2_loopB
    s_waitcnt vmcnt(12) lgkmcnt(0)
    s_barrier
    s_add_u32 m0, s24, s30
    s_nop 0
    buffer_load_dwordx4 v6, s[12:15], s25 offen sc1 lds
    buffer_load_dwordx4 v6, s[12:15], s25 offen offset:1024 sc1 lds
    buffer_load_dwordx4 v6, s[12:15], s25 offen offset:2048 sc1 lds
    buffer_load_dwordx4 v6, s[12:15], s25 offen offset:3072 sc1 lds
    s_add_u32 s25, s25, 0x2000
    v_mfma_f32_16x16x32_bf16 v[48:51], v[96:99], v[72:75], v[48:51]
    ds_read_b64_tr_b16 v[144:145], v17 offset:0
    ds_read_b64_tr_b16 v[146:147], v17 offset:2048
    v_mfma_f32_16x16x32_bf16 v[56:59], v[96:99], v[76:79], v[56:59]
    ds_read_b64_tr_b16 v[148:149], v18 offset:0
    ds_read_b64_tr_b16 v[150:151], v18 offset:2048
    v_mfma_f32_16x16x32_bf16 v[52:55], v[100:103], v[72:75], v[52:55]
    ds_read_b128 v[112:115], v16 offset:0
    v_mfma_f32_16x16x32_bf16 v[60:63], v[100:103], v[76:79], v[60:63]
    ds_read_b128 v[116:119], v16 offset:1024
    ds_read_b128 v[120:123], v19 offset:0
    v_mfma_f32_16x16x32_bf16 v[48:51], v[104:107], v[88:91], v[48:51]
    ds_read_b128 v[124:127], v19 offset:1024
    v_mfma_f32_16x16x32_bf16 v[56:59], v[104:107], v[92:95], v[56:59]
    ds_read_b64_tr_b16 v[152:153], v17 offset:4096
    ds_read_b64_tr_b16 v[154:155], v17 offset:6144
    v_mfma_f32_16x16x32_bf16 v[52:55], v[108:111], v[88:91], v[52:55]
    ds_read_b64_tr_b16 v[156:157], v18 offset:4096
    ds_read_b64_tr_b16 v[158:159], v18 offset:6144
    v_mfma_f32_16x16x32_bf16 v[60:63], v[108:111], v[92:95], v[60:63]
    ds_read_b128 v[128:131], v16 offset:8192
    v_mfma_f32_16x16x32_bf16 v[32:35], v[96:99], v[64:67], v[32:35]
    ds_read_b128 v[132:135], v16 offset:9216
    ds_read_b128 v[136:139], v19 offset:8192
    v_mfma_f32_16x16x32_bf16 v[40:43], v[96:99], v[68:71], v[40:43]
    ds_read_b128 v[140:143], v19 offset:9216
    v_mfma_f32_16x16x32_bf16 v[36:39], v[100:103], v[64:67], v[36:39]
    s_mov_b32 s24, s23
    s_add_u32 s23, s23, 32768
    v_mfma_f32_16x16x32_bf16 v[44:47], v[100:103], v[68:71], v[44:47]
    s_cmp_eq_u32 s23, 163840
    s_cselect_b32 s23, 0, s23
    v_mfma_f32_16x16x32_bf16 v[32:35], v[104:107], v[80:83], v[32:35]
    v_add_u32 v16, s23, v10
    v_add_u32 v17, s23, v13
    v_mfma_f32_16x16x32_bf16 v[40:43], v[104:107], v[84:87], v[40:43]
    v_add_u32 v18, s23, v14
    v_mfma_f32_16x16x32_bf16 v[36:39], v[108:111], v[80:83], v[36:39]
    v_add_u32 v19, s23, v15
    v_mfma_f32_16x16x32_bf16 v[44:47], v[108:111], v[84:87], v[44:47]
    s_waitcnt vmcnt(12) lgkmcnt(0)
    s_barrier
    v_mfma_f32_16x16x32_bf16 v[48:51], v[144:147], v[120:123], v[48:51]
    ds_read_b64_tr_b16 v[96:97], v17 offset:0
    ds_read_b64_tr_b16 v[98:99], v17 offset:2048
    v_mfma_f32_16x16x32_bf16 v[56:59], v[144:147], v[124:127], v[56:59]
    ds_read_b64_tr_b16 v[100:101], v18 offset:0
    ds_read_b64_tr_b16 v[102:103], v18 offset:2048
    v_mfma_f32_16x16x32_bf16 v[52:55], v[148:151], v[120:123], v[52:55]
    ds_read_b128 v[64:67], v16 offset:0
    v_mfma_f32_16x16x32_bf16 v[60:63], v[148:151], v[124:127], v[60:63]
    ds_read_b128 v[68:71], v16 offset:1024
    ds_read_b128 v[72:75], v19 offset:0
    v_mfma_f32_16x16x32_bf16 v[48:51], v[152:155], v[136:139], v[48:51]
    ds_read_b128 v[76:79], v19 offset:1024
    v_mfma_f32_16x16x32_bf16 v[56:59], v[152:155], v[140:143], v[56:59]
    ds_read_b64_tr_b16 v[104:105], v17 offset:4096
    ds_read_b64_tr_b16 v[106:107], v17 offset:6144
    v_mfma_f32_16x16x32_bf16 v[52:55], v[156:159], v[136:139], v[52:55]
    ds_read_b64_tr_b16 v[108:109], v18 offset:4096
    ds_read_b64_tr_b16 v[110:111], v18 offset:6144
    v_mfma_f32_16x16x32_bf16 v[60:63], v[156:159], v[140:143], v[60:63]
    ds_read_b128 v[80:83], v16 offset:8192
    v_mfma_f32_16x16x32_bf16 v[32:35], v[144:147], v[112:115], v[32:35]
    ds_read_b128 v[84:87], v16 offset:9216
    ds_read_b128 v[88:91], v19 offset:8192
    v_mfma_f32_16x16x32_bf16 v[40:43], v[144:147], v[116:119], v[40:43]
    ds_read_b128 v[92:95], v19 offset:9216
    v_mfma_f32_16x16x32_bf16 v[36:39], v[148:151], v[112:115], v[36:39]
    s_mov_b32 s24, s23
    s_add_u32 s23, s23, 32768
    v_mfma_f32_16x16x32_bf16 v[44:47], v[148:151], v[116:119], v[44:47]
    s_cmp_eq_u32 s23, 163840
    s_cselect_b32 s23, 0, s23
    v_mfma_f32_16x16x32_bf16 v[32:35], v[152:155], v[128:131], v[32:35]
    v_add_u32 v16, s23, v10
    v_add_u32 v17, s23, v13
    v_mfma_f32_16x16x32_bf16 v[40:43], v[152:155], v[132:135], v[40:43]
    v_add_u32 v18, s23, v14
    v_mfma_f32_16x16x32_bf16 v[36:39], v[156:159], v[128:131], v[36:39]
    v_add_u32 v19, s23, v15
    v_mfma_f32_16x16x32_bf16 v[44:47], v[156:159], v[132:135], v[44:47]
    s_waitcnt vmcnt(8) lgkmcnt(0)
    s_barrier
    v_mfma_f32_16x16x32_bf16 v[48:51], v[96:99], v[72:75], v[48:51]
    ds_read_b64_tr_b16 v[144:145], v17 offset:0
    ds_read_b64_tr_b16 v[146:147], v17 offset:2048
    v_mfma_f32_16x16x32_bf16 v[56:59], v[96:99], v[76:79], v[56:59]
    ds_read_b64_tr_b16 v[148:149], v18 offset:0
    ds_read_b64_tr_b16 v[150:151], v18 offset:2048
    v_mfma_f32_16x16x32_bf16 v[52:55], v[100:103], v[72:75], v[52:55]
    ds_read_b128 v[112:115], v16 offset:0
    v_mfma_f32_16x16x32_bf16 v[60:63], v[100:103], v[76:79], v[60:63]
    ds_read_b128 v[116:119], v16 offset:1024
    ds_read_b128 v[120:123], v19 offset:0
    v_mfma_f32_16x16x32_bf16 v[48:51], v[104:107], v[88:91], v[48:51]
    ds_read_b128 v[124:127], v19 offset:1024
    v_mfma_f32_16x16x32_bf16 v[56:59], v[104:107], v[92:95], v[56:59]
    ds_read_b64_tr_b16 v[152:153], v17 offset:4096
    ds_read_b64_tr_b16 v[154:155], v17 offset:6144
    v_mfma_f32_16x16x32_bf16 v[52:55], v[108:111], v[88:91], v[52:55]
    ds_read_b64_tr_b16 v[156:157], v18 offset:4096
    ds_read_b64_tr_b16 v[158:159], v18 offset:6144
    v_mfma_f32_16x16x32_bf16 v[60:63], v[108:111], v[92:95], v[60:63]
    ds_read_b128 v[128:131], v16 offset:8192
    v_mfma_f32_16x16x32_bf16 v[32:35], v[96:99], v[64:67], v[32:35]
    ds_read_b128 v[132:135], v16 offset:9216
    ds_read_b128 v[136:139], v19 offset:8192
    v_mfma_f32_16x16x32_bf16 v[40:43], v[96:99], v[68:71], v[40:43]
    ds_read_b128 v[140:143], v19 offset:9216
    v_mfma_f32_16x16x32_bf16 v[36:39], v[100:103], v[64:67], v[36:39]
    s_mov_b32 s24, s23
    s_add_u32 s23, s23, 32768
    v_mfma_f32_16x16x32_bf16 v[44:47], v[100:103], v[68:71], v[44:47]
    s_cmp_eq_u32 s23, 163840
    s_cselect_b32 s23, 0, s23
    v_mfma_f32_16x16x32_bf16 v[32:35], v[104:107], v[80:83], v[32:35]
    v_add_u32 v16, s23, v10
    v_add_u32 v17, s23, v13
    v_mfma_f32_16x16x32_bf16 v[40:43], v[104:107], v[84:87], v[40:43]
    v_add_u32 v18, s23, v14
    v_mfma_f32_16x16x32_bf16 v[36:39], v[108:111], v[80:83], v[36:39]
    v_add_u32 v19, s23, v15
    v_mfma_f32_16x16x32_bf16 v[44:47], v[108:111], v[84:87], v[44:47]
    s_waitcnt vmcnt(4) lgkmcnt(0)
    s_barrier
    v_mfma_f32_16x16x32_bf16 v[48:51], v[144:147], v[120:123], v[48:51]
    ds_read_b64_tr_b16 v[96:97], v17 offset:0
    ds_read_b64_tr_b16 v[98:99], v17 offset:2048
    v_mfma_f32_16x16x32_bf16 v[56:59], v[144:147], v[124:127], v[56:59]
    ds_read_b64_tr_b16 v[100:101], v18 offset:0
    ds_read_b64_tr_b16 v[102:103], v18 offset:2048
    v_mfma_f32_16x16x32_bf16 v[52:55], v[148:151], v[120:123], v[52:55]
    ds_read_b128 v[64:67], v16 offset:0
    v_mfma_f32_16x16x32_bf16 v[60:63], v[148:151], v[124:127], v[60:63]
    ds_read_b128 v[68:71], v16 offset:1024
    ds_read_b128 v[72:75], v19 offset:0
    v_mfma_f32_16x16x32_bf16 v[48:51], v[152:155], v[136:139], v[48:51]
    ds_read_b128 v[76:79], v19 offset:1024
    v_mfma_f32_16x16x32_bf16 v[56:59], v[152:155], v[140:143], v[56:59]
    ds_read_b64_tr_b16 v[104:105], v17 offset:4096
    ds_read_b64_tr_b16 v[106:107], v17 offset:6144
    v_mfma_f32_16x16x32_bf16 v[52:55], v[156:159], v[136:139], v[52:55]
    ds_read_b64_tr_b16 v[108:109], v18 offset:4096
    ds_read_b64_tr_b16 v[110:111], v18 offset:6144
    v_mfma_f32_16x16x32_bf16 v[60:63], v[156:159], v[140:143], v[60:63]
    ds_read_b128 v[80:83], v16 offset:8192
    v_mfma_f32_16x16x32_bf16 v[32:35], v[144:147], v[112:115], v[32:35]
    ds_read_b128 v[84:87], v16 offset:9216
    ds_read_b128 v[88:91], v19 offset:8192
    v_mfma_f32_16x16x32_bf16 v[40:43], v[144:147], v[116:119], v[40:43]
    ds_read_b128 v[92:95], v19 offset:9216
    v_mfma_f32_16x16x32_bf16 v[36:39], v[148:151], v[112:115], v[36:39]
    s_mov_b32 s24, s23
    s_add_u32 s23, s23, 32768
    v_mfma_f32_16x16x32_bf16 v[44:47], v[148:151], v[116:119], v[44:47]
    s_cmp_eq_u32 s23, 163840
    s_cselect_b32 s23, 0, s23
    v_mfma_f32_16x16x32_bf16 v[32:35], v[152:155], v[128:131], v[32:35]
    v_add_u32 v16, s23, v10
    v_add_u32 v17, s23, v13
    v_mfma_f32_16x16x32_bf16 v[40:43], v[152:155], v[132:135], v[40:43]
    v_add_u32 v18, s23, v14
    v_mfma_f32_16x16x32_bf16 v[36:39], v[156:159], v[128:131], v[36:39]
    v_add_u32 v19, s23, v15
    v_mfma_f32_16x16x32_bf16 v[44:47], v[156:159], v[132:135], v[44:47]
    s_waitcnt vmcnt(0) lgkmcnt(0)
    s_barrier
    v_mfma_f32_16x16x32_bf16 v[48:51], v[96:99], v[72:75], v[48:51]
    ds_read_b64_tr_b16 v[144:145], v17 offset:0
    ds_read_b64_tr_b16 v[146:147], v17 offset:2048
    v_mfma_f32_16x16x32_bf16 v[56:59], v[96:99], v[76:79], v[56:59]
    ds_read_b64_tr_b16 v[148:149], v18 offset:0
    ds_read_b64_tr_b16 v[150:151], v18 offset:2048
    v_mfma_f32_16x16x32_bf16 v[52:55], v[100:103], v[72:75], v[52:55]
    ds_read_b128 v[112:115], v16 offset:0
    v_mfma_f32_16x16x32_bf16 v[60:63], v[100:103], v[76:79], v[60:63]
    ds_read_b128 v[116:119], v16 offset:1024
    ds_read_b128 v[120:123], v19 offset:0
    v_mfma_f32_16x16x32_bf16 v[48:51], v[104:107], v[88:91], v[48:51]
    ds_read_b128 v[124:127], v19 offset:1024
    v_mfma_f32_16x16x32_bf16 v[56:59], v[104:107], v[92:95], v[56:59]
    ds_read_b64_tr_b16 v[152:153], v17 offset:4096
    ds_read_b64_tr_b16 v[154:155], v17 offset:6144
    v_mfma_f32_16x16x32_bf16 v[52:55], v[108:111], v[88:91], v[52:55]
    ds_read_b64_tr_b16 v[156:157], v18 offset:4096
    ds_read_b64_tr_b16 v[158:159], v18 offset:6144
    v_mfma_f32_16x16x32_bf16 v[60:63], v[108:111], v[92:95], v[60:63]
    ds_read_b128 v[128:131], v16 offset:8192
    v_mfma_f32_16x16x32_bf16 v[32:35], v[96:99], v[64:67], v[32:35]
    ds_read_b128 v[132:135], v16 offset:9216
    ds_read_b128 v[136:139], v19 offset:8192
    v_mfma_f32_16x16x32_bf16 v[40:43], v[96:99], v[68:71], v[40:43]
    ds_read_b128 v[140:143], v19 offset:9216
    v_mfma_f32_16x16x32_bf16 v[36:39], v[100:103], v[64:67], v[36:39]
    s_mov_b32 s24, s23
    s_add_u32 s23, s23, 32768
    v_mfma_f32_16x16x32_bf16 v[44:47], v[100:103], v[68:71], v[44:47]
    s_cmp_eq_u32 s23, 163840
    s_cselect_b32 s23, 0, s23
    v_mfma_f32_16x16x32_bf16 v[32:35], v[104:107], v[80:83], v[32:35]
    v_add_u32 v16, s23, v10
    v_add_u32 v17, s23, v13
    v_mfma_f32_16x16x32_bf16 v[40:43], v[104:107], v[84:87], v[40:43]
    v_add_u32 v18, s23, v14
    v_mfma_f32_16x16x32_bf16 v[36:39], v[108:111], v[80:83], v[36:39]
    v_add_u32 v19, s23, v15
    v_mfma_f32_16x16x32_bf16 v[44:47], v[108:111], v[84:87], v[44:47]
    s_waitcnt lgkmcnt(0)
    v_mfma_f32_16x16x32_bf16 v[48:51], v[144:147], v[120:123], v[48:51]
    v_mfma_f32_16x16x32_bf16 v[56:59], v[144:147], v[124:127], v[56:59]
    v_mfma_f32_16x16x32_bf16 v[52:55], v[148:151], v[120:123], v[52:55]
    v_mfma_f32_16x16x32_bf16 v[60:63], v[148:151], v[124:127], v[60:63]
    v_mfma_f32_16x16x32_bf16 v[48:51], v[152:155], v[136:139], v[48:51]
    v_mfma_f32_16x16x32_bf16 v[56:59], v[152:155], v[140:143], v[56:59]
    v_mfma_f32_16x16x32_bf16 v[52:55], v[156:159], v[136:139], v[52:55]
    v_mfma_f32_16x16x32_bf16 v[60:63], v[156:159], v[140:143], v[60:63]
    v_mfma_f32_16x16x32_bf16 v[32:35], v[144:147], v[112:115], v[32:35]
    v_mfma_f32_16x16x32_bf16 v[40:43], v[144:147], v[116:119], v[40:43]
    v_mfma_f32_16x16x32_bf16 v[36:39], v[148:151], v[112:115], v[36:39]
    v_mfma_f32_16x16x32_bf16 v[44:47], v[148:151], v[116:119], v[44:47]
    s_nop 4
    v_cvt_pk_bf16_f32 v160, v48, v49
    v_cvt_pk_bf16_f32 v161, v50, v51
    v_mfma_f32_16x16x32_bf16 v[32:35], v[152:155], v[128:131], v[32:35]
    v_cvt_pk_bf16_f32 v162, v52, v53
    v_cvt_pk_bf16_f32 v163, v54, v55
    v_mfma_f32_16x16x32_bf16 v[40:43], v[152:155], v[132:135], v[40:43]
    buffer_store_dwordx4 v[160:163], v6, s[52:55], s40 offen offset:0 sc1
    v_cvt_pk_bf16_f32 v164, v56, v57
    v_mfma_f32_16x16x32_bf16 v[36:39], v[156:159], v[128:131], v[36:39]
    v_cvt_pk_bf16_f32 v165, v58, v59
    v_cvt_pk_bf16_f32 v166, v60, v61
    v_mfma_f32_16x16x32_bf16 v[44:47], v[156:159], v[132:135], v[44:47]
    v_cvt_pk_bf16_f32 v167, v62, v63
    buffer_store_dwordx4 v[164:167], v6, s[52:55], s40 offen offset:1024 sc1
    s_nop 7
d2_epi:
    s_mov_b32 s28, 262144
    s_waitcnt vmcnt(0)
    s_mov_b64 exec, 1
    buffer_store_dwordx2 v[248:249], v20, s[52:55], s42 offen sc1
d2_poll:
    buffer_load_dwordx2 v[22:23], v20, s[52:55], s43 offen sc1
    s_waitcnt vmcnt(0)
    v_cmp_ne_u64 vcc, v[248:249], v[22:23]
    s_nop 1
    s_cmp_eq_u64 vcc, 0
    s_cbranch_scc1 d2_got
    s_sleep 1
    s_sub_u32 s28, s28, 1
    s_cmp_lg_u32 s28, 0
    s_cbranch_scc1 d2_poll
d2_got:
    s_mov_b64 exec, -1
    buffer_load_dwordx4 v[64:67], v6, s[52:55], s41 offen offset:0 sc1
    buffer_load_dwordx4 v[68:71], v6, s[52:55], s41 offen offset:1024 sc1
    s_waitcnt vmcnt(1)
    v_lshlrev_b32 v84, 16, v64
    v_and_b32 v85, 0xffff0000, v64
    v_lshlrev_b32 v86, 16, v65
    v_and_b32 v87, 0xffff0000, v65
    v_lshlrev_b32 v88, 16, v66
    v_and_b32 v89, 0xffff0000, v66
    v_lshlrev_b32 v90, 16, v67
    v_and_b32 v91, 0xffff0000, v67
    v_pk_add_f32 v[32:33], v[32:33], v[84:85]
    v_pk_add_f32 v[34:35], v[34:35], v[86:87]
    v_pk_add_f32 v[36:37], v[36:37], v[88:89]
    v_pk_add_f32 v[38:39], v[38:39], v[90:91]
    v_cvt_pk_bf16_f32 v112, v32, v33
    v_cvt_pk_bf16_f32 v113, v34, v35
    v_cvt_pk_bf16_f32 v114, v36, v37
    v_cvt_pk_bf16_f32 v115, v38, v39
    s_nop 1
    v_permlane16_swap_b32 v112, v114
    v_permlane16_swap_b32 v113, v115
    s_nop 1
    buffer_store_dwordx4 v[112:115], v9, s[48:51], s35 offen
    s_waitcnt vmcnt(1)
    v_lshlrev_b32 v84, 16, v68
    v_and_b32 v85, 0xffff0000, v68
    v_lshlrev_b32 v86, 16, v69
    v_and_b32 v87, 0xffff0000, v69
    v_lshlrev_b32 v88, 16, v70
    v_and_b32 v89, 0xffff0000, v70
    v_lshlrev_b32 v90, 16, v71
    v_and_b32 v91, 0xffff0000, v71
    v_pk_add_f32 v[40:41], v[40:41], v[84:85]
    v_pk_add_f32 v[42:43], v[42:43], v[86:87]
    v_pk_add_f32 v[44:45], v[44:45], v[88:89]
    v_pk_add_f32 v[46:47], v[46:47], v[90:91]
    v_cvt_pk_bf16_f32 v116, v40, v41
    v_cvt_pk_bf16_f32 v117, v42, v43
    v_cvt_pk_bf16_f32 v118, v44, v45
    v_cvt_pk_bf16_f32 v119, v46, v47
    s_nop 1
    v_permlane16_swap_b32 v116, v118
    v_permlane16_swap_b32 v117, v119
    s_nop 1
    buffer_store_dwordx4 v[116:119], v9, s[48:51], s36 offen
the_end:
    s_endpgm
attn_slow:
    v_mov_b32 v18, 0xff800000
    s_mov_b32 s28, 0
attn_slow1:
    buffer_load_dwordx4 v[88:91], v6, s[8:11], s28 offen sc1
    buffer_load_dwordx4 v[92:95], v6, s[8:11], s28 offen offset:1024 sc1
    s_waitcnt vmcnt(0)
    s_nop 15
    v_mfma_f32_32x32x16_bf16 v[48:63], v[88:91], v[8:11], 0
    v_mfma_f32_32x32x16_bf16 v[48:63], v[92:95], v[12:15], v[48:63]
    s_nop 15
    s_nop 3
    v_max3_f32 v18, v18, v48, v49
    v_max3_f32 v18, v18, v50, v51
    v_max3_f32 v18, v18, v52, v53
    v_max3_f32 v18, v18, v54, v55
    v_max3_f32 v18, v18, v56, v57
    v_max3_f32 v18, v18, v58, v59
    v_max3_f32 v18, v18, v60, v61
    v_max3_f32 v18, v18, v62, v63
    s_add_u32 s28, s28, 2048
    s_cmp_lt_u32 s28, 131072
    s_cbranch_scc1 attn_slow1
    v_mov_b32 v19, v18
    s_nop 1
    v_permlane32_swap_b32 v19, v18
    s_nop 1
    v_max_f32 v18, v18, v19
    v_sub_f32 v32, 0, v18
    v_sub_f32 v33, 0, v18
    v_sub_f32 v34, 0, v18
    v_sub_f32 v35, 0, v18
    v_sub_f32 v36, 0, v18
    v_sub_f32 v37, 0, v18
    v_sub_f32 v38, 0, v18
    v_sub_f32 v39, 0, v18
    v_sub_f32 v40, 0, v18
    v_sub_f32 v41, 0, v18
    v_sub_f32 v42, 0, v18
    v_sub_f32 v43, 0, v18
    v_sub_f32 v44, 0, v18
    v_sub_f32 v45, 0, v18
    v_sub_f32 v46, 0, v18
    v_sub_f32 v47, 0, v18
    v_mov_b32 v104, 0
    v_mov_b32 v105, 0
    v_mov_b32 v106, 0
    v_mov_b32 v107, 0
    v_mov_b32 v108, 0
    v_mov_b32 v109, 0
    v_mov_b32 v110, 0
    v_mov_b32 v111, 0
    v_mov_b32 v112, 0
    v_mov_b32 v113, 0
    v_mov_b32 v114, 0
    v_mov_b32 v115, 0
    v_mov_b32 v116, 0
    v_mov_b32 v117, 0
    v_mov_b32 v118, 0
    v_mov_b32 v119, 0
    v_mov_b32 v120, 0
    v_mov_b32 v121, 0
    v_mov_b32 v122, 0
    v_mov_b32 v123, 0
    s_mov_b32 s28, 0
attn_slow2:
    buffer_load_dwordx4 v[88:91], v6, s[8:11], s28 offen sc1
    buffer_load_dwordx4 v[92:95], v6, s[8:11], s28 offen offset:1024 sc1
    buffer_load_dwordx4 v[96:99], v6, s[12:15], s28 offen sc1
    buffer_load_dwordx4 v[100:103], v6, s[12:15], s28 offen offset:1024 sc1
    s_waitcnt vmcnt(0)
    v_mfma_f32_32x32x16_bf16 v[48:63], v[88:91], v[8:11], v[32:47]
    v_mfma_f32_32x32x16_bf16 v[48:63], v[92:95], v[12:15], v[48:63]
    s_nop 15
    s_nop 3
    v_exp_f32 v48, v48
    v_exp_f32 v49, v49
    v_exp_f32 v50, v50
    v_exp_f32 v51, v51
    v_exp_f32 v52, v52
    v_exp_f32 v53, v53
    v_exp_f32 v54, v54
    v_exp_f32 v55, v55
    v_exp_f32 v56, v56
    v_exp_f32 v57, v57
    v_exp_f32 v58, v58
    v_exp_f32 v59, v59
    v_exp_f32 v60, v60
    v_exp_f32 v61, v61
    v_exp_f32 v62, v62
    v_exp_f32 v63, v63
    s_nop 0
    v_cvt_pk_bf16_f32 v80, v48, v49
    v_cvt_pk_bf16_f32 v81, v50, v51
    v_cvt_pk_bf16_f32 v82, v52, v53
    v_cvt_pk_bf16_f32 v83, v54, v55
    v_cvt_pk_bf16_f32 v84, v56, v57
    v_cvt_pk_bf16_f32 v85, v58, v59
    v_cvt_pk_bf16_f32 v86, v60, v61
    v_cvt_pk_bf16_f32 v87, v62, v63
    s_nop 1
    v_mfma_f32_32x32x16_bf16 v[104:119], v[96:99], v[80:83], v[104:119]
    v_mfma_f32_32x32x16_bf16 v[104:119], v[100:103], v[84:87], v[104:119]
    v_mfma_f32_16x16x32_bf16 v[120:123], v[124:127], v[80:83], v[120:123]
    v_mfma_f32_16x16x32_bf16 v[120:123], v[124:127], v[84:87], v[120:123]
    s_nop 15
    s_add_u32 s28, s28, 2048
    s_cmp_lt_u32 s28, 131072
    s_cbranch_scc1 attn_slow2
    s_nop 15
    s_branch attn_fin
code_end:
.section .rodata,"a"
.p2align 6
.amdhsa_kernel sequential_preLN__mha_block__glu_gated_glu__prompt_kernel
  .amdhsa_next_free_vgpr 256
  .amdhsa_next_free_sgpr 64
  .amdhsa_accum_offset 256
  .amdhsa_group_segment_fixed_size 0
  .amdhsa_kernarg_size 80
  .amdhsa_user_sgpr_count 2
  .amdhsa_user_sgpr_kernarg_segment_ptr 1
  .amdhsa_system_sgpr_workgroup_id_x 1
.end_amdhsa_kernel
```
